```python
import torch

def _softmax(x, axis=-1):
    return torch.softmax(x, dim=axis)
def _gelu(x):
    return torch.nn.functional.gelu(x, approximate="tanh")
def _silu(x):
    return torch.nn.functional.silu(x)
def _sigmoid(x):
    return torch.sigmoid(x)
def _layernorm(x, axis=-1, eps=1e-5):
    m = x.mean(dim=axis, keepdim=True)
    v = x.var(dim=axis, keepdim=True, unbiased=False)
    return (x - m) / torch.sqrt(v + eps)
def _scatter_add(tgt, idx, src, axis=0):
    return tgt.clone().index_add_(axis, idx, src)
def _segment_sum(src, seg, n):
    out = torch.zeros((n,) + src.shape[1:], dtype=src.dtype)
    return out.index_add_(0, seg, src)
def _pad(x, pw):
    flat = tuple(v for pair in reversed(pw) for v in pair)
    return torch.nn.functional.pad(x, flat)

kernel_name = 'recurrent_scan__sliding_local_dilated__dense_activation_gelu__prompt'

def setup_inputs():

    _w = (lambda a: (lambda t: t.to(torch.bfloat16) if t.is_floating_point() else t)(torch.as_tensor(a)))
    def _A_setup():
        B, S, D = 1, 2048, 512
        return {
            "x": _w((lambda *s: torch.randn(*s, dtype=torch.bfloat16) * 0.05)(B, S, D)),
            "wqkv": _w((lambda *s: torch.randn(*s, dtype=torch.bfloat16) * 0.2)(D, 3 * D)),
            "wo": _w((lambda *s: torch.randn(*s, dtype=torch.bfloat16) * 0.2)(D, D)),
        }
    _A_in = _A_setup()

    def _B_setup():
        B, S, D, F = 1, 2048, 512, 1792
        return {
            "x": _w((lambda *s: torch.randn(*s, dtype=torch.bfloat16) * 0.05)(B, S, D)),
            "w1": _w((lambda *s: torch.randn(*s, dtype=torch.bfloat16) * 0.4)(D, F) * (D ** -0.5)),
            "b1": _w((lambda *s: torch.randn(*s, dtype=torch.bfloat16) * 0.4)(F) * 0.01),
            "w2": _w((lambda *s: torch.randn(*s, dtype=torch.bfloat16) * 0.1)(F, D) * (F ** -0.5)),
            "b2": _w((lambda *s: torch.randn(*s, dtype=torch.bfloat16) * 0.1)(D) * 0.01),
        }
    _B_in = _B_setup()

    return {
        "A_x": _A_in["x"],
        "A_wqkv": _A_in["wqkv"],
        "A_wo": _A_in["wo"],
        "B_x": _B_in["x"],
        "B_w1": _B_in["w1"],
        "B_b1": _B_in["b1"],
        "B_w2": _B_in["w2"],
        "B_b2": _B_in["b2"],
    }

def reference(A_x, A_wqkv, A_wo, B_x, B_w1, B_b1, B_w2, B_b2):
    def _A_ref(x, wqkv, wo):
        B, S, D = x.shape
        H = 32; Dh = D // H
        W, dil = 8, 2
        qkv = (lambda x, *d: x.permute(*d))((x @ wqkv).reshape(B, S, 3, H, Dh), 2, 0, 3, 1, 4)
        q, k, v = qkv[0], qkv[1], qkv[2]
        scale = Dh ** -0.5
        pos = torch.arange(S)
        off = torch.arange(W) * dil
        idx = pos[:, None] - off[None, :]
        mask = idx >= 0
        idx_c = torch.where(mask, idx, 0).reshape(-1)
        kg = k[:, :, idx_c, :].reshape(B, H, S, W, Dh)
        vg = v[:, :, idx_c, :].reshape(B, H, S, W, Dh)
        logits = torch.einsum("bhsd,bhswd->bhsw", q, kg) * scale
        logits = torch.where(mask[None, None, :, :], logits, -1e9)
        attn = _softmax(logits, axis=-1)
        o = torch.einsum("bhsw,bhswd->bhsd", attn, vg)
        return (lambda x, *d: x.permute(*d))(o, 0, 2, 1, 3).reshape(B, S, D) @ wo

    def _B_ref(x, w1, b1, w2, b2):
        h = torch.einsum("bsd,df->bsf", x, w1) + b1
        h = _gelu(h)
        return torch.einsum("bsf,fd->bsd", h, w2) + b2

    x = A_x
    xn = _layernorm(x, axis=-1)
    s = _A_ref(xn, A_wqkv, A_wo)
    g = _silu(_B_ref(xn, B_w1, B_b1, B_w2, B_b2))
    return x + s * g
```

```asm
; @launch grid=(256,1,1) block=(256,1,1) lds=163840
.amdgcn_target "amdgcn-amd-amdhsa--gfx950"
.text
.globl recurrent_scan__sliding_local_dilated__dense_activation_gelu__prompt_kernel
.p2align 8
.type recurrent_scan__sliding_local_dilated__dense_activation_gelu__prompt_kernel,@function
recurrent_scan__sliding_local_dilated__dense_activation_gelu__prompt_kernel:
    s_load_dwordx2 s[8:9], s[0:1], 0
    s_load_dwordx2 s[12:13], s[0:1], 32
    s_load_dwordx2 s[78:79], s[0:1], 8
    s_cmp_ge_u32 s2, 256
    s_cbranch_scc1 L_exit
    s_getpc_b64 s[48:49]
    s_mov_b32 s50, L_code_end - recurrent_scan__sliding_local_dilated__dense_activation_gelu__prompt_kernel - 128
    s_mov_b32 s51, 0x20000
    s_lshr_b32 s3, s2, 3
    v_lshrrev_b32 v2, 6, v0
    s_lshl_b32 s77, s3, 7
    v_lshl_add_u32 v4, v0, 12, s77
    v_min_u32 v4, s50, v4
    v_mov_b32 v5, 0
    v_lshl_add_u64 v[4:5], v[4:5], 0, s[48:49]
    global_load_dword v9, v[4:5], off
    v_readfirstlane_b32 s4, v2
    v_and_b32 v0, 63, v0
    s_and_b32 s77, s3, 3
    s_lshr_b32 s6, s3, 2
    s_and_b32 s5, s2, 3
    s_lshl2_add_u32 s5, s5, s77
    s_lshl1_add_u32 s7, s77, s6
    s_and_b32 s77, s7, 7
    s_lshl_b32 s52, s77, 7
    s_and_b32 s68, s4, 1
    s_lshr_b32 s69, s4, 1
    s_lshl_b32 s72, s4, 12
    s_bitset1_b32 s72, 16
    s_mov_b32 s10, 2097152
    s_mov_b32 s11, s51
    s_lshl1_add_u32 s77, s5, s68
    s_lshl_b32 s77, s77, 6
    s_add_u32 s77, s77, s69
    s_lshl_b32 s77, s77, 10
    v_lshrrev_b32 v1, 3, v0
    v_lshrrev_b32 v2, 4, v0
    v_and_b32 v3, 7, v0
    v_xor_b32 v4, v2, v3
    v_lshl_add_u32 v4, v4, 4, s77
    v_lshl_add_u32 v104, v1, 11, v4
    s_lshl4_add_u32 s77, s5, s69
    s_lshl3_add_u32 s77, s77, s68
    s_sub_u32 s77, s77, 16
    s_lshl_b32 s77, s77, 10
    v_and_b32 v4, 15, v0
    v_lshl_add_u32 v4, v4, 4, s77
    v_lshl_add_u32 v4, v2, 11, v4
    s_add_u32 m0, s72, 0
    s_bitcmp1_b32 s2, 7
    s_waitcnt lgkmcnt(0)
    s_cbranch_scc0 L_nohalo
    buffer_load_dwordx4 v[116:119], v4, s[8:11], 0 offen offset:0
    buffer_load_dwordx4 v[120:123], v4, s[8:11], 0 offen offset:256
    buffer_load_dwordx4 v[124:127], v4, s[8:11], 0 offen offset:512
    buffer_load_dwordx4 v[128:131], v4, s[8:11], 0 offen offset:768
    s_mov_b64 s[12:13], s[78:79]
L_nohalo:
    buffer_load_dwordx4 v104, s[8:11], s52 offen offset:0 lds
    v_xor_b32 v105, 64, v104
    v_add_u32 v105, 15360, v105
    v_add_u32 v106, 30720, v104
    v_add_u32 v107, 30720, v105
    buffer_load_dwordx4 v105, s[8:11], s52 offen offset:1024 lds
    s_and_b32 s6, s6, 3
    s_and_b32 s77, s2, 4
    s_or_b32 s6, s6, s77
    s_mul_i32 s77, s6, 7
    s_add_u32 s77, s77, 1
    s_lshr_b32 s77, s77, 1
    s_and_b32 s83, s2, 3
    s_cmp_eq_u32 s83, 3
    s_cselect_b32 s83, 0, s83
    s_add_u32 s77, s77, s83
    s_bitcmp1_b32 s2, 7
    s_cselect_b32 s77, s6, s77
    s_cselect_b32 s91, 6, 7
    s_lshl_b32 s99, s77, 7
    s_lshl_b32 s14, s91, 18
    s_mov_b32 s15, s51
    s_lshl_b32 s91, s91, 8
    buffer_load_dwordx4 v106, s[8:11], s52 offen offset:2048 lds
    v_and_b32 v2, 1, v2
    v_lshlrev_b32 v2, 2, v2
    v_xor_b32 v2, v2, v3
    v_lshlrev_b32 v2, 4, v2
    v_lshl_add_u32 v3, s4, 4, v1
    v_mul_u32_u24 v3, s91, v3
    v_lshl_add_u32 v3, v3, 1, v2
    v_add_u32 v11, s99, v3
    s_lshl_b32 s77, s91, 4
    s_sub_u32 s77, s77, 1024
    v_add_u32 v12, s77, v11
    buffer_load_dwordx4 v107, s[8:11], s52 offen offset:3072 lds
    s_mul_i32 s60, s52, s91
    s_lshl_b32 s73, s4, 11
    s_add_u32 m0, s73, 0
    s_nop 0
    buffer_load_dwordx4 v11, s[12:15], s60 offen offset:0 lds
    s_add_u32 s77, s52, 128
    s_and_b32 s53, s77, 0x380
    s_mul_i32 s61, s53, s91
    s_add_u32 s77, s53, 128
    s_and_b32 s54, s77, 0x380
    s_mul_i32 s62, s54, s91
    s_add_u32 s77, s54, 128
    s_and_b32 s55, s77, 0x380
    s_mul_i32 s63, s55, s91
    s_load_dwordx2 s[16:17], s[0:1], 80
    s_load_dwordx2 s[20:21], s[0:1], 48
    s_load_dwordx2 s[80:81], s[0:1], 16
    s_load_dwordx2 s[24:25], s[0:1], 64
    s_load_dwordx2 s[28:29], s[0:1], 72
    s_load_dwordx2 s[32:33], s[0:1], 40
    s_load_dwordx2 s[36:37], s[0:1], 56
    s_bitcmp1_b32 s2, 7
    s_cbranch_scc1 L_att
    buffer_load_dwordx4 v12, s[12:15], s60 offen offset:1024 lds
    v_lshrrev_b32 v2, 3, v0
    v_and_b32 v2, 6, v2
    v_xor_b32 v2, v2, v0
    v_and_b32 v2, 7, v2
    v_lshlrev_b32 v2, 4, v2
    v_lshl_add_u32 v15, v1, 10, v2
    v_lshlrev_b32 v8, 4, v0
    s_lshl_b32 s74, s4, 10
    s_add_u32 s77, s55, 128
    s_and_b32 s56, s77, 0x380
    s_mul_i32 s64, s56, s91
    s_add_u32 s77, s56, 128
    s_add_u32 m0, s73, 8192
    s_nop 0
    buffer_load_dwordx4 v11, s[12:15], s61 offen offset:0 lds
    s_and_b32 s57, s77, 0x380
    s_mul_i32 s65, s57, s91
    s_add_u32 s77, s57, 128
    s_and_b32 s58, s77, 0x380
    s_mul_i32 s66, s58, s91
    s_add_u32 s77, s58, 128
    s_and_b32 s59, s77, 0x380
    s_mul_i32 s67, s59, s91
    v_and_b32 v1, 31, v0
    v_lshrrev_b32 v2, 5, v0
    v_bfe_u32 v3, v0, 1, 3
    v_xor_b32 v3, v3, v2
    buffer_load_dwordx4 v12, s[12:15], s61 offen offset:1024 lds
    v_lshlrev_b32 v3, 4, v3
    v_lshl_add_u32 v3, v1, 7, v3
    s_xor_b32 s7, s69, s68
    s_lshl_b32 s77, s7, 6
    v_xor_b32 v3, s77, v3
    s_lshl_b32 s77, s68, 13
    s_add_u32 s77, s77, 65536
    s_lshl_b32 s82, s69, 12
    s_add_u32 s77, s77, s82
    v_add_u32 v108, s77, v3
    v_xor_b32 v109, 32, v108
    v_xor_b32 v110, 64, v108
    s_add_u32 m0, s72, 16384
    s_nop 0
    buffer_load_dwordx4 v104, s[8:11], s53 offen offset:0 lds
    v_xor_b32 v111, 96, v108
    v_xor_b32 v112, 4096, v108
    v_xor_b32 v113, 4096, v109
    v_xor_b32 v114, 4096, v110
    v_xor_b32 v115, 4096, v111
    v_bfe_u32 v1, v0, 2, 2
    v_bfe_u32 v3, v0, 4, 1
    v_and_b32 v4, 3, v0
    v_lshlrev_b32 v4, 3, v4
    v_lshl_add_u32 v4, v3, 5, v4
    v_lshl_add_u32 v3, v2, 3, v1
    v_lshl_add_u32 v13, v3, 7, v4
    v_bfe_u32 v5, v0, 3, 1
    v_xor_b32 v5, s69, v5
    v_lshl_add_u32 v13, v5, 6, v13
    s_lshl_b32 s77, s7, 12
    v_add_u32 v13, s77, v13
    v_xor_b32 v14, 4096, v13
    v_mov_b32 v23, 0x44444444
    v_mov_b32 v5, 0xeeeeeeee
    v_and_b32 v1, 1, v0
    v_cmp_eq_u32 vcc, 1, v1
    s_nop 1
    v_cndmask_b32 v23, v23, v5, vcc
    v_and_b32 v1, 4, v0
    v_cmp_eq_u32 vcc, 0, v1
    v_mov_b32 v5, 0x3f803f80
    s_nop 0
    v_cndmask_b32 v24, 0, v5, vcc
    v_mov_b32 v25, v24
    v_sub_u32 v26, v5, v24
    v_mov_b32 v27, v26
    v_mov_b32 v30, 0
    v_mov_b32 v31, 0
    v_mov_b32 v34, 0
    v_mov_b32 v35, 0
    v_mov_b32 v37, 0
    v_mov_b32 v38, 0
    v_mov_b32 v39, 0
    v_mov_b32 v40, 0
    v_mov_b32 v41, 0
    v_mov_b32 v42, 0
    v_mov_b32 v43, 0
    v_lshl_add_u32 v135, v3, 6, v4
    v_mov_b32 v156, 0
    v_mov_b32 v157, 0
    v_mov_b32 v158, 0
    v_mov_b32 v159, 0
    v_mov_b32 v160, 0
    v_mov_b32 v161, 0
    v_mov_b32 v162, 0
    v_mov_b32 v163, 0
    v_mov_b32 v164, 0
    v_mov_b32 v165, 0
    v_mov_b32 v166, 0
    v_mov_b32 v167, 0
    v_mov_b32 v168, 0
    v_mov_b32 v169, 0
    v_mov_b32 v170, 0
    v_mov_b32 v171, 0
    v_mov_b32 v172, 0
    v_mov_b32 v173, 0
    v_mov_b32 v174, 0
    v_mov_b32 v175, 0
    v_mov_b32 v176, 0
    v_mov_b32 v177, 0
    v_mov_b32 v178, 0
    v_mov_b32 v179, 0
    s_waitcnt lgkmcnt(0)
    buffer_load_dwordx4 v105, s[8:11], s53 offen offset:1024 lds
    s_xor_b32 s71, s6, 4
    buffer_load_dwordx4 v106, s[8:11], s53 offen offset:2048 lds
    s_lshr_b32 s77, s3, 4
    buffer_load_dwordx4 v107, s[8:11], s53 offen offset:3072 lds
    s_and_b32 s70, s2, 3
    s_add_u32 m0, s72, 32768
    s_nop 0
    buffer_load_dwordx4 v104, s[8:11], s54 offen offset:0 lds
    s_lshl1_add_u32 s70, s70, s77
    buffer_load_dwordx4 v105, s[8:11], s54 offen offset:1024 lds
    s_and_b32 s77, s3, 3
    buffer_load_dwordx4 v106, s[8:11], s54 offen offset:2048 lds
    s_lshl2_add_u32 s70, s70, s77
    buffer_load_dwordx4 v107, s[8:11], s54 offen offset:3072 lds
    s_lshl_b32 s77, s71, 7
    v_add_u32 v15, s77, v15
    s_mov_b32 s18, 12582912
    s_mov_b32 s26, 2097152
    s_mov_b32 s30, 256
    s_mov_b32 s34, 3584
    s_mov_b32 s38, 1024
    s_mov_b32 s19, s51
    s_mov_b32 s23, s51
    s_mov_b32 s27, s51
    s_mov_b32 s31, s51
    s_mov_b32 s35, s51
    s_mov_b32 s39, s51
    s_mov_b32 s43, s51
    s_mov_b32 s47, s51
    s_mov_b32 s87, s51
    s_mul_i32 s91, s6, 448
    s_bitcmp0_b32 s6, 0
    s_cselect_b32 s3, 384, 0
    s_add_u32 s91, s91, s3
    s_cmp_eq_u32 s83, 2
    s_movk_i32 s0, 128
    s_cselect_b32 s0, -256, s0
    s_cmp_eq_u32 s83, 1
    s_movk_i32 s1, 128
    s_cselect_b32 s1, -256, s1
    s_lshl_b32 s77, s7, 11
    v_add_u32 v135, s77, v135
    v_xor_b32 v136, 2048, v135
    v_lshrrev_b32 v1, 2, v0
    v_and_b32 v2, 3, v0
    s_waitcnt vmcnt(10)
    s_barrier
    ds_read_b64_tr_b16 v[44:45], v13 offset:0
    ds_read_b64_tr_b16 v[46:47], v13 offset:512
    ds_read_b128 a[0:3], v108 offset:0
    ds_read_b128 a[128:131], v112 offset:0
    ds_read_b64_tr_b16 v[48:49], v13 offset:2048
    ds_read_b64_tr_b16 v[50:51], v13 offset:2560
    ds_read_b128 a[4:7], v109 offset:0
    ds_read_b128 a[132:135], v113 offset:0
    ds_read_b64_tr_b16 v[52:53], v14 offset:0
    ds_read_b64_tr_b16 v[54:55], v14 offset:512
    ds_read_b128 a[8:11], v110 offset:0
    ds_read_b128 a[136:139], v114 offset:0
    s_waitcnt lgkmcnt(6)
    v_smfmac_f32_16x16x64_bf16 v[40:43], v[24:27], v[44:51], v23
    v_mfma_f32_32x32x16_bf16 v[68:83], v[44:47], a[0:3], 0
    s_add_u32 m0, s73, 16384
    ds_read_b64_tr_b16 v[56:57], v14 offset:2048
    ds_read_b64_tr_b16 v[58:59], v14 offset:2560
    buffer_load_dwordx4 v11, s[12:15], s62 offen offset:0 lds
    v_mfma_f32_32x32x16_bf16 v[84:99], v[44:47], a[128:131], 0
    ds_read_b128 a[12:15], v111 offset:0
    ds_read_b128 a[140:143], v115 offset:0
    s_waitcnt lgkmcnt(9)
    v_mfma_f32_32x32x16_bf16 v[68:83], v[48:51], a[4:7], v[68:83]
    buffer_load_dwordx4 v12, s[12:15], s62 offen offset:1024 lds
    s_waitcnt lgkmcnt(8)
    v_mfma_f32_32x32x16_bf16 v[84:99], v[48:51], a[132:135], v[84:99]
    s_add_u32 m0, s72, 49152
    s_nop 0
    buffer_load_dwordx4 v104, s[8:11], s55 offen offset:0 lds
    v_smfmac_f32_16x16x64_bf16 v[156:159], v[24:27], a[0:7], v23
    v_smfmac_f32_16x16x64_bf16 v[160:163], v[24:27], a[128:135], v23
    v_mfma_f32_4x4x4_16b_bf16 v[164:167], a[0:1], a[0:1], v[164:167]
    v_mfma_f32_4x4x4_16b_bf16 v[172:175], a[128:129], a[128:129], v[172:175]
    buffer_load_dwordx4 v105, s[8:11], s55 offen offset:1024 lds
    v_mfma_f32_4x4x4_16b_bf16 v[168:171], a[2:3], a[2:3], v[168:171]
    v_mfma_f32_4x4x4_16b_bf16 v[176:179], a[130:131], a[130:131], v[176:179]
    v_mfma_f32_4x4x4_16b_bf16 v[164:167], a[4:5], a[4:5], v[164:167]
    v_mfma_f32_4x4x4_16b_bf16 v[172:175], a[132:133], a[132:133], v[172:175]
    v_mfma_f32_4x4x4_16b_bf16 v[168:171], a[6:7], a[6:7], v[168:171]
    v_mfma_f32_4x4x4_16b_bf16 v[176:179], a[134:135], a[134:135], v[176:179]
    s_waitcnt lgkmcnt(2)
    v_mfma_f32_32x32x16_bf16 v[68:83], v[52:55], a[8:11], v[68:83]
    s_waitcnt vmcnt(8) lgkmcnt(0)
    s_barrier
    ds_read_b64_tr_b16 v[60:61], v13 offset:8192
    ds_read_b64_tr_b16 v[62:63], v13 offset:8704
    ds_read_b128 a[16:19], v108 offset:16384
    ds_read_b128 a[144:147], v112 offset:16384
    v_mfma_f32_32x32x16_bf16 v[84:99], v[52:55], a[136:139], v[84:99]
    ds_read_b64_tr_b16 v[64:65], v13 offset:10240
    ds_read_b64_tr_b16 v[66:67], v13 offset:10752
    ds_read_b128 a[20:23], v109 offset:16384
    ds_read_b128 a[148:151], v113 offset:16384
    buffer_load_dwordx4 v106, s[8:11], s55 offen offset:2048 lds
    v_mfma_f32_32x32x16_bf16 v[68:83], v[56:59], a[12:15], v[68:83]
    ds_read_b64_tr_b16 v[44:45], v14 offset:8192
    ds_read_b64_tr_b16 v[46:47], v14 offset:8704
    buffer_load_dwordx4 v107, s[8:11], s55 offen offset:3072 lds
    v_mfma_f32_32x32x16_bf16 v[84:99], v[56:59], a[140:143], v[84:99]
    ds_read_b128 a[24:27], v110 offset:16384
    ds_read_b128 a[152:155], v114 offset:16384
    s_waitcnt lgkmcnt(6)
    v_smfmac_f32_16x16x64_bf16 v[40:43], v[24:27], v[60:67], v23
    v_mfma_f32_32x32x16_bf16 v[68:83], v[60:63], a[16:19], v[68:83]
    s_add_u32 m0, s73, 24576
    ds_read_b64_tr_b16 v[48:49], v14 offset:10240
    ds_read_b64_tr_b16 v[50:51], v14 offset:10752
    buffer_load_dwordx4 v11, s[12:15], s63 offen offset:0 lds
    v_mfma_f32_32x32x16_bf16 v[84:99], v[60:63], a[144:147], v[84:99]
    ds_read_b128 a[28:31], v111 offset:16384
    ds_read_b128 a[156:159], v115 offset:16384
    buffer_load_dwordx4 v12, s[12:15], s63 offen offset:1024 lds
    s_waitcnt lgkmcnt(9)
    v_mfma_f32_32x32x16_bf16 v[68:83], v[64:67], a[20:23], v[68:83]
    s_waitcnt lgkmcnt(8)
    v_mfma_f32_32x32x16_bf16 v[84:99], v[64:67], a[148:151], v[84:99]
    s_add_u32 m0, s72, 0
    s_nop 0
    buffer_load_dwordx4 v104, s[8:11], s56 offen offset:0 lds
    v_smfmac_f32_16x16x64_bf16 v[156:159], v[24:27], a[16:23], v23
    v_smfmac_f32_16x16x64_bf16 v[160:163], v[24:27], a[144:151], v23
    v_mfma_f32_4x4x4_16b_bf16 v[164:167], a[16:17], a[16:17], v[164:167]
    v_mfma_f32_4x4x4_16b_bf16 v[172:175], a[144:145], a[144:145], v[172:175]
    buffer_load_dwordx4 v105, s[8:11], s56 offen offset:1024 lds
    v_mfma_f32_4x4x4_16b_bf16 v[168:171], a[18:19], a[18:19], v[168:171]
    v_mfma_f32_4x4x4_16b_bf16 v[176:179], a[146:147], a[146:147], v[176:179]
    v_mfma_f32_4x4x4_16b_bf16 v[164:167], a[20:21], a[20:21], v[164:167]
    v_mfma_f32_4x4x4_16b_bf16 v[172:175], a[148:149], a[148:149], v[172:175]
    v_mfma_f32_4x4x4_16b_bf16 v[168:171], a[22:23], a[22:23], v[168:171]
    v_mfma_f32_4x4x4_16b_bf16 v[176:179], a[150:151], a[150:151], v[176:179]
    s_waitcnt lgkmcnt(2)
    v_mfma_f32_32x32x16_bf16 v[68:83], v[44:47], a[24:27], v[68:83]
    s_waitcnt vmcnt(8) lgkmcnt(0)
    s_barrier
    ds_read_b64_tr_b16 v[52:53], v13 offset:16384
    ds_read_b64_tr_b16 v[54:55], v13 offset:16896
    ds_read_b128 a[32:35], v108 offset:32768
    ds_read_b128 a[160:163], v112 offset:32768
    v_mfma_f32_32x32x16_bf16 v[84:99], v[44:47], a[152:155], v[84:99]
    ds_read_b64_tr_b16 v[56:57], v13 offset:18432
    ds_read_b64_tr_b16 v[58:59], v13 offset:18944
    ds_read_b128 a[36:39], v109 offset:32768
    ds_read_b128 a[164:167], v113 offset:32768
    buffer_load_dwordx4 v106, s[8:11], s56 offen offset:2048 lds
    v_mfma_f32_32x32x16_bf16 v[68:83], v[48:51], a[28:31], v[68:83]
    ds_read_b64_tr_b16 v[60:61], v14 offset:16384
    ds_read_b64_tr_b16 v[62:63], v14 offset:16896
    buffer_load_dwordx4 v107, s[8:11], s56 offen offset:3072 lds
    v_mfma_f32_32x32x16_bf16 v[84:99], v[48:51], a[156:159], v[84:99]
    ds_read_b128 a[40:43], v110 offset:32768
    ds_read_b128 a[168:171], v114 offset:32768
    s_waitcnt lgkmcnt(6)
    v_smfmac_f32_16x16x64_bf16 v[40:43], v[24:27], v[52:59], v23
    v_mfma_f32_32x32x16_bf16 v[68:83], v[52:55], a[32:35], v[68:83]
    s_add_u32 m0, s73, 32768
    ds_read_b64_tr_b16 v[64:65], v14 offset:18432
    ds_read_b64_tr_b16 v[66:67], v14 offset:18944
    buffer_load_dwordx4 v11, s[12:15], s64 offen offset:0 lds
    v_mfma_f32_32x32x16_bf16 v[84:99], v[52:55], a[160:163], v[84:99]
    ds_read_b128 a[44:47], v111 offset:32768
    ds_read_b128 a[172:175], v115 offset:32768
    buffer_load_dwordx4 v12, s[12:15], s64 offen offset:1024 lds
    s_waitcnt lgkmcnt(9)
    v_mfma_f32_32x32x16_bf16 v[68:83], v[56:59], a[36:39], v[68:83]
    s_waitcnt lgkmcnt(8)
    v_mfma_f32_32x32x16_bf16 v[84:99], v[56:59], a[164:167], v[84:99]
    s_add_u32 m0, s72, 16384
    s_nop 0
    buffer_load_dwordx4 v104, s[8:11], s57 offen offset:0 lds
    v_smfmac_f32_16x16x64_bf16 v[156:159], v[24:27], a[32:39], v23
    v_smfmac_f32_16x16x64_bf16 v[160:163], v[24:27], a[160:167], v23
    v_mfma_f32_4x4x4_16b_bf16 v[164:167], a[32:33], a[32:33], v[164:167]
    v_mfma_f32_4x4x4_16b_bf16 v[172:175], a[160:161], a[160:161], v[172:175]
    buffer_load_dwordx4 v105, s[8:11], s57 offen offset:1024 lds
    v_mfma_f32_4x4x4_16b_bf16 v[168:171], a[34:35], a[34:35], v[168:171]
    v_mfma_f32_4x4x4_16b_bf16 v[176:179], a[162:163], a[162:163], v[176:179]
    v_mfma_f32_4x4x4_16b_bf16 v[164:167], a[36:37], a[36:37], v[164:167]
    v_mfma_f32_4x4x4_16b_bf16 v[172:175], a[164:165], a[164:165], v[172:175]
    v_mfma_f32_4x4x4_16b_bf16 v[168:171], a[38:39], a[38:39], v[168:171]
    v_mfma_f32_4x4x4_16b_bf16 v[176:179], a[166:167], a[166:167], v[176:179]
    s_waitcnt lgkmcnt(2)
    v_mfma_f32_32x32x16_bf16 v[68:83], v[60:63], a[40:43], v[68:83]
    s_waitcnt vmcnt(8) lgkmcnt(0)
    s_barrier
    ds_read_b64_tr_b16 v[44:45], v13 offset:24576
    ds_read_b64_tr_b16 v[46:47], v13 offset:25088
    ds_read_b128 a[48:51], v108 offset:49152
    ds_read_b128 a[176:179], v112 offset:49152
    v_mfma_f32_32x32x16_bf16 v[84:99], v[60:63], a[168:171], v[84:99]
    ds_read_b64_tr_b16 v[48:49], v13 offset:26624
    ds_read_b64_tr_b16 v[50:51], v13 offset:27136
    ds_read_b128 a[52:55], v109 offset:49152
    ds_read_b128 a[180:183], v113 offset:49152
    buffer_load_dwordx4 v106, s[8:11], s57 offen offset:2048 lds
    v_mfma_f32_32x32x16_bf16 v[68:83], v[64:67], a[44:47], v[68:83]
    ds_read_b64_tr_b16 v[52:53], v14 offset:24576
    ds_read_b64_tr_b16 v[54:55], v14 offset:25088
    buffer_load_dwordx4 v107, s[8:11], s57 offen offset:3072 lds
    v_mfma_f32_32x32x16_bf16 v[84:99], v[64:67], a[172:175], v[84:99]
    ds_read_b128 a[56:59], v110 offset:49152
    ds_read_b128 a[184:187], v114 offset:49152
    s_waitcnt lgkmcnt(6)
    v_smfmac_f32_16x16x64_bf16 v[40:43], v[24:27], v[44:51], v23
    v_mfma_f32_32x32x16_bf16 v[68:83], v[44:47], a[48:51], v[68:83]
    s_add_u32 m0, s73, 40960
    ds_read_b64_tr_b16 v[56:57], v14 offset:26624
    ds_read_b64_tr_b16 v[58:59], v14 offset:27136
    buffer_load_dwordx4 v11, s[12:15], s65 offen offset:0 lds
    v_mfma_f32_32x32x16_bf16 v[84:99], v[44:47], a[176:179], v[84:99]
    ds_read_b128 a[60:63], v111 offset:49152
    ds_read_b128 a[188:191], v115 offset:49152
    buffer_load_dwordx4 v12, s[12:15], s65 offen offset:1024 lds
    s_waitcnt lgkmcnt(9)
    v_mfma_f32_32x32x16_bf16 v[68:83], v[48:51], a[52:55], v[68:83]
    s_waitcnt lgkmcnt(8)
    v_mfma_f32_32x32x16_bf16 v[84:99], v[48:51], a[180:183], v[84:99]
    s_add_u32 m0, s72, 32768
    s_nop 0
    buffer_load_dwordx4 v104, s[8:11], s58 offen offset:0 lds
    v_smfmac_f32_16x16x64_bf16 v[156:159], v[24:27], a[48:55], v23
    v_smfmac_f32_16x16x64_bf16 v[160:163], v[24:27], a[176:183], v23
    v_mfma_f32_4x4x4_16b_bf16 v[164:167], a[48:49], a[48:49], v[164:167]
    v_mfma_f32_4x4x4_16b_bf16 v[172:175], a[176:177], a[176:177], v[172:175]
    buffer_load_dwordx4 v105, s[8:11], s58 offen offset:1024 lds
    v_mfma_f32_4x4x4_16b_bf16 v[168:171], a[50:51], a[50:51], v[168:171]
    v_mfma_f32_4x4x4_16b_bf16 v[176:179], a[178:179], a[178:179], v[176:179]
    v_mfma_f32_4x4x4_16b_bf16 v[164:167], a[52:53], a[52:53], v[164:167]
    v_mfma_f32_4x4x4_16b_bf16 v[172:175], a[180:181], a[180:181], v[172:175]
    v_mfma_f32_4x4x4_16b_bf16 v[168:171], a[54:55], a[54:55], v[168:171]
    v_mfma_f32_4x4x4_16b_bf16 v[176:179], a[182:183], a[182:183], v[176:179]
    s_waitcnt lgkmcnt(2)
    v_mfma_f32_32x32x16_bf16 v[68:83], v[52:55], a[56:59], v[68:83]
    s_waitcnt vmcnt(8) lgkmcnt(0)
    s_barrier
    ds_read_b64_tr_b16 v[60:61], v13 offset:32768
    ds_read_b64_tr_b16 v[62:63], v13 offset:33280
    ds_read_b128 a[64:67], v108 offset:0
    ds_read_b128 a[192:195], v112 offset:0
    v_mfma_f32_32x32x16_bf16 v[84:99], v[52:55], a[184:187], v[84:99]
    ds_read_b64_tr_b16 v[64:65], v13 offset:34816
    ds_read_b64_tr_b16 v[66:67], v13 offset:35328
    ds_read_b128 a[68:71], v109 offset:0
    ds_read_b128 a[196:199], v113 offset:0
    buffer_load_dwordx4 v106, s[8:11], s58 offen offset:2048 lds
    v_mfma_f32_32x32x16_bf16 v[68:83], v[56:59], a[60:63], v[68:83]
    ds_read_b64_tr_b16 v[44:45], v14 offset:32768
    ds_read_b64_tr_b16 v[46:47], v14 offset:33280
    buffer_load_dwordx4 v107, s[8:11], s58 offen offset:3072 lds
    v_mfma_f32_32x32x16_bf16 v[84:99], v[56:59], a[188:191], v[84:99]
    ds_read_b128 a[72:75], v110 offset:0
    ds_read_b128 a[200:203], v114 offset:0
    s_waitcnt lgkmcnt(6)
    v_smfmac_f32_16x16x64_bf16 v[40:43], v[24:27], v[60:67], v23
    v_mfma_f32_32x32x16_bf16 v[68:83], v[60:63], a[64:67], v[68:83]
    s_add_u32 m0, s73, 49152
    ds_read_b64_tr_b16 v[48:49], v14 offset:34816
    ds_read_b64_tr_b16 v[50:51], v14 offset:35328
    buffer_load_dwordx4 v11, s[12:15], s66 offen offset:0 lds
    v_mfma_f32_32x32x16_bf16 v[84:99], v[60:63], a[192:195], v[84:99]
    ds_read_b128 a[76:79], v111 offset:0
    ds_read_b128 a[204:207], v115 offset:0
    buffer_load_dwordx4 v12, s[12:15], s66 offen offset:1024 lds
    s_waitcnt lgkmcnt(9)
    v_mfma_f32_32x32x16_bf16 v[68:83], v[64:67], a[68:71], v[68:83]
    s_waitcnt lgkmcnt(8)
    v_mfma_f32_32x32x16_bf16 v[84:99], v[64:67], a[196:199], v[84:99]
    s_add_u32 m0, s72, 49152
    s_nop 0
    buffer_load_dwordx4 v104, s[8:11], s59 offen offset:0 lds
    v_smfmac_f32_16x16x64_bf16 v[156:159], v[24:27], a[64:71], v23
    v_smfmac_f32_16x16x64_bf16 v[160:163], v[24:27], a[192:199], v23
    v_mfma_f32_4x4x4_16b_bf16 v[164:167], a[64:65], a[64:65], v[164:167]
    v_mfma_f32_4x4x4_16b_bf16 v[172:175], a[192:193], a[192:193], v[172:175]
    buffer_load_dwordx4 v105, s[8:11], s59 offen offset:1024 lds
    v_mfma_f32_4x4x4_16b_bf16 v[168:171], a[66:67], a[66:67], v[168:171]
    v_mfma_f32_4x4x4_16b_bf16 v[176:179], a[194:195], a[194:195], v[176:179]
    v_mfma_f32_4x4x4_16b_bf16 v[164:167], a[68:69], a[68:69], v[164:167]
    v_mfma_f32_4x4x4_16b_bf16 v[172:175], a[196:197], a[196:197], v[172:175]
    v_mfma_f32_4x4x4_16b_bf16 v[168:171], a[70:71], a[70:71], v[168:171]
    v_mfma_f32_4x4x4_16b_bf16 v[176:179], a[198:199], a[198:199], v[176:179]
    s_waitcnt lgkmcnt(2)
    v_mfma_f32_32x32x16_bf16 v[68:83], v[44:47], a[72:75], v[68:83]
    s_waitcnt vmcnt(8) lgkmcnt(0)
    s_barrier
    ds_read_b64_tr_b16 v[52:53], v13 offset:40960
    ds_read_b64_tr_b16 v[54:55], v13 offset:41472
    ds_read_b128 a[80:83], v108 offset:16384
    ds_read_b128 a[208:211], v112 offset:16384
    v_mfma_f32_32x32x16_bf16 v[84:99], v[44:47], a[200:203], v[84:99]
    ds_read_b64_tr_b16 v[56:57], v13 offset:43008
    ds_read_b64_tr_b16 v[58:59], v13 offset:43520
    ds_read_b128 a[84:87], v109 offset:16384
    ds_read_b128 a[212:215], v113 offset:16384
    buffer_load_dwordx4 v106, s[8:11], s59 offen offset:2048 lds
    v_mfma_f32_32x32x16_bf16 v[68:83], v[48:51], a[76:79], v[68:83]
    ds_read_b64_tr_b16 v[60:61], v14 offset:40960
    ds_read_b64_tr_b16 v[62:63], v14 offset:41472
    buffer_load_dwordx4 v107, s[8:11], s59 offen offset:3072 lds
    v_mfma_f32_32x32x16_bf16 v[84:99], v[48:51], a[204:207], v[84:99]
    ds_read_b128 a[88:91], v110 offset:16384
    ds_read_b128 a[216:219], v114 offset:16384
    s_add_u32 m0, s73, 57344
    s_nop 0
    buffer_load_dwordx4 v11, s[12:15], s67 offen offset:0 lds
    v_lshlrev_b32 v2, 4, v2
    s_mul_i32 s77, s4, 57344
    s_add_u32 s77, s77, s91
    v_mul_u32_u24 v134, 3584, v1
    v_add3_u32 v134, v134, v2, s77
    s_mov_b32 s40, s16
    s_mov_b32 s41, s17
    v_add_u32 v16, 7168, v15
    v_add_u32 v17, 14336, v15
    v_add_u32 v18, 21504, v15
    s_mul_i32 s77, s4, 37
    s_add_u32 s77, s77, -4
    buffer_load_dwordx4 v12, s[12:15], s67 offen offset:1024 lds
    v_add_u32 v11, s0, v11
    v_add_u32 v12, s0, v12
    s_cmp_eq_u32 s4, 1
    s_cselect_b32 s77, 32, s77
    s_cselect_b32 s82, 38, 37
    s_cmp_eq_u32 s4, 0
    s_cselect_b32 s77, 0, s77
    s_cselect_b32 s82, 32, s82
    s_cselect_b32 s20, s80, s20
    s_cselect_b32 s21, s81, s21
    s_cselect_b32 s3, 0, 32
    s_sub_u32 s3, s77, s3
    s_lshl_b32 s3, s3, 14
    s_add_u32 s20, s20, s3
    s_addc_u32 s21, s21, 0
    s_add_u32 m0, s73, 0
    s_nop 0
    buffer_load_dwordx4 v11, s[12:15], s60 offen offset:0 lds
    s_lshl_b32 s22, s82, 14
    s_lshl_b32 s86, s82, 11
    s_mul_i32 s3, s70, 299008
    s_lshl_b32 s77, s77, 11
    s_add_u32 s3, s3, s77
    s_add_u32 s84, s16, s3
    s_addc_u32 s85, s17, 0
    s_lshl_b32 s90, s4, 12
    s_add_u32 s82, s82, 1
    s_lshr_b32 s82, s82, 1
    s_and_b32 s3, s70, 3
    s_mul_i32 s3, s3, s82
    buffer_load_dwordx4 v12, s[12:15], s60 offen offset:1024 lds
    s_add_u32 s3, s3, 3
    s_lshr_b32 s3, s3, 2
    s_add_u32 s3, s3, 4
    s_cmp_ge_u32 s3, s82
    s_cselect_b32 s77, s82, 0
    s_sub_u32 s3, s3, s77
    s_lshl_b32 s88, s3, 15
    s_lshl_b32 s89, s3, 12
    s_lshl_b32 s78, s82, 15
    s_lshl_b32 s79, s82, 12
    v_bfe_u32 v1, v0, 2, 3
    v_and_b32 v2, 32, v0
    v_lshlrev_b32 v2, 6, v2
    v_lshl_add_u32 v2, v1, 7, v2
    v_and_b32 v1, 24, v0
    v_lshl_add_u32 v2, v1, 2, v2
    s_add_u32 m0, s73, 8192
    s_nop 0
    buffer_load_dwordx4 v11, s[12:15], s61 offen offset:0 lds
    v_and_b32 v1, 3, v0
    v_lshl_add_u32 v2, v1, 3, v2
    v_add_u32 v21, s72, v2
    v_xor_b32 v22, 40, v21
    s_add_u32 s77, s90, 131072
    v_lshl_add_u32 v133, v0, 2, s77
    v_xor_b32 v132, 4096, v133
    v_and_b32 v1, 31, v0
    v_lshlrev_b32 v1, 1, v1
    s_lshl_b32 s77, s69, 6
    s_add_u32 s77, s77, s99
    buffer_load_ushort v137, v1, s[32:35], s77 offen
    s_add_u32 s82, s77, s0
    buffer_load_ushort v138, v1, s[32:35], s82 offen
    s_add_u32 s82, s82, s1
    buffer_load_ushort v139, v1, s[32:35], s82 offen
    buffer_load_ushort v140, v1, s[32:35], s91 offen
    s_lshl_b32 s77, s77, 6
    s_lshl_b32 s82, s68, 10
    s_add_u32 s82, s82, 65536
    s_lshl_b32 s3, s5, 1
    buffer_load_dwordx4 v12, s[12:15], s61 offen offset:1024 lds
    s_add_u32 s3, s3, s69
    s_mul_i32 s75, s3, 299008
    s_xor_b32 s3, s3, 1
    s_mul_i32 s76, s3, 299008
    s_add_u32 s75, s75, s82
    s_add_u32 s76, s76, s82
    s_lshl_b32 s91, s91, 6
    s_add_u32 s91, s91, s75
    s_add_u32 s75, s75, s77
    s_add_u32 s76, s76, s77
    s_lshl_b32 s83, s5, 4
    s_add_u32 s83, s83, s6
    v_add_u32 v141, s74, v8
    v_add_u32 v141, 151552, v141
    s_waitcnt lgkmcnt(6)
    v_smfmac_f32_16x16x64_bf16 v[40:43], v[24:27], v[52:59], v23
    s_add_u32 m0, s73, 16384
    s_nop 0
    buffer_load_dwordx4 v11, s[12:15], s62 offen offset:0 lds
    v_mfma_f32_32x32x16_bf16 v[68:83], v[52:55], a[80:83], v[68:83]
    ds_read_b64_tr_b16 v[64:65], v14 offset:43008
    ds_read_b64_tr_b16 v[66:67], v14 offset:43520
    v_mfma_f32_32x32x16_bf16 v[84:99], v[52:55], a[208:211], v[84:99]
    ds_read_b128 a[92:95], v111 offset:16384
    ds_read_b128 a[220:223], v115 offset:16384
    s_waitcnt lgkmcnt(9)
    v_mfma_f32_32x32x16_bf16 v[68:83], v[56:59], a[84:87], v[68:83]
    s_waitcnt lgkmcnt(8)
    v_mfma_f32_32x32x16_bf16 v[84:99], v[56:59], a[212:215], v[84:99]
    v_smfmac_f32_16x16x64_bf16 v[156:159], v[24:27], a[80:87], v23
    buffer_load_dwordx4 v12, s[12:15], s62 offen offset:1024 lds
    v_smfmac_f32_16x16x64_bf16 v[160:163], v[24:27], a[208:215], v23
    v_mfma_f32_4x4x4_16b_bf16 v[164:167], a[80:81], a[80:81], v[164:167]
    v_mfma_f32_4x4x4_16b_bf16 v[172:175], a[208:209], a[208:209], v[172:175]
    v_mfma_f32_4x4x4_16b_bf16 v[168:171], a[82:83], a[82:83], v[168:171]
    v_mfma_f32_4x4x4_16b_bf16 v[176:179], a[210:211], a[210:211], v[176:179]
    v_mfma_f32_4x4x4_16b_bf16 v[164:167], a[84:85], a[84:85], v[164:167]
    v_mfma_f32_4x4x4_16b_bf16 v[172:175], a[212:213], a[212:213], v[172:175]
    v_mfma_f32_4x4x4_16b_bf16 v[168:171], a[86:87], a[86:87], v[168:171]
    v_mfma_f32_4x4x4_16b_bf16 v[176:179], a[214:215], a[214:215], v[176:179]
    s_waitcnt lgkmcnt(2)
    v_mfma_f32_32x32x16_bf16 v[68:83], v[60:63], a[88:91], v[68:83]
    s_waitcnt vmcnt(16) lgkmcnt(0)
    s_barrier
    ds_read_b64_tr_b16 v[44:45], v13 offset:49152
    ds_read_b64_tr_b16 v[46:47], v13 offset:49664
    ds_read_b128 a[96:99], v108 offset:32768
    ds_read_b128 a[224:227], v112 offset:32768
    v_mfma_f32_32x32x16_bf16 v[84:99], v[60:63], a[216:219], v[84:99]
    s_add_u32 m0, s73, 24576
    ds_read_b64_tr_b16 v[48:49], v13 offset:51200
    ds_read_b64_tr_b16 v[50:51], v13 offset:51712
    ds_read_b128 a[100:103], v109 offset:32768
    ds_read_b128 a[228:231], v113 offset:32768
    buffer_load_dwordx4 v11, s[12:15], s63 offen offset:0 lds
    v_mfma_f32_32x32x16_bf16 v[68:83], v[64:67], a[92:95], v[68:83]
    ds_read_b64_tr_b16 v[52:53], v14 offset:49152
    ds_read_b64_tr_b16 v[54:55], v14 offset:49664
    v_mfma_f32_32x32x16_bf16 v[84:99], v[64:67], a[220:223], v[84:99]
    ds_read_b128 a[104:107], v110 offset:32768
    ds_read_b128 a[232:235], v114 offset:32768
    s_waitcnt lgkmcnt(6)
    v_smfmac_f32_16x16x64_bf16 v[40:43], v[24:27], v[44:51], v23
    buffer_load_dwordx4 v12, s[12:15], s63 offen offset:1024 lds
    v_mfma_f32_32x32x16_bf16 v[68:83], v[44:47], a[96:99], v[68:83]
    ds_read_b64_tr_b16 v[56:57], v14 offset:51200
    ds_read_b64_tr_b16 v[58:59], v14 offset:51712
    v_mfma_f32_32x32x16_bf16 v[84:99], v[44:47], a[224:227], v[84:99]
    ds_read_b128 a[108:111], v111 offset:32768
    ds_read_b128 a[236:239], v115 offset:32768
    s_waitcnt lgkmcnt(9)
    v_mfma_f32_32x32x16_bf16 v[68:83], v[48:51], a[100:103], v[68:83]
    s_waitcnt lgkmcnt(8)
    v_mfma_f32_32x32x16_bf16 v[84:99], v[48:51], a[228:231], v[84:99]
    v_smfmac_f32_16x16x64_bf16 v[156:159], v[24:27], a[96:103], v23
    s_add_u32 m0, s73, 32768
    s_nop 0
    buffer_load_dwordx4 v11, s[12:15], s64 offen offset:0 lds
    v_smfmac_f32_16x16x64_bf16 v[160:163], v[24:27], a[224:231], v23
    v_mfma_f32_4x4x4_16b_bf16 v[164:167], a[96:97], a[96:97], v[164:167]
    v_mfma_f32_4x4x4_16b_bf16 v[172:175], a[224:225], a[224:225], v[172:175]
    v_mfma_f32_4x4x4_16b_bf16 v[168:171], a[98:99], a[98:99], v[168:171]
    v_mfma_f32_4x4x4_16b_bf16 v[176:179], a[226:227], a[226:227], v[176:179]
    v_mfma_f32_4x4x4_16b_bf16 v[164:167], a[100:101], a[100:101], v[164:167]
    v_mfma_f32_4x4x4_16b_bf16 v[172:175], a[228:229], a[228:229], v[172:175]
    v_mfma_f32_4x4x4_16b_bf16 v[168:171], a[102:103], a[102:103], v[168:171]
    v_mfma_f32_4x4x4_16b_bf16 v[176:179], a[230:231], a[230:231], v[176:179]
    s_waitcnt lgkmcnt(2)
    v_mfma_f32_32x32x16_bf16 v[68:83], v[52:55], a[104:107], v[68:83]
    s_waitcnt vmcnt(13) lgkmcnt(0)
    s_barrier
    ds_read_b64_tr_b16 v[60:61], v13 offset:57344
    ds_read_b64_tr_b16 v[62:63], v13 offset:57856
    ds_read_b128 a[112:115], v108 offset:49152
    ds_read_b128 a[240:243], v112 offset:49152
    buffer_load_dwordx4 v12, s[12:15], s64 offen offset:1024 lds
    v_mfma_f32_32x32x16_bf16 v[84:99], v[52:55], a[232:235], v[84:99]
    ds_read_b64_tr_b16 v[64:65], v13 offset:59392
    ds_read_b64_tr_b16 v[66:67], v13 offset:59904
    ds_read_b128 a[116:119], v109 offset:49152
    ds_read_b128 a[244:247], v113 offset:49152
    v_mfma_f32_32x32x16_bf16 v[68:83], v[56:59], a[108:111], v[68:83]
    ds_read_b64_tr_b16 v[44:45], v14 offset:57344
    ds_read_b64_tr_b16 v[46:47], v14 offset:57856
    v_mfma_f32_32x32x16_bf16 v[84:99], v[56:59], a[236:239], v[84:99]
    ds_read_b128 a[120:123], v110 offset:49152
    ds_read_b128 a[248:251], v114 offset:49152
    s_waitcnt lgkmcnt(6)
    v_smfmac_f32_16x16x64_bf16 v[40:43], v[24:27], v[60:67], v23
    s_add_u32 m0, s73, 40960
    s_nop 0
    buffer_load_dwordx4 v11, s[12:15], s65 offen offset:0 lds
    v_mfma_f32_32x32x16_bf16 v[68:83], v[60:63], a[112:115], v[68:83]
    ds_read_b64_tr_b16 v[48:49], v14 offset:59392
    ds_read_b64_tr_b16 v[50:51], v14 offset:59904
    v_and_b32 v3, 1, v0
    v_mfma_f32_32x32x16_bf16 v[84:99], v[60:63], a[240:243], v[84:99]
    ds_read_b128 a[124:127], v111 offset:49152
    ds_read_b128 a[252:255], v115 offset:49152
    v_add_f32 v1, v40, v41
    s_waitcnt lgkmcnt(9)
    v_mfma_f32_32x32x16_bf16 v[68:83], v[64:67], a[116:119], v[68:83]
    v_mov_b32 v40, 0
    v_cmp_eq_u32 vcc, 1, v3
    s_waitcnt lgkmcnt(8)
    v_mfma_f32_32x32x16_bf16 v[84:99], v[64:67], a[244:247], v[84:99]
    v_mov_b32 v41, 0
    ds_write_b32 v132, v1
    v_and_b32 v3, 2, v0
    v_smfmac_f32_16x16x64_bf16 v[156:159], v[24:27], a[112:119], v23
    buffer_load_dwordx4 v12, s[12:15], s65 offen offset:1024 lds
    v_smfmac_f32_16x16x64_bf16 v[160:163], v[24:27], a[240:247], v23
    v_cmp_eq_u32 s[92:93], 2, v3
    v_mfma_f32_4x4x4_16b_bf16 v[164:167], a[112:113], a[112:113], v[164:167]
    v_mfma_f32_4x4x4_16b_bf16 v[172:175], a[240:241], a[240:241], v[172:175]
    v_mfma_f32_4x4x4_16b_bf16 v[168:171], a[114:115], a[114:115], v[168:171]
    v_mfma_f32_4x4x4_16b_bf16 v[176:179], a[242:243], a[242:243], v[176:179]
    v_mfma_f32_4x4x4_16b_bf16 v[164:167], a[116:117], a[116:117], v[164:167]
    v_mfma_f32_4x4x4_16b_bf16 v[172:175], a[244:245], a[244:245], v[172:175]
    v_mfma_f32_4x4x4_16b_bf16 v[168:171], a[118:119], a[118:119], v[168:171]
    v_mfma_f32_4x4x4_16b_bf16 v[176:179], a[246:247], a[246:247], v[176:179]
    s_waitcnt lgkmcnt(3)
    v_mfma_f32_32x32x16_bf16 v[68:83], v[44:47], a[120:123], v[68:83]
    s_waitcnt vmcnt(14) lgkmcnt(0)
    s_barrier
    ds_read_b64_tr_b16 v[52:53], v13 offset:0
    ds_read_b64_tr_b16 v[54:55], v13 offset:512
    v_add_f32 v196, v156, v157
    v_add_f32 v164, v164, v168
    v_mfma_f32_32x32x16_bf16 v[84:99], v[44:47], a[248:251], v[84:99]
    s_add_u32 m0, s73, 49152
    ds_read_b64_tr_b16 v[56:57], v13 offset:2048
    ds_read_b64_tr_b16 v[58:59], v13 offset:2560
    buffer_load_dwordx4 v11, s[12:15], s66 offen offset:0 lds
    v_add_f32 v165, v165, v169
    v_add_f32 v166, v166, v170
    v_add_f32 v167, v167, v171
    v_mfma_f32_32x32x16_bf16 v[68:83], v[48:51], a[124:127], v[68:83]
    ds_read_b64_tr_b16 v[60:61], v14 offset:0
    ds_read_b32 v2, v133
    v_cndmask_b32 v164, v164, v165, vcc
    v_cndmask_b32 v166, v166, v167, vcc
    v_cndmask_b32 v164, v164, v166, s[92:93]
    v_mov_b32 v165, v164
    v_add_f32 v198, v160, v161
    v_add_f32 v172, v172, v176
    v_add_f32 v173, v173, v177
    v_mfma_f32_32x32x16_bf16 v[84:99], v[48:51], a[252:255], v[84:99]
    ds_read_b64_tr_b16 v[62:63], v14 offset:512
    v_add_f32 v174, v174, v178
    v_add_f32 v175, v175, v179
    v_cndmask_b32 v172, v172, v173, vcc
    v_cndmask_b32 v174, v174, v175, vcc
    v_cndmask_b32 v172, v172, v174, s[92:93]
    v_mov_b32 v173, v172
    v_permlane32_swap_b32 v164, v165
    s_waitcnt lgkmcnt(3)
    v_smfmac_f32_16x16x64_bf16 v[40:43], v[24:27], v[52:59], v23
    v_permlane32_swap_b32 v172, v173
    v_add_f32 v197, v164, v165
    v_add_f32 v199, v172, v173
    v_mfma_f32_32x32x16_bf16 v[100:115], v[52:55], a[0:3], 0
    ds_read_b64_tr_b16 v[64:65], v14 offset:2048
    buffer_load_dwordx4 v12, s[12:15], s66 offen offset:1024 lds
    ds_write_b128 v141, v[196:199]
    v_xor_b32 v141, 2048, v141
    v_mfma_f32_32x32x16_bf16 v[116:131], v[52:55], a[128:131], 0
    ds_read_b64_tr_b16 v[66:67], v14 offset:2560
    v_mfma_f32_32x32x16_bf16 v[100:115], v[56:59], a[4:7], v[100:115]
    s_waitcnt vmcnt(10) lgkmcnt(1)
    s_barrier
    ds_read_b128 v[200:203], v141
    v_cmp_gt_u32 vcc, 32, v0
    v_mfma_f32_32x32x16_bf16 v[116:131], v[56:59], a[132:135], v[116:131]
    ds_read_b64_tr_b16 v[44:45], v13 offset:8192
    ds_read_b64_tr_b16 v[46:47], v13 offset:8704
    v_add_f32 v1, v1, v2
    v_and_b32 v2, 0xffff0000, v1
    v_sub_f32 v1, v1, v2
    v_cvt_pk_bf16_f32 v36, v2, v1
    v_mov_b32 v37, v137
    s_waitcnt lgkmcnt(3)
    v_mfma_f32_32x32x16_bf16 v[100:115], v[60:63], a[8:11], v[100:115]
    ds_read_b64_tr_b16 v[48:49], v13 offset:10240
    s_waitcnt lgkmcnt(3)
    v_add_f32 v196, v196, v202
    v_add_f32 v197, v197, v203
    v_add_f32 v198, v198, v200
    v_add_f32 v199, v199, v201
    v_mul_f32 v196, 0x3b000000, v196
    v_mul_f32 v198, 0x3b000000, v198
    v_mfma_f32_32x32x16_bf16 v[116:131], v[60:63], a[136:139], v[116:131]
    ds_read_b64_tr_b16 v[50:51], v13 offset:10752
    v_mul_f32 v197, 0x3b000000, v197
    v_mul_f32 v199, 0x3b000000, v199
    v_fma_f32 v197, -v196, v196, v197
    v_fma_f32 v199, -v198, v198, v199
    v_max_f32 v197, 0, v197
    v_max_f32 v199, 0, v199
    v_cvt_pk_bf16_f32 v28, -v196, -v196
    v_mfma_f32_32x32x16_bf16 v[100:115], v[64:67], a[12:15], v[100:115]
    ds_read_b64_tr_b16 v[52:53], v14 offset:8192
    v_cvt_pk_bf16_f32 v32, -v198, -v198
    v_cvt_pk_bf16_f32 v200, v197, v197
    v_cvt_pk_bf16_f32 v201, v199, v199
    v_and_b32 v200, 0xffff0000, v200
    v_and_b32 v201, 0xffff0000, v201
    v_add_f32 v200, 0x3727c5ac, v200
    v_add_f32 v201, 0x3727c5ac, v201
    v_mfma_f32_32x32x16_bf16 v[116:131], v[64:67], a[140:143], v[116:131]
    ds_read_b64_tr_b16 v[54:55], v14 offset:8704
    v_cvt_pk_bf16_f32 v200, v200, v200
    v_cvt_pk_bf16_f32 v201, v201, v201
    v_and_b32 v200, 0xffff0000, v200
    v_and_b32 v201, 0xffff0000, v201
    v_sqrt_f32 v200, v200
    s_waitcnt lgkmcnt(2)
    v_smfmac_f32_16x16x64_bf16 v[40:43], v[24:27], v[44:51], v23
    v_sqrt_f32 v201, v201
    v_mfma_f32_32x32x16_bf16 v[100:115], v[44:47], a[16:19], v[100:115]
    ds_read_b64_tr_b16 v[56:57], v14 offset:10240
    v_cvt_pk_bf16_f32 v29, v200, 0
    v_cvt_pk_bf16_f32 v33, v201, 0
    v_lshlrev_b32 v150, 16, v29
    v_lshlrev_b32 v152, 16, v33
    v_rcp_f32 v154, v150
    v_mfma_f32_32x32x16_bf16 v[116:131], v[44:47], a[144:147], v[116:131]
    ds_read_b64_tr_b16 v[58:59], v14 offset:10752
    v_rcp_f32 v155, v152
    v_cndmask_b32 v28, 0, v28, vcc
    v_cndmask_b32 v29, 0, v29, vcc
    v_cndmask_b32 v32, 0, v32, vcc
    v_cndmask_b32 v33, 0, v33, vcc
    v_mfma_f32_32x32x16_bf16 v[68:83], v[36:39], v[28:31], v[68:83]
    v_mul_f32 v142, 0xc0135761, v154
    v_mul_f32 v154, v154, v154
    v_mul_f32 v146, 0x3d372713, v142
    v_mul_f32 v146, v146, v154
    v_mfma_f32_32x32x16_bf16 v[84:99], v[36:39], v[32:35], v[84:99]
    v_mul_f32 v144, 0xc0135761, v155
    v_mul_f32 v155, v155, v155
    v_mul_f32 v148, 0x3d372713, v144
    v_mul_f32 v148, v148, v155
    v_mfma_f32_32x32x16_bf16 v[100:115], v[48:51], a[20:23], v[100:115]
    s_waitcnt vmcnt(6)
    s_barrier
    v_mul_f32 v180, v68, v68
    v_mfma_f32_32x32x16_bf16 v[116:131], v[48:51], a[148:151], v[116:131]
    s_add_u32 m0, s73, 57344
    ds_read_b64_tr_b16 v[60:61], v13 offset:16384
    ds_read_b64_tr_b16 v[62:63], v13 offset:16896
    buffer_load_dwordx4 v11, s[12:15], s67 offen offset:0 lds
    v_mul_f32 v181, v69, v69
    s_waitcnt lgkmcnt(2)
    v_mfma_f32_32x32x16_bf16 v[100:115], v[52:55], a[24:27], v[100:115]
    ds_read_b64_tr_b16 v[64:65], v13 offset:18432
    v_mul_f32 v182, v70, v70
    v_mul_f32 v183, v71, v71
    v_fma_f32 v180, v180, v146, v142
    v_fma_f32 v181, v181, v146, v142
    v_fma_f32 v182, v182, v146, v142
    v_fma_f32 v183, v183, v146, v142
    v_mfma_f32_32x32x16_bf16 v[116:131], v[52:55], a[152:155], v[116:131]
    ds_read_b64_tr_b16 v[66:67], v13 offset:18944
    v_mul_f32 v180, v180, v68
    v_mul_f32 v181, v181, v69
    v_mul_f32 v182, v182, v70
    v_mul_f32 v183, v183, v71
    v_exp_f32 v180, v180
    v_mfma_f32_32x32x16_bf16 v[100:115], v[56:59], a[28:31], v[100:115]
    ds_read_b64_tr_b16 v[44:45], v14 offset:16384
    buffer_load_dwordx4 v12, s[12:15], s67 offen offset:1024 lds
    v_mul_f32 v184, v72, v72
    v_exp_f32 v181, v181
    v_mul_f32 v185, v73, v73
    v_mfma_f32_32x32x16_bf16 v[116:131], v[56:59], a[156:159], v[116:131]
    ds_read_b64_tr_b16 v[46:47], v14 offset:16896
    v_exp_f32 v182, v182
    v_mul_f32 v186, v74, v74
    v_exp_f32 v183, v183
    s_waitcnt lgkmcnt(2)
    v_smfmac_f32_16x16x64_bf16 v[40:43], v[24:27], v[60:67], v23
    v_mul_f32 v187, v75, v75
    v_mfma_f32_32x32x16_bf16 v[100:115], v[60:63], a[32:35], v[100:115]
    ds_read_b64_tr_b16 v[48:49], v14 offset:18432
    v_add_u32 v11, s1, v11
    v_add_u32 v12, s1, v12
    v_fma_f32 v180, v180, v150, v150
    v_fma_f32 v184, v184, v146, v142
    v_fma_f32 v181, v181, v150, v150
    v_fma_f32 v185, v185, v146, v142
    v_mfma_f32_32x32x16_bf16 v[116:131], v[60:63], a[160:163], v[116:131]
    s_add_u32 m0, s73, 0
    ds_read_b64_tr_b16 v[50:51], v14 offset:18944
    buffer_load_dwordx4 v11, s[12:15], s60 offen offset:0 lds
    v_fma_f32 v182, v182, v150, v150
    v_fma_f32 v186, v186, v146, v142
    v_fma_f32 v183, v183, v150, v150
    v_mfma_f32_32x32x16_bf16 v[100:115], v[64:67], a[36:39], v[100:115]
    ds_read_b64_tr_b16 v[52:53], v13 offset:24576
    v_fma_f32 v187, v187, v146, v142
    v_rcp_f32 v180, v180
    v_mul_f32 v184, v184, v72
    v_rcp_f32 v181, v181
    v_mfma_f32_32x32x16_bf16 v[116:131], v[64:67], a[164:167], v[116:131]
    ds_read_b64_tr_b16 v[54:55], v13 offset:25088
    v_mul_f32 v185, v185, v73
    v_rcp_f32 v182, v182
    v_mul_f32 v186, v186, v74
    s_waitcnt lgkmcnt(2)
    v_mfma_f32_32x32x16_bf16 v[100:115], v[44:47], a[40:43], v[100:115]
    ds_read_b64_tr_b16 v[56:57], v13 offset:26624
    v_rcp_f32 v183, v183
    v_mul_f32 v187, v187, v75
    v_mul_f32 v180, v180, v68
    v_exp_f32 v184, v184
    v_mfma_f32_32x32x16_bf16 v[116:131], v[44:47], a[168:171], v[116:131]
    ds_read_b64_tr_b16 v[58:59], v13 offset:27136
    buffer_load_dwordx4 v12, s[12:15], s60 offen offset:1024 lds
    v_mul_f32 v181, v181, v69
    v_exp_f32 v185, v185
    v_mfma_f32_32x32x16_bf16 v[100:115], v[48:51], a[44:47], v[100:115]
    ds_read_b64_tr_b16 v[60:61], v14 offset:24576
    v_mul_f32 v182, v182, v70
    v_exp_f32 v186, v186
    v_mul_f32 v183, v183, v71
    v_exp_f32 v187, v187
    v_mfma_f32_32x32x16_bf16 v[116:131], v[48:51], a[172:175], v[116:131]
    ds_read_b64_tr_b16 v[62:63], v14 offset:25088
    v_cvt_pk_bf16_f32 v188, v180, v181
    v_fma_f32 v184, v184, v150, v150
    v_cvt_pk_bf16_f32 v189, v182, v183
    v_fma_f32 v185, v185, v150, v150
    s_waitcnt lgkmcnt(2)
    v_smfmac_f32_16x16x64_bf16 v[40:43], v[24:27], v[52:59], v23
    v_fma_f32 v186, v186, v150, v150
    v_fma_f32 v187, v187, v150, v150
    v_mfma_f32_32x32x16_bf16 v[100:115], v[52:55], a[48:51], v[100:115]
    ds_read_b64_tr_b16 v[64:65], v14 offset:26624
    v_rcp_f32 v184, v184
    v_rcp_f32 v185, v185
    v_rcp_f32 v186, v186
    v_mfma_f32_32x32x16_bf16 v[116:131], v[52:55], a[176:179], v[116:131]
    ds_read_b64_tr_b16 v[66:67], v14 offset:27136
    v_rcp_f32 v187, v187
    v_mul_f32 v184, v184, v72
    v_mul_f32 v185, v185, v73
    v_mul_f32 v186, v186, v74
    v_mul_f32 v187, v187, v75
    v_mfma_f32_32x32x16_bf16 v[100:115], v[56:59], a[52:55], v[100:115]
    s_waitcnt vmcnt(6)
    s_barrier
    v_cvt_pk_bf16_f32 v190, v184, v185
    v_mfma_f32_32x32x16_bf16 v[116:131], v[56:59], a[180:183], v[116:131]
    s_add_u32 m0, s73, 8192
    ds_read_b64_tr_b16 v[44:45], v13 offset:32768
    ds_read_b64_tr_b16 v[46:47], v13 offset:33280
    buffer_load_dwordx4 v11, s[12:15], s61 offen offset:0 lds
    v_cvt_pk_bf16_f32 v191, v186, v187
    s_waitcnt lgkmcnt(2)
    v_mfma_f32_32x32x16_bf16 v[100:115], v[60:63], a[56:59], v[100:115]
    ds_read_b64_tr_b16 v[48:49], v13 offset:34816
    buffer_store_dwordx4 v[188:191], v8, s[16:19], s75 offen offset:0 sc1
    v_mul_f32 v180, v76, v76
    v_mul_f32 v181, v77, v77
    v_mul_f32 v182, v78, v78
    v_mfma_f32_32x32x16_bf16 v[116:131], v[60:63], a[184:187], v[116:131]
    ds_read_b64_tr_b16 v[50:51], v13 offset:35328
    v_mul_f32 v183, v79, v79
    v_fma_f32 v180, v180, v146, v142
    v_fma_f32 v181, v181, v146, v142
    v_fma_f32 v182, v182, v146, v142
    v_fma_f32 v183, v183, v146, v142
    v_mfma_f32_32x32x16_bf16 v[100:115], v[64:67], a[60:63], v[100:115]
    ds_read_b64_tr_b16 v[52:53], v14 offset:32768
    buffer_load_dwordx4 v12, s[12:15], s61 offen offset:1024 lds
    v_mul_f32 v180, v180, v76
    v_mul_f32 v181, v181, v77
    v_mul_f32 v182, v182, v78
    v_mfma_f32_32x32x16_bf16 v[116:131], v[64:67], a[188:191], v[116:131]
    ds_read_b64_tr_b16 v[54:55], v14 offset:33280
    v_mul_f32 v183, v183, v79
    v_exp_f32 v180, v180
    v_mul_f32 v184, v80, v80
    s_waitcnt lgkmcnt(2)
    v_smfmac_f32_16x16x64_bf16 v[40:43], v[24:27], v[44:51], v23
    v_exp_f32 v181, v181
    v_mfma_f32_32x32x16_bf16 v[100:115], v[44:47], a[64:67], v[100:115]
    ds_read_b64_tr_b16 v[56:57], v14 offset:34816
    v_mul_f32 v185, v81, v81
    v_exp_f32 v182, v182
    v_mul_f32 v186, v82, v82
    v_exp_f32 v183, v183
    v_mfma_f32_32x32x16_bf16 v[116:131], v[44:47], a[192:195], v[116:131]
    s_add_u32 m0, s73, 16384
    ds_read_b64_tr_b16 v[58:59], v14 offset:35328
    buffer_load_dwordx4 v11, s[12:15], s62 offen offset:0 lds
    v_mul_f32 v187, v83, v83
    v_fma_f32 v180, v180, v150, v150
    v_fma_f32 v184, v184, v146, v142
    v_mfma_f32_32x32x16_bf16 v[100:115], v[48:51], a[68:71], v[100:115]
    ds_read_b64_tr_b16 v[60:61], v13 offset:40960
    v_fma_f32 v181, v181, v150, v150
    v_fma_f32 v185, v185, v146, v142
    v_fma_f32 v182, v182, v150, v150
    v_fma_f32 v186, v186, v146, v142
    v_fma_f32 v183, v183, v150, v150
    v_fma_f32 v187, v187, v146, v142
    v_mfma_f32_32x32x16_bf16 v[116:131], v[48:51], a[196:199], v[116:131]
    ds_read_b64_tr_b16 v[62:63], v13 offset:41472
    v_rcp_f32 v180, v180
    v_mul_f32 v184, v184, v80
    v_rcp_f32 v181, v181
    s_waitcnt lgkmcnt(2)
    v_mfma_f32_32x32x16_bf16 v[100:115], v[52:55], a[72:75], v[100:115]
    ds_read_b64_tr_b16 v[64:65], v13 offset:43008
    v_mul_f32 v185, v185, v81
    v_rcp_f32 v182, v182
    v_mul_f32 v186, v186, v82
    v_rcp_f32 v183, v183
    v_mfma_f32_32x32x16_bf16 v[116:131], v[52:55], a[200:203], v[116:131]
    ds_read_b64_tr_b16 v[66:67], v13 offset:43520
    buffer_load_dwordx4 v12, s[12:15], s62 offen offset:1024 lds
    v_mul_f32 v187, v187, v83
    v_mul_f32 v180, v180, v76
    v_exp_f32 v184, v184
    v_mfma_f32_32x32x16_bf16 v[100:115], v[56:59], a[76:79], v[100:115]
    ds_read_b64_tr_b16 v[44:45], v14 offset:40960
    v_mul_f32 v181, v181, v77
    v_exp_f32 v185, v185
    v_mul_f32 v182, v182, v78
    v_exp_f32 v186, v186
    v_mfma_f32_32x32x16_bf16 v[116:131], v[56:59], a[204:207], v[116:131]
    ds_read_b64_tr_b16 v[46:47], v14 offset:41472
    v_mul_f32 v183, v183, v79
    v_exp_f32 v187, v187
    v_cvt_pk_bf16_f32 v192, v180, v181
    s_waitcnt lgkmcnt(2)
    v_smfmac_f32_16x16x64_bf16 v[40:43], v[24:27], v[60:67], v23
    v_fma_f32 v184, v184, v150, v150
    v_mfma_f32_32x32x16_bf16 v[100:115], v[60:63], a[80:83], v[100:115]
    ds_read_b64_tr_b16 v[48:49], v14 offset:43008
    v_cvt_pk_bf16_f32 v193, v182, v183
    v_fma_f32 v185, v185, v150, v150
    v_fma_f32 v186, v186, v150, v150
    v_fma_f32 v187, v187, v150, v150
    v_rcp_f32 v184, v184
    v_mfma_f32_32x32x16_bf16 v[116:131], v[60:63], a[208:211], v[116:131]
    ds_read_b64_tr_b16 v[50:51], v14 offset:43520
    v_rcp_f32 v185, v185
    v_rcp_f32 v186, v186
    v_rcp_f32 v187, v187
    v_mfma_f32_32x32x16_bf16 v[100:115], v[64:67], a[84:87], v[100:115]
    s_waitcnt vmcnt(7)
    s_barrier
    v_mfma_f32_32x32x16_bf16 v[116:131], v[64:67], a[212:215], v[116:131]
    s_add_u32 m0, s73, 24576
    ds_read_b64_tr_b16 v[52:53], v13 offset:49152
    ds_read_b64_tr_b16 v[54:55], v13 offset:49664
    buffer_load_dwordx4 v11, s[12:15], s63 offen offset:0 lds
    s_waitcnt lgkmcnt(2)
    v_mfma_f32_32x32x16_bf16 v[100:115], v[44:47], a[88:91], v[100:115]
    ds_read_b64_tr_b16 v[56:57], v13 offset:51200
    v_mul_f32 v184, v184, v80
    v_mul_f32 v185, v185, v81
    v_mul_f32 v186, v186, v82
    v_mul_f32 v187, v187, v83
    v_cvt_pk_bf16_f32 v194, v184, v185
    v_cvt_pk_bf16_f32 v195, v186, v187
    v_mfma_f32_32x32x16_bf16 v[116:131], v[44:47], a[216:219], v[116:131]
    ds_read_b64_tr_b16 v[58:59], v13 offset:51712
    buffer_load_dwordx4 v12, s[12:15], s63 offen offset:1024 lds
    buffer_store_dwordx4 v[192:195], v8, s[16:19], s75 offen offset:2048 sc1
    s_lshl_b32 s3, s0, 6
    s_add_u32 s75, s75, s3
    v_mfma_f32_32x32x16_bf16 v[100:115], v[48:51], a[92:95], v[100:115]
    ds_read_b64_tr_b16 v[60:61], v14 offset:49152
    v_mul_f32 v180, v84, v84
    v_mul_f32 v181, v85, v85
    v_mul_f32 v182, v86, v86
    v_mul_f32 v183, v87, v87
    v_fma_f32 v180, v180, v148, v144
    v_fma_f32 v181, v181, v148, v144
    v_mfma_f32_32x32x16_bf16 v[116:131], v[48:51], a[220:223], v[116:131]
    s_add_u32 m0, s90, 65536
    ds_read_b64_tr_b16 v[62:63], v14 offset:49664
    buffer_load_dwordx4 v15, s[20:23], s88 offen offset:0 lds
    v_fma_f32 v182, v182, v148, v144
    s_waitcnt lgkmcnt(2)
    v_smfmac_f32_16x16x64_bf16 v[40:43], v[24:27], v[52:59], v23
    v_fma_f32 v183, v183, v148, v144
    v_mul_f32 v180, v180, v84
    v_mfma_f32_32x32x16_bf16 v[100:115], v[52:55], a[96:99], v[100:115]
    ds_read_b64_tr_b16 v[64:65], v14 offset:51200
    buffer_load_dwordx4 v16, s[20:23], s88 offen offset:1024 lds
    v_mul_f32 v181, v181, v85
    v_mul_f32 v182, v182, v86
    v_mul_f32 v183, v183, v87
    v_mfma_f32_32x32x16_bf16 v[116:131], v[52:55], a[224:227], v[116:131]
    ds_read_b64_tr_b16 v[66:67], v14 offset:51712
    v_exp_f32 v180, v180
    v_mul_f32 v184, v88, v88
    v_exp_f32 v181, v181
    v_mul_f32 v185, v89, v89
    v_mfma_f32_32x32x16_bf16 v[100:115], v[56:59], a[100:103], v[100:115]
    s_add_u32 m0, s73, 32768
    ds_read_b64_tr_b16 v[44:45], v13 offset:57344
    buffer_load_dwordx4 v11, s[12:15], s64 offen offset:0 lds
    v_exp_f32 v182, v182
    v_mul_f32 v186, v90, v90
    v_mfma_f32_32x32x16_bf16 v[116:131], v[56:59], a[228:231], v[116:131]
    ds_read_b64_tr_b16 v[46:47], v13 offset:57856
    v_exp_f32 v183, v183
    v_mul_f32 v187, v91, v91
    v_fma_f32 v180, v180, v152, v152
    v_fma_f32 v184, v184, v148, v144
    s_waitcnt lgkmcnt(2)
    v_mfma_f32_32x32x16_bf16 v[100:115], v[60:63], a[104:107], v[100:115]
    ds_read_b64_tr_b16 v[48:49], v13 offset:59392
    buffer_load_dwordx4 v12, s[12:15], s64 offen offset:1024 lds
    v_fma_f32 v181, v181, v152, v152
    v_fma_f32 v185, v185, v148, v144
    v_fma_f32 v182, v182, v152, v152
    v_mfma_f32_32x32x16_bf16 v[116:131], v[60:63], a[232:235], v[116:131]
    ds_read_b64_tr_b16 v[50:51], v13 offset:59904
    v_xor_b32 v19, 64, v21
    v_fma_f32 v186, v186, v148, v144
    v_fma_f32 v183, v183, v152, v152
    v_fma_f32 v187, v187, v148, v144
    v_rcp_f32 v180, v180
    v_mfma_f32_32x32x16_bf16 v[100:115], v[64:67], a[108:111], v[100:115]
    s_add_u32 m0, s90, 65536
    ds_read_b64_tr_b16 v[52:53], v14 offset:57344
    buffer_load_dwordx4 v17, s[20:23], s88 offen offset:2048 lds
    v_mul_f32 v184, v184, v88
    v_rcp_f32 v181, v181
    v_mfma_f32_32x32x16_bf16 v[116:131], v[64:67], a[236:239], v[116:131]
    ds_read_b64_tr_b16 v[54:55], v14 offset:57856
    v_xor_b32 v20, 64, v22
    v_mul_f32 v185, v185, v89
    v_rcp_f32 v182, v182
    v_mul_f32 v186, v186, v90
    s_waitcnt lgkmcnt(2)
    v_smfmac_f32_16x16x64_bf16 v[40:43], v[24:27], v[44:51], v23
    v_rcp_f32 v183, v183
    v_mfma_f32_32x32x16_bf16 v[100:115], v[44:47], a[112:115], v[100:115]
    ds_read_b64_tr_b16 v[56:57], v14 offset:59392
    buffer_load_dwordx4 v18, s[20:23], s88 offen offset:3072 lds
    s_add_u32 s88, s88, 32768
    s_cmp_eq_u32 s88, s78
    s_cselect_b32 s88, 0, s88
    v_mfma_f32_32x32x16_bf16 v[116:131], v[44:47], a[240:243], v[116:131]
    ds_read_b64_tr_b16 v[58:59], v14 offset:59904
    v_add_f32 v1, v40, v41
    v_mov_b32 v40, 0
    v_mul_f32 v187, v187, v91
    v_mul_f32 v180, v180, v84
    v_exp_f32 v184, v184
    v_mfma_f32_32x32x16_bf16 v[100:115], v[48:51], a[116:119], v[100:115]
    v_mov_b32 v41, 0
    ds_write_b32 v132, v1
    v_mul_f32 v181, v181, v85
    v_exp_f32 v185, v185
    v_mul_f32 v182, v182, v86
    v_mfma_f32_32x32x16_bf16 v[116:131], v[48:51], a[244:247], v[116:131]
    v_exp_f32 v186, v186
    v_mul_f32 v183, v183, v87
    v_exp_f32 v187, v187
    v_cvt_pk_bf16_f32 v188, v180, v181
    s_waitcnt lgkmcnt(1)
    v_mfma_f32_32x32x16_bf16 v[100:115], v[52:55], a[120:123], v[100:115]
    s_waitcnt vmcnt(11) lgkmcnt(0)
    s_barrier
    ds_read_b64_tr_b16 v[60:61], v13 offset:0
    ds_read_b64_tr_b16 v[62:63], v13 offset:512
    ds_read_b32 v2, v133
    v_fma_f32 v184, v184, v152, v152
    v_mfma_f32_32x32x16_bf16 v[116:131], v[52:55], a[248:251], v[116:131]
    s_add_u32 m0, s73, 40960
    ds_read_b64_tr_b16 v[64:65], v13 offset:2048
    ds_read_b64_tr_b16 v[66:67], v13 offset:2560
    buffer_load_dwordx4 v11, s[12:15], s65 offen offset:0 lds
    v_cvt_pk_bf16_f32 v189, v182, v183
    v_fma_f32 v185, v185, v152, v152
    v_mfma_f32_32x32x16_bf16 v[100:115], v[56:59], a[124:127], v[100:115]
    ds_read_b64_tr_b16 v[44:45], v14 offset:0
    v_fma_f32 v186, v186, v152, v152
    v_fma_f32 v187, v187, v152, v152
    v_rcp_f32 v184, v184
    v_rcp_f32 v185, v185
    v_mfma_f32_32x32x16_bf16 v[116:131], v[56:59], a[252:255], v[116:131]
    ds_read_b64_tr_b16 v[46:47], v14 offset:512
    buffer_load_dwordx4 v12, s[12:15], s65 offen offset:1024 lds
    s_waitcnt lgkmcnt(4)
    v_add_f32 v1, v1, v2
    v_and_b32 v2, 0xffff0000, v1
    v_sub_f32 v1, v1, v2
    v_cvt_pk_bf16_f32 v36, v2, v1
    v_mov_b32 v37, v138
    s_nop 1
    v_mfma_f32_32x32x16_bf16 v[100:115], v[36:39], v[28:31], v[100:115]
    v_rcp_f32 v186, v186
    v_rcp_f32 v187, v187
    v_mul_f32 v184, v184, v88
    v_mul_f32 v185, v185, v89
    v_mul_f32 v186, v186, v90
    v_mfma_f32_32x32x16_bf16 v[116:131], v[36:39], v[32:35], v[116:131]
    v_mul_f32 v187, v187, v91
    v_cvt_pk_bf16_f32 v190, v184, v185
    v_cvt_pk_bf16_f32 v191, v186, v187
    buffer_store_dwordx4 v[188:191], v8, s[16:19], s76 offen offset:0 sc1
    v_pk_mul_f32 v[180:181], v[92:93], v[92:93]
    v_pk_mul_f32 v[184:185], v[96:97], v[96:97]
    v_pk_mul_f32 v[182:183], v[94:95], v[94:95]
    v_pk_mul_f32 v[186:187], v[98:99], v[98:99]
    v_pk_fma_f32 v[180:181], v[180:181], v[148:149], v[144:145] op_sel_hi:[1,0,0]
    v_pk_fma_f32 v[184:185], v[184:185], v[148:149], v[144:145] op_sel_hi:[1,0,0]
    v_pk_fma_f32 v[182:183], v[182:183], v[148:149], v[144:145] op_sel_hi:[1,0,0]
    v_pk_fma_f32 v[186:187], v[186:187], v[148:149], v[144:145] op_sel_hi:[1,0,0]
    v_pk_mul_f32 v[180:181], v[180:181], v[92:93]
    v_pk_mul_f32 v[184:185], v[184:185], v[96:97]
    v_pk_mul_f32 v[182:183], v[182:183], v[94:95]
    v_pk_mul_f32 v[186:187], v[186:187], v[98:99]
    v_exp_f32 v180, v180
    v_exp_f32 v184, v184
    v_exp_f32 v181, v181
    v_exp_f32 v185, v185
    v_exp_f32 v182, v182
    v_exp_f32 v186, v186
    v_exp_f32 v183, v183
    v_exp_f32 v187, v187
    v_pk_fma_f32 v[180:181], v[180:181], v[152:153], v[152:153] op_sel_hi:[1,0,0]
    v_pk_fma_f32 v[184:185], v[184:185], v[152:153], v[152:153] op_sel_hi:[1,0,0]
    v_pk_fma_f32 v[182:183], v[182:183], v[152:153], v[152:153] op_sel_hi:[1,0,0]
    v_pk_fma_f32 v[186:187], v[186:187], v[152:153], v[152:153] op_sel_hi:[1,0,0]
    v_rcp_f32 v180, v180
    v_rcp_f32 v184, v184
    v_rcp_f32 v181, v181
    v_rcp_f32 v185, v185
    v_rcp_f32 v182, v182
    v_rcp_f32 v186, v186
    v_rcp_f32 v183, v183
    v_rcp_f32 v187, v187
    v_pk_mul_f32 v[180:181], v[180:181], v[92:93]
    v_pk_mul_f32 v[184:185], v[184:185], v[96:97]
    v_pk_mul_f32 v[182:183], v[182:183], v[94:95]
    v_pk_mul_f32 v[186:187], v[186:187], v[98:99]
    v_cvt_pk_bf16_f32 v192, v180, v181
    v_cvt_pk_bf16_f32 v194, v184, v185
    v_cvt_pk_bf16_f32 v193, v182, v183
    v_cvt_pk_bf16_f32 v195, v186, v187
    s_waitcnt lgkmcnt(2)
    v_smfmac_f32_16x16x64_bf16 v[40:43], v[24:27], v[60:67], v23
    v_mfma_f32_32x32x16_bf16 v[68:83], v[60:63], a[0:3], 0
    s_add_u32 m0, s90, 81920
    ds_read_b64_tr_b16 v[48:49], v14 offset:2048
    buffer_load_dwordx4 v15, s[20:23], s88 offen offset:0 lds
    buffer_store_dwordx4 v[192:195], v8, s[16:19], s76 offen offset:2048 sc1
    v_mfma_f32_32x32x16_bf16 v[84:99], v[60:63], a[128:131], 0
    ds_read_b64_tr_b16 v[50:51], v14 offset:2560
    s_lshl_b32 s3, s0, 6
    s_add_u32 s76, s76, s3
    v_mul_f32 v180, v100, v100
    v_mul_f32 v181, v101, v101
    v_mul_f32 v182, v102, v102
    v_mul_f32 v183, v103, v103
    v_mfma_f32_32x32x16_bf16 v[68:83], v[64:67], a[4:7], v[68:83]
    ds_read_b64_tr_b16 v[52:53], v13 offset:8192
    buffer_load_dwordx4 v16, s[20:23], s88 offen offset:1024 lds
    v_fma_f32 v180, v180, v146, v142
    v_fma_f32 v181, v181, v146, v142
    v_fma_f32 v182, v182, v146, v142
    v_fma_f32 v183, v183, v146, v142
    v_mfma_f32_32x32x16_bf16 v[84:99], v[64:67], a[132:135], v[84:99]
    ds_read_b64_tr_b16 v[54:55], v13 offset:8704
    v_mul_f32 v180, v180, v100
    v_mul_f32 v181, v181, v101
    v_mul_f32 v182, v182, v102
    v_mul_f32 v183, v183, v103
    s_waitcnt lgkmcnt(2)
    v_mfma_f32_32x32x16_bf16 v[68:83], v[44:47], a[8:11], v[68:83]
    s_add_u32 m0, s73, 49152
    ds_read_b64_tr_b16 v[56:57], v13 offset:10240
    buffer_load_dwordx4 v11, s[12:15], s66 offen offset:0 lds
    v_exp_f32 v180, v180
    v_mul_f32 v184, v104, v104
    v_mfma_f32_32x32x16_bf16 v[84:99], v[44:47], a[136:139], v[84:99]
    ds_read_b64_tr_b16 v[58:59], v13 offset:10752
    v_exp_f32 v181, v181
    v_mul_f32 v185, v105, v105
    v_exp_f32 v182, v182
    v_mul_f32 v186, v106, v106
    v_mfma_f32_32x32x16_bf16 v[68:83], v[48:51], a[12:15], v[68:83]
    ds_read_b64_tr_b16 v[60:61], v14 offset:8192
    buffer_load_dwordx4 v12, s[12:15], s66 offen offset:1024 lds
    v_exp_f32 v183, v183
    v_mul_f32 v187, v107, v107
    v_fma_f32 v180, v180, v150, v150
    v_mfma_f32_32x32x16_bf16 v[84:99], v[48:51], a[140:143], v[84:99]
    ds_read_b64_tr_b16 v[62:63], v14 offset:8704
    v_fma_f32 v184, v184, v146, v142
    v_fma_f32 v181, v181, v150, v150
    v_fma_f32 v185, v185, v146, v142
    v_fma_f32 v182, v182, v150, v150
    v_fma_f32 v186, v186, v146, v142
    s_waitcnt lgkmcnt(2)
    v_smfmac_f32_16x16x64_bf16 v[40:43], v[24:27], v[52:59], v23
    v_fma_f32 v183, v183, v150, v150
    v_mfma_f32_32x32x16_bf16 v[68:83], v[52:55], a[16:19], v[68:83]
    s_add_u32 m0, s90, 81920
    ds_read_b64_tr_b16 v[64:65], v14 offset:10240
    buffer_load_dwordx4 v17, s[20:23], s88 offen offset:2048 lds
    v_fma_f32 v187, v187, v146, v142
    v_rcp_f32 v180, v180
    v_mfma_f32_32x32x16_bf16 v[84:99], v[52:55], a[144:147], v[84:99]
    ds_read_b64_tr_b16 v[66:67], v14 offset:10752
    v_mul_f32 v184, v184, v104
    v_rcp_f32 v181, v181
    v_mul_f32 v185, v185, v105
    v_rcp_f32 v182, v182
    v_mfma_f32_32x32x16_bf16 v[68:83], v[56:59], a[20:23], v[68:83]
    s_waitcnt vmcnt(16)
    s_barrier
    v_mfma_f32_32x32x16_bf16 v[84:99], v[56:59], a[148:151], v[84:99]
    ds_read_b64_tr_b16 v[44:45], v13 offset:16384
    ds_read_b64_tr_b16 v[46:47], v13 offset:16896
    buffer_load_dwordx4 v18, s[20:23], s88 offen offset:3072 lds
    s_add_u32 s88, s88, 32768
    s_cmp_eq_u32 s88, s78
    s_cselect_b32 s88, 0, s88
    s_waitcnt lgkmcnt(2)
    v_mfma_f32_32x32x16_bf16 v[68:83], v[60:63], a[24:27], v[68:83]
    ds_read_b64_tr_b16 v[48:49], v13 offset:18432
    v_mul_f32 v186, v186, v106
    v_rcp_f32 v183, v183
    v_mul_f32 v187, v187, v107
    v_mul_f32 v180, v180, v100
    v_mfma_f32_32x32x16_bf16 v[84:99], v[60:63], a[152:155], v[84:99]
    s_add_u32 m0, s73, 57344
    ds_read_b64_tr_b16 v[50:51], v13 offset:18944
    buffer_load_dwordx4 v11, s[12:15], s67 offen offset:0 lds
    v_exp_f32 v184, v184
    v_mul_f32 v181, v181, v101
    v_mfma_f32_32x32x16_bf16 v[68:83], v[64:67], a[28:31], v[68:83]
    ds_read_b64_tr_b16 v[52:53], v14 offset:16384
    v_exp_f32 v185, v185
    v_mul_f32 v182, v182, v102
    v_exp_f32 v186, v186
    v_mul_f32 v183, v183, v103
    v_mfma_f32_32x32x16_bf16 v[84:99], v[64:67], a[156:159], v[84:99]
    ds_read_b64_tr_b16 v[54:55], v14 offset:16896
    buffer_load_dwordx4 v12, s[12:15], s67 offen offset:1024 lds
    v_exp_f32 v187, v187
    v_cvt_pk_bf16_f32 v188, v180, v181
    s_waitcnt lgkmcnt(2)
    v_smfmac_f32_16x16x64_bf16 v[40:43], v[24:27], v[44:51], v23
    v_fma_f32 v184, v184, v150, v150
    v_mfma_f32_32x32x16_bf16 v[68:83], v[44:47], a[32:35], v[68:83]
    s_add_u32 m0, s90, 98304
    ds_read_b64_tr_b16 v[56:57], v14 offset:18432
    buffer_load_dwordx4 v15, s[20:23], s88 offen offset:0 lds
    v_cvt_pk_bf16_f32 v189, v182, v183
    v_fma_f32 v185, v185, v150, v150
    v_mfma_f32_32x32x16_bf16 v[84:99], v[44:47], a[160:163], v[84:99]
    ds_read_b64_tr_b16 v[58:59], v14 offset:18944
    v_fma_f32 v186, v186, v150, v150
    v_fma_f32 v187, v187, v150, v150
    v_rcp_f32 v184, v184
    v_rcp_f32 v185, v185
    v_mfma_f32_32x32x16_bf16 v[68:83], v[48:51], a[36:39], v[68:83]
    ds_read_b64_tr_b16 v[60:61], v13 offset:24576
    buffer_load_dwordx4 v16, s[20:23], s88 offen offset:1024 lds
    v_rcp_f32 v186, v186
    v_rcp_f32 v187, v187
    v_mfma_f32_32x32x16_bf16 v[84:99], v[48:51], a[164:167], v[84:99]
    ds_read_b64_tr_b16 v[62:63], v13 offset:25088
    v_mul_f32 v184, v184, v104
    v_mul_f32 v185, v185, v105
    v_mul_f32 v186, v186, v106
    v_mul_f32 v187, v187, v107
    s_waitcnt lgkmcnt(2)
    v_mfma_f32_32x32x16_bf16 v[68:83], v[52:55], a[40:43], v[68:83]
    s_add_u32 m0, s74, 0
    ds_read_b64_tr_b16 v[64:65], v13 offset:26624
    buffer_load_dwordx4 v134, s[12:15], s60 offen lds
    v_cvt_pk_bf16_f32 v190, v184, v185
    v_cvt_pk_bf16_f32 v191, v186, v187
    v_mfma_f32_32x32x16_bf16 v[84:99], v[52:55], a[168:171], v[84:99]
    ds_read_b64_tr_b16 v[66:67], v13 offset:27136
    buffer_store_dwordx4 v[188:191], v8, s[16:19], s75 offen offset:0 sc1
    v_mul_f32 v180, v108, v108
    v_mul_f32 v181, v109, v109
    v_mul_f32 v182, v110, v110
    v_mul_f32 v183, v111, v111
    v_mfma_f32_32x32x16_bf16 v[68:83], v[56:59], a[44:47], v[68:83]
    ds_read_b64_tr_b16 v[44:45], v14 offset:24576
    v_fma_f32 v180, v180, v146, v142
    v_fma_f32 v181, v181, v146, v142
    v_fma_f32 v182, v182, v146, v142
    v_fma_f32 v183, v183, v146, v142
    v_mul_f32 v180, v180, v108
    v_mul_f32 v181, v181, v109
    v_mfma_f32_32x32x16_bf16 v[84:99], v[56:59], a[172:175], v[84:99]
    s_add_u32 m0, s90, 98304
    ds_read_b64_tr_b16 v[46:47], v14 offset:25088
    buffer_load_dwordx4 v17, s[20:23], s88 offen offset:2048 lds
    v_mul_f32 v182, v182, v110
    v_mul_f32 v183, v183, v111
    s_waitcnt lgkmcnt(2)
    v_smfmac_f32_16x16x64_bf16 v[40:43], v[24:27], v[60:67], v23
    v_exp_f32 v180, v180
    v_mfma_f32_32x32x16_bf16 v[68:83], v[60:63], a[48:51], v[68:83]
    ds_read_b64_tr_b16 v[48:49], v14 offset:26624
    buffer_load_dwordx4 v18, s[20:23], s88 offen offset:3072 lds
    s_add_u32 s88, s88, 32768
    s_cmp_eq_u32 s88, s78
    s_cselect_b32 s88, 0, s88
    v_mfma_f32_32x32x16_bf16 v[84:99], v[60:63], a[176:179], v[84:99]
    ds_read_b64_tr_b16 v[50:51], v14 offset:27136
    v_mul_f32 v184, v112, v112
    v_exp_f32 v181, v181
    v_mul_f32 v185, v113, v113
    v_exp_f32 v182, v182
    v_mfma_f32_32x32x16_bf16 v[68:83], v[64:67], a[52:55], v[68:83]
    s_waitcnt vmcnt(16)
    s_barrier
    v_mfma_f32_32x32x16_bf16 v[84:99], v[64:67], a[180:183], v[84:99]
    s_add_u32 m0, s74, 4096
    ds_read_b64_tr_b16 v[52:53], v13 offset:32768
    ds_read_b64_tr_b16 v[54:55], v13 offset:33280
    buffer_load_dwordx4 v134, s[12:15], s61 offen lds
    s_waitcnt lgkmcnt(2)
    v_mfma_f32_32x32x16_bf16 v[68:83], v[44:47], a[56:59], v[68:83]
    ds_read_b64_tr_b16 v[56:57], v13 offset:34816
    v_mul_f32 v186, v114, v114
    v_exp_f32 v183, v183
    v_mul_f32 v187, v115, v115
    v_fma_f32 v180, v180, v150, v150
    v_fma_f32 v184, v184, v146, v142
    v_mfma_f32_32x32x16_bf16 v[84:99], v[44:47], a[184:187], v[84:99]
    ds_read_b64_tr_b16 v[58:59], v13 offset:35328
    v_fma_f32 v181, v181, v150, v150
    v_fma_f32 v185, v185, v146, v142
    v_fma_f32 v182, v182, v150, v150
    v_fma_f32 v186, v186, v146, v142
    v_fma_f32 v183, v183, v150, v150
    v_fma_f32 v187, v187, v146, v142
    v_mfma_f32_32x32x16_bf16 v[68:83], v[48:51], a[60:63], v[68:83]
    ds_read_b64_tr_b16 v[60:61], v14 offset:32768
    v_rcp_f32 v180, v180
    v_mul_f32 v184, v184, v112
    v_rcp_f32 v181, v181
    v_mul_f32 v185, v185, v113
    v_mfma_f32_32x32x16_bf16 v[84:99], v[48:51], a[188:191], v[84:99]
    ds_read_b64_tr_b16 v[62:63], v14 offset:33280
    v_rcp_f32 v182, v182
    v_mul_f32 v186, v186, v114
    v_rcp_f32 v183, v183
    s_waitcnt lgkmcnt(2)
    v_smfmac_f32_16x16x64_bf16 v[40:43], v[24:27], v[52:59], v23
    v_mul_f32 v187, v187, v115
    v_mfma_f32_32x32x16_bf16 v[68:83], v[52:55], a[64:67], v[68:83]
    s_add_u32 m0, s90, 114688
    ds_read_b64_tr_b16 v[64:65], v14 offset:34816
    buffer_load_dwordx4 v15, s[20:23], s88 offen offset:0 lds
    ds_read_b64_tr_b16 a[128:129], v21 offset:0
    v_mul_f32 v180, v180, v108
    v_mfma_f32_32x32x16_bf16 v[84:99], v[52:55], a[192:195], v[84:99]
    ds_read_b64_tr_b16 v[66:67], v14 offset:35328
    ds_read_b64_tr_b16 a[130:131], v21 offset:1024
    v_exp_f32 v184, v184
    v_mul_f32 v181, v181, v109
    v_exp_f32 v185, v185
    v_mfma_f32_32x32x16_bf16 v[68:83], v[56:59], a[68:71], v[68:83]
    ds_read_b64_tr_b16 v[44:45], v13 offset:40960
    buffer_load_dwordx4 v16, s[20:23], s88 offen offset:1024 lds
    ds_read_b64_tr_b16 a[132:133], v22 offset:0
    v_mul_f32 v182, v182, v110
    v_exp_f32 v186, v186
    v_mfma_f32_32x32x16_bf16 v[84:99], v[56:59], a[196:199], v[84:99]
    ds_read_b64_tr_b16 v[46:47], v13 offset:41472
    ds_read_b64_tr_b16 a[134:135], v22 offset:1024
    v_mul_f32 v183, v183, v111
    v_exp_f32 v187, v187
    s_waitcnt lgkmcnt(5)
    v_mfma_f32_32x32x16_bf16 v[68:83], v[60:63], a[72:75], v[68:83]
    s_add_u32 m0, s74, 8192
    ds_read_b64_tr_b16 v[48:49], v13 offset:43008
    buffer_load_dwordx4 v134, s[12:15], s62 offen lds
    v_cvt_pk_bf16_f32 v192, v180, v181
    v_fma_f32 v184, v184, v150, v150
    v_cvt_pk_bf16_f32 v193, v182, v183
    v_mfma_f32_32x32x16_bf16 v[84:99], v[60:63], a[200:203], v[84:99]
    ds_read_b64_tr_b16 v[50:51], v13 offset:43520
    ds_read_b64_tr_b16 a[136:137], v19 offset:0
    ds_read_b64_tr_b16 a[138:139], v19 offset:1024
    v_fma_f32 v185, v185, v150, v150
    v_fma_f32 v186, v186, v150, v150
    v_fma_f32 v187, v187, v150, v150
    v_mfma_f32_32x32x16_bf16 v[68:83], v[64:67], a[76:79], v[68:83]
    ds_read_b64_tr_b16 v[52:53], v14 offset:40960
    ds_read_b64_tr_b16 a[140:141], v20 offset:0
    v_rcp_f32 v184, v184
    v_rcp_f32 v185, v185
    v_mfma_f32_32x32x16_bf16 v[84:99], v[64:67], a[204:207], v[84:99]
    ds_read_b64_tr_b16 v[54:55], v14 offset:41472
    ds_read_b64_tr_b16 a[142:143], v20 offset:1024
    v_rcp_f32 v186, v186
    v_rcp_f32 v187, v187
    s_waitcnt lgkmcnt(6)
    v_smfmac_f32_16x16x64_bf16 v[40:43], v[24:27], v[44:51], v23
    v_mul_f32 v184, v184, v112
    v_mul_f32 v185, v185, v113
    v_mfma_f32_32x32x16_bf16 v[68:83], v[44:47], a[80:83], v[68:83]
    s_add_u32 m0, s90, 114688
    ds_read_b64_tr_b16 v[56:57], v14 offset:43008
    buffer_load_dwordx4 v17, s[20:23], s88 offen offset:2048 lds
    s_waitcnt vmcnt(13)
    ds_read_b64_tr_b16 a[144:145], v21 offset:16384
    v_mfma_f32_32x32x16_bf16 v[84:99], v[44:47], a[208:211], v[84:99]
    ds_read_b64_tr_b16 v[58:59], v14 offset:43520
    ds_read_b64_tr_b16 a[146:147], v21 offset:17408
    v_mul_f32 v186, v186, v114
    v_mul_f32 v187, v187, v115
    v_cvt_pk_bf16_f32 v194, v184, v185
    v_cvt_pk_bf16_f32 v195, v186, v187
    v_mfma_f32_32x32x16_bf16 v[68:83], v[48:51], a[84:87], v[68:83]
    s_waitcnt vmcnt(11)
    s_barrier
    v_mfma_f32_32x32x16_bf16 v[84:99], v[48:51], a[212:215], v[84:99]
    ds_read_b64_tr_b16 v[60:61], v13 offset:49152
    ds_read_b64_tr_b16 v[62:63], v13 offset:49664
    buffer_load_dwordx4 v18, s[20:23], s88 offen offset:3072 lds
    s_add_u32 s88, s88, 32768
    s_cmp_eq_u32 s88, s78
    s_cselect_b32 s88, 0, s88
    s_waitcnt lgkmcnt(3)
    v_mfma_f32_32x32x16_bf16 v[68:83], v[52:55], a[88:91], v[68:83]
    ds_read_b64_tr_b16 v[64:65], v13 offset:51200
    ds_read_b64_tr_b16 a[148:149], v22 offset:16384
    ds_read_b64_tr_b16 a[150:151], v22 offset:17408
    buffer_store_dwordx4 v[192:195], v8, s[16:19], s75 offen offset:2048 sc1
    s_lshl_b32 s3, s1, 6
    s_add_u32 s75, s75, s3
    v_mfma_f32_32x32x16_bf16 v[84:99], v[52:55], a[216:219], v[84:99]
    s_add_u32 m0, s74, 12288
    ds_read_b64_tr_b16 v[66:67], v13 offset:51712
    buffer_load_dwordx4 v134, s[12:15], s63 offen lds
    ds_read_b64_tr_b16 a[152:153], v19 offset:16384
    v_mul_f32 v180, v116, v116
    v_mul_f32 v181, v117, v117
    v_mfma_f32_32x32x16_bf16 v[68:83], v[56:59], a[92:95], v[68:83]
    ds_read_b64_tr_b16 v[44:45], v14 offset:49152
    ds_read_b64_tr_b16 a[154:155], v19 offset:17408
    ds_read_b64_tr_b16 a[156:157], v20 offset:16384
    v_mul_f32 v182, v118, v118
    v_mul_f32 v183, v119, v119
    v_fma_f32 v180, v180, v148, v144
    v_mfma_f32_32x32x16_bf16 v[84:99], v[56:59], a[220:223], v[84:99]
    ds_read_b64_tr_b16 v[46:47], v14 offset:49664
    ds_read_b64_tr_b16 a[158:159], v20 offset:17408
    v_fma_f32 v181, v181, v148, v144
    v_fma_f32 v182, v182, v148, v144
    v_fma_f32 v183, v183, v148, v144
    v_mul_f32 v180, v180, v116
    s_waitcnt lgkmcnt(6)
    v_smfmac_f32_16x16x64_bf16 v[40:43], v[24:27], v[60:67], v23
    v_mul_f32 v181, v181, v117
    v_mfma_f32_32x32x16_bf16 v[68:83], v[60:63], a[96:99], v[68:83]
    s_add_u32 m0, s90, 147456
    ds_read_b64_tr_b16 v[48:49], v14 offset:51200
    buffer_load_dwordx4 v15, s[20:23], s88 offen offset:0 lds
    v_mul_f32 v182, v182, v118
    v_mul_f32 v183, v183, v119
    v_mfma_f32_32x32x16_bf16 v[84:99], v[60:63], a[224:227], v[84:99]
    ds_read_b64_tr_b16 v[50:51], v14 offset:51712
    v_exp_f32 v180, v180
    v_mul_f32 v184, v120, v120
    v_exp_f32 v181, v181
    v_mul_f32 v185, v121, v121
    v_mfma_f32_32x32x16_bf16 v[68:83], v[64:67], a[100:103], v[68:83]
    ds_read_b64_tr_b16 v[52:53], v13 offset:57344
    buffer_load_dwordx4 v16, s[20:23], s88 offen offset:1024 lds
    v_exp_f32 v182, v182
    v_mul_f32 v186, v122, v122
    v_mfma_f32_32x32x16_bf16 v[84:99], v[64:67], a[228:231], v[84:99]
    ds_read_b64_tr_b16 v[54:55], v13 offset:57856
    v_exp_f32 v183, v183
    v_mul_f32 v187, v123, v123
    v_fma_f32 v180, v180, v152, v152
    v_fma_f32 v184, v184, v148, v144
    s_waitcnt lgkmcnt(2)
    v_mfma_f32_32x32x16_bf16 v[68:83], v[44:47], a[104:107], v[68:83]
    s_add_u32 m0, s74, 16384
    ds_read_b64_tr_b16 v[56:57], v13 offset:59392
    buffer_load_dwordx4 v134, s[12:15], s64 offen lds
    v_fma_f32 v181, v181, v152, v152
    v_fma_f32 v185, v185, v148, v144
    v_fma_f32 v182, v182, v152, v152
    v_mfma_f32_32x32x16_bf16 v[84:99], v[44:47], a[232:235], v[84:99]
    ds_read_b64_tr_b16 v[58:59], v13 offset:59904
    v_fma_f32 v186, v186, v148, v144
    v_fma_f32 v183, v183, v152, v152
    v_fma_f32 v187, v187, v148, v144
    v_rcp_f32 v180, v180
    v_mul_f32 v184, v184, v120
    v_mfma_f32_32x32x16_bf16 v[68:83], v[48:51], a[108:111], v[68:83]
    s_add_u32 m0, s90, 147456
    ds_read_b64_tr_b16 v[60:61], v14 offset:57344
    buffer_load_dwordx4 v17, s[20:23], s88 offen offset:2048 lds
    v_rcp_f32 v181, v181
    v_mul_f32 v185, v185, v121
    v_mfma_f32_32x32x16_bf16 v[84:99], v[48:51], a[236:239], v[84:99]
    ds_read_b64_tr_b16 v[62:63], v14 offset:57856
    v_rcp_f32 v182, v182
    v_mul_f32 v186, v186, v122
    v_rcp_f32 v183, v183
    s_waitcnt lgkmcnt(2)
    v_smfmac_f32_16x16x64_bf16 v[40:43], v[24:27], v[52:59], v23
    v_mul_f32 v187, v187, v123
    v_mfma_f32_32x32x16_bf16 v[68:83], v[52:55], a[112:115], v[68:83]
    ds_read_b64_tr_b16 v[64:65], v14 offset:59392
    buffer_load_dwordx4 v18, s[20:23], s88 offen offset:3072 lds
    s_add_u32 s88, s88, 32768
    s_cmp_eq_u32 s88, s78
    s_cselect_b32 s88, 0, s88
    v_mfma_f32_32x32x16_bf16 v[84:99], v[52:55], a[240:243], v[84:99]
    ds_read_b64_tr_b16 v[66:67], v14 offset:59904
    v_add_f32 v1, v40, v41
    v_mov_b32 v40, 0
    v_mul_f32 v180, v180, v116
    v_exp_f32 v184, v184
    v_mul_f32 v181, v181, v117
    v_mfma_f32_32x32x16_bf16 v[68:83], v[56:59], a[116:119], v[68:83]
    v_mov_b32 v41, 0
    ds_write_b32 v132, v1
    v_exp_f32 v185, v185
    v_mul_f32 v182, v182, v118
    v_exp_f32 v186, v186
    v_mfma_f32_32x32x16_bf16 v[84:99], v[56:59], a[244:247], v[84:99]
    s_add_u32 m0, s90, 65536
    s_nop 0
    buffer_load_dwordx4 v15, s[20:23], s88 offen offset:0 lds
    v_mul_f32 v183, v183, v119
    v_exp_f32 v187, v187
    s_waitcnt lgkmcnt(1)
    v_mfma_f32_32x32x16_bf16 v[68:83], v[60:63], a[120:123], v[68:83]
    s_waitcnt vmcnt(13) lgkmcnt(0)
    s_barrier
    ds_read_b64_tr_b16 v[44:45], v135 offset:0
    ds_read_b64_tr_b16 v[46:47], v135 offset:256
    ds_read_b32 v2, v133
    v_cvt_pk_bf16_f32 v188, v180, v181
    v_mfma_f32_32x32x16_bf16 v[84:99], v[60:63], a[248:251], v[84:99]
    ds_read_b64_tr_b16 v[48:49], v135 offset:1024
    ds_read_b64_tr_b16 v[50:51], v135 offset:1280
    buffer_load_dwordx4 v16, s[20:23], s88 offen offset:1024 lds
    v_fma_f32 v184, v184, v152, v152
    v_cvt_pk_bf16_f32 v189, v182, v183
    v_fma_f32 v185, v185, v152, v152
    v_mfma_f32_32x32x16_bf16 v[68:83], v[64:67], a[124:127], v[68:83]
    ds_read_b64_tr_b16 v[52:53], v136 offset:0
    v_fma_f32 v186, v186, v152, v152
    v_fma_f32 v187, v187, v152, v152
    v_rcp_f32 v184, v184
    v_rcp_f32 v185, v185
    v_mfma_f32_32x32x16_bf16 v[84:99], v[64:67], a[252:255], v[84:99]
    s_add_u32 m0, s74, 20480
    ds_read_b64_tr_b16 v[54:55], v136 offset:256
    buffer_load_dwordx4 v134, s[12:15], s65 offen lds
    s_waitcnt lgkmcnt(4)
    v_add_f32 v1, v1, v2
    v_and_b32 v2, 0xffff0000, v1
    v_sub_f32 v1, v1, v2
    v_cvt_pk_bf16_f32 v36, v2, v1
    v_mov_b32 v37, v139
    s_nop 1
    v_mfma_f32_32x32x16_bf16 v[68:83], v[36:39], v[28:31], v[68:83]
    v_rcp_f32 v186, v186
    v_rcp_f32 v187, v187
    v_mul_f32 v184, v184, v120
    v_mul_f32 v185, v185, v121
    v_mul_f32 v186, v186, v122
    v_mfma_f32_32x32x16_bf16 v[84:99], v[36:39], v[32:35], v[84:99]
    v_mul_f32 v187, v187, v123
    v_cvt_pk_bf16_f32 v190, v184, v185
    v_cvt_pk_bf16_f32 v191, v186, v187
    buffer_store_dwordx4 v[188:191], v8, s[16:19], s76 offen offset:0 sc1
    v_pk_mul_f32 v[180:181], v[124:125], v[124:125]
    v_pk_mul_f32 v[184:185], v[128:129], v[128:129]
    v_pk_mul_f32 v[182:183], v[126:127], v[126:127]
    v_pk_mul_f32 v[186:187], v[130:131], v[130:131]
    v_pk_fma_f32 v[180:181], v[180:181], v[148:149], v[144:145] op_sel_hi:[1,0,0]
    v_pk_fma_f32 v[184:185], v[184:185], v[148:149], v[144:145] op_sel_hi:[1,0,0]
    v_pk_fma_f32 v[182:183], v[182:183], v[148:149], v[144:145] op_sel_hi:[1,0,0]
    v_pk_fma_f32 v[186:187], v[186:187], v[148:149], v[144:145] op_sel_hi:[1,0,0]
    v_pk_mul_f32 v[180:181], v[180:181], v[124:125]
    v_pk_mul_f32 v[184:185], v[184:185], v[128:129]
    v_pk_mul_f32 v[182:183], v[182:183], v[126:127]
    v_pk_mul_f32 v[186:187], v[186:187], v[130:131]
    v_exp_f32 v180, v180
    v_exp_f32 v184, v184
    v_exp_f32 v181, v181
    v_exp_f32 v185, v185
    v_exp_f32 v182, v182
    v_exp_f32 v186, v186
    v_exp_f32 v183, v183
    v_exp_f32 v187, v187
    v_pk_fma_f32 v[180:181], v[180:181], v[152:153], v[152:153] op_sel_hi:[1,0,0]
    v_pk_fma_f32 v[184:185], v[184:185], v[152:153], v[152:153] op_sel_hi:[1,0,0]
    v_pk_fma_f32 v[182:183], v[182:183], v[152:153], v[152:153] op_sel_hi:[1,0,0]
    v_pk_fma_f32 v[186:187], v[186:187], v[152:153], v[152:153] op_sel_hi:[1,0,0]
    v_rcp_f32 v180, v180
    v_rcp_f32 v184, v184
    v_rcp_f32 v181, v181
    v_rcp_f32 v185, v185
    v_rcp_f32 v182, v182
    v_rcp_f32 v186, v186
    v_rcp_f32 v183, v183
    v_rcp_f32 v187, v187
    v_pk_mul_f32 v[180:181], v[180:181], v[124:125]
    v_pk_mul_f32 v[184:185], v[184:185], v[128:129]
    v_pk_mul_f32 v[182:183], v[182:183], v[126:127]
    v_pk_mul_f32 v[186:187], v[186:187], v[130:131]
    v_cvt_pk_bf16_f32 v192, v180, v181
    v_cvt_pk_bf16_f32 v194, v184, v185
    v_cvt_pk_bf16_f32 v193, v182, v183
    v_cvt_pk_bf16_f32 v195, v186, v187
    buffer_store_dwordx4 v[192:195], v8, s[16:19], s76 offen offset:2048 sc1
    s_lshl_b32 s3, s1, 6
    s_add_u32 s76, s76, s3
    v_pk_mul_f32 v[180:181], v[68:69], v[68:69]
    v_pk_mul_f32 v[184:185], v[72:73], v[72:73]
    v_pk_mul_f32 v[182:183], v[70:71], v[70:71]
    v_pk_mul_f32 v[186:187], v[74:75], v[74:75]
    v_pk_fma_f32 v[180:181], v[180:181], v[146:147], v[142:143] op_sel_hi:[1,0,0]
    v_pk_fma_f32 v[184:185], v[184:185], v[146:147], v[142:143] op_sel_hi:[1,0,0]
    v_pk_fma_f32 v[182:183], v[182:183], v[146:147], v[142:143] op_sel_hi:[1,0,0]
    v_pk_fma_f32 v[186:187], v[186:187], v[146:147], v[142:143] op_sel_hi:[1,0,0]
    v_pk_mul_f32 v[180:181], v[180:181], v[68:69]
    v_pk_mul_f32 v[184:185], v[184:185], v[72:73]
    v_pk_mul_f32 v[182:183], v[182:183], v[70:71]
    v_pk_mul_f32 v[186:187], v[186:187], v[74:75]
    v_exp_f32 v180, v180
    v_exp_f32 v184, v184
    v_exp_f32 v181, v181
    v_exp_f32 v185, v185
    v_exp_f32 v182, v182
    v_exp_f32 v186, v186
    v_exp_f32 v183, v183
    v_exp_f32 v187, v187
    v_pk_fma_f32 v[180:181], v[180:181], v[150:151], v[150:151] op_sel_hi:[1,0,0]
    v_pk_fma_f32 v[184:185], v[184:185], v[150:151], v[150:151] op_sel_hi:[1,0,0]
    v_pk_fma_f32 v[182:183], v[182:183], v[150:151], v[150:151] op_sel_hi:[1,0,0]
    v_pk_fma_f32 v[186:187], v[186:187], v[150:151], v[150:151] op_sel_hi:[1,0,0]
    v_rcp_f32 v180, v180
    v_rcp_f32 v184, v184
    v_rcp_f32 v181, v181
    v_rcp_f32 v185, v185
    v_rcp_f32 v182, v182
    v_rcp_f32 v186, v186
    v_rcp_f32 v183, v183
    v_rcp_f32 v187, v187
    v_pk_mul_f32 v[180:181], v[180:181], v[68:69]
    v_pk_mul_f32 v[184:185], v[184:185], v[72:73]
    v_pk_mul_f32 v[182:183], v[182:183], v[70:71]
    v_pk_mul_f32 v[186:187], v[186:187], v[74:75]
    v_cvt_pk_bf16_f32 v188, v180, v181
    v_cvt_pk_bf16_f32 v190, v184, v185
    v_cvt_pk_bf16_f32 v189, v182, v183
    v_cvt_pk_bf16_f32 v191, v186, v187
    buffer_store_dwordx4 v[188:191], v8, s[16:19], s75 offen offset:0 sc1
    v_pk_mul_f32 v[180:181], v[76:77], v[76:77]
    v_pk_mul_f32 v[184:185], v[80:81], v[80:81]
    v_pk_mul_f32 v[182:183], v[78:79], v[78:79]
    v_pk_mul_f32 v[186:187], v[82:83], v[82:83]
    v_pk_fma_f32 v[180:181], v[180:181], v[146:147], v[142:143] op_sel_hi:[1,0,0]
    v_pk_fma_f32 v[184:185], v[184:185], v[146:147], v[142:143] op_sel_hi:[1,0,0]
    v_pk_fma_f32 v[182:183], v[182:183], v[146:147], v[142:143] op_sel_hi:[1,0,0]
    v_pk_fma_f32 v[186:187], v[186:187], v[146:147], v[142:143] op_sel_hi:[1,0,0]
    v_pk_mul_f32 v[180:181], v[180:181], v[76:77]
    v_pk_mul_f32 v[184:185], v[184:185], v[80:81]
    v_pk_mul_f32 v[182:183], v[182:183], v[78:79]
    v_pk_mul_f32 v[186:187], v[186:187], v[82:83]
    v_exp_f32 v180, v180
    v_exp_f32 v184, v184
    v_exp_f32 v181, v181
    v_exp_f32 v185, v185
    v_exp_f32 v182, v182
    v_exp_f32 v186, v186
    v_exp_f32 v183, v183
    v_exp_f32 v187, v187
    v_pk_fma_f32 v[180:181], v[180:181], v[150:151], v[150:151] op_sel_hi:[1,0,0]
    v_pk_fma_f32 v[184:185], v[184:185], v[150:151], v[150:151] op_sel_hi:[1,0,0]
    v_pk_fma_f32 v[182:183], v[182:183], v[150:151], v[150:151] op_sel_hi:[1,0,0]
    v_pk_fma_f32 v[186:187], v[186:187], v[150:151], v[150:151] op_sel_hi:[1,0,0]
    v_rcp_f32 v180, v180
    v_rcp_f32 v184, v184
    v_rcp_f32 v181, v181
    v_rcp_f32 v185, v185
    v_rcp_f32 v182, v182
    v_rcp_f32 v186, v186
    v_rcp_f32 v183, v183
    v_rcp_f32 v187, v187
    v_pk_mul_f32 v[180:181], v[180:181], v[76:77]
    v_pk_mul_f32 v[184:185], v[184:185], v[80:81]
    v_pk_mul_f32 v[182:183], v[182:183], v[78:79]
    v_pk_mul_f32 v[186:187], v[186:187], v[82:83]
    v_cvt_pk_bf16_f32 v192, v180, v181
    v_cvt_pk_bf16_f32 v194, v184, v185
    v_cvt_pk_bf16_f32 v193, v182, v183
    v_cvt_pk_bf16_f32 v195, v186, v187
    s_waitcnt lgkmcnt(2)
    v_smfmac_f32_16x16x64_bf16 v[40:43], v[24:27], v[44:51], v23
    v_mfma_f32_32x32x16_bf16 v[100:115], v[44:47], a[0:3], 0
    s_add_u32 m0, s90, 65536
    ds_read_b64_tr_b16 v[56:57], v136 offset:1024
    ds_read_b64_tr_b16 v[58:59], v136 offset:1280
    buffer_load_dwordx4 v17, s[20:23], s88 offen offset:2048 lds
    buffer_store_dwordx4 v[192:195], v8, s[16:19], s75 offen offset:2048 sc1
    v_mul_f32 v180, v84, v84
    v_mfma_f32_32x32x16_bf16 v[100:115], v[48:51], a[4:7], v[100:115]
    ds_read_b64_tr_b16 v[60:61], v135 offset:4096
    ds_read_b64_tr_b16 v[62:63], v135 offset:4352
    buffer_load_dwordx4 v18, s[20:23], s88 offen offset:3072 lds
    s_add_u32 s88, s88, 32768
    s_cmp_eq_u32 s88, s78
    s_cselect_b32 s88, 0, s88
    v_mul_f32 v181, v85, v85
    v_mul_f32 v182, v86, v86
    s_waitcnt lgkmcnt(2)
    v_mfma_f32_32x32x16_bf16 v[100:115], v[52:55], a[8:11], v[100:115]
    s_add_u32 m0, s74, 24576
    ds_read_b64_tr_b16 v[64:65], v135 offset:5120
    ds_read_b64_tr_b16 v[66:67], v135 offset:5376
    buffer_load_dwordx4 v134, s[12:15], s66 offen lds
    v_mul_f32 v183, v87, v87
    v_fma_f32 v180, v180, v148, v144
    v_fma_f32 v181, v181, v148, v144
    v_mfma_f32_32x32x16_bf16 v[100:115], v[56:59], a[12:15], v[100:115]
    s_add_u32 m0, s90, 81920
    ds_read_b64_tr_b16 v[44:45], v136 offset:4096
    ds_read_b64_tr_b16 v[46:47], v136 offset:4352
    buffer_load_dwordx4 v15, s[20:23], s88 offen offset:0 lds
    v_fma_f32 v182, v182, v148, v144
    v_fma_f32 v183, v183, v148, v144
    s_waitcnt lgkmcnt(2)
    v_smfmac_f32_16x16x64_bf16 v[40:43], v[24:27], v[60:67], v23
    v_add_u32 v132, -131072, v132
    v_mul_f32 v180, v180, v84
    v_mul_f32 v181, v181, v85
    v_mfma_f32_32x32x16_bf16 v[100:115], v[60:63], a[16:19], v[100:115]
    ds_read_b64_tr_b16 v[48:49], v136 offset:5120
    ds_read_b64_tr_b16 v[50:51], v136 offset:5376
    buffer_load_dwordx4 v16, s[20:23], s88 offen offset:1024 lds
    v_add_u32 v133, -131072, v133
    v_mul_f32 v182, v182, v86
    v_mul_f32 v183, v183, v87
    v_exp_f32 v180, v180
    v_mfma_f32_32x32x16_bf16 v[100:115], v[64:67], a[20:23], v[100:115]
    s_waitcnt vmcnt(17)
    s_barrier
    ds_read_b64_tr_b16 v[52:53], v135 offset:8192
    ds_read_b64_tr_b16 v[54:55], v135 offset:8448
    v_mul_f32 v184, v88, v88
    v_exp_f32 v181, v181
    s_waitcnt lgkmcnt(2)
    v_mfma_f32_32x32x16_bf16 v[100:115], v[44:47], a[24:27], v[100:115]
    s_add_u32 m0, s74, 28672
    ds_read_b64_tr_b16 v[56:57], v135 offset:9216
    ds_read_b64_tr_b16 v[58:59], v135 offset:9472
    buffer_load_dwordx4 v134, s[12:15], s67 offen lds
    v_mul_f32 v185, v89, v89
    v_exp_f32 v182, v182
    v_mfma_f32_32x32x16_bf16 v[100:115], v[48:51], a[28:31], v[100:115]
    s_add_u32 m0, s90, 81920
    ds_read_b64_tr_b16 v[60:61], v136 offset:8192
    ds_read_b64_tr_b16 v[62:63], v136 offset:8448
    buffer_load_dwordx4 v17, s[20:23], s88 offen offset:2048 lds
    v_mul_f32 v186, v90, v90
    v_exp_f32 v183, v183
    s_waitcnt lgkmcnt(2)
    v_smfmac_f32_16x16x64_bf16 v[40:43], v[24:27], v[52:59], v23
    v_mul_f32 v187, v91, v91
    v_fma_f32 v180, v180, v152, v152
    v_fma_f32 v184, v184, v148, v144
    v_mfma_f32_32x32x16_bf16 v[100:115], v[52:55], a[32:35], v[100:115]
    ds_read_b64_tr_b16 v[64:65], v136 offset:9216
    ds_read_b64_tr_b16 v[66:67], v136 offset:9472
    buffer_load_dwordx4 v18, s[20:23], s88 offen offset:3072 lds
    s_add_u32 s88, s88, 32768
    s_cmp_eq_u32 s88, s78
    s_cselect_b32 s88, 0, s88
    v_fma_f32 v181, v181, v152, v152
    v_fma_f32 v185, v185, v148, v144
    v_mfma_f32_32x32x16_bf16 v[100:115], v[56:59], a[36:39], v[100:115]
    s_add_u32 m0, s90, 32768
    ds_read_b64_tr_b16 v[44:45], v135 offset:12288
    ds_read_b64_tr_b16 v[46:47], v135 offset:12544
    buffer_load_dwordx4 v15, s[20:23], s88 offen offset:0 lds
    v_fma_f32 v182, v182, v152, v152
    v_fma_f32 v186, v186, v148, v144
    s_waitcnt lgkmcnt(2)
    v_mfma_f32_32x32x16_bf16 v[100:115], v[60:63], a[40:43], v[100:115]
    ds_read_b64_tr_b16 v[48:49], v135 offset:13312
    ds_read_b64_tr_b16 v[50:51], v135 offset:13568
    buffer_load_dwordx4 v16, s[20:23], s88 offen offset:1024 lds
    v_fma_f32 v183, v183, v152, v152
    v_fma_f32 v187, v187, v148, v144
    v_rcp_f32 v180, v180
    v_mfma_f32_32x32x16_bf16 v[100:115], v[64:67], a[44:47], v[100:115]
    ds_read_b64_tr_b16 v[52:53], v136 offset:12288
    ds_read_b64_tr_b16 v[54:55], v136 offset:12544
    v_mul_f32 v184, v184, v88
    v_rcp_f32 v181, v181
    v_mul_f32 v185, v185, v89
    v_rcp_f32 v182, v182
    s_waitcnt lgkmcnt(2)
    v_smfmac_f32_16x16x64_bf16 v[40:43], v[24:27], v[44:51], v23
    v_mul_f32 v186, v186, v90
    v_rcp_f32 v183, v183
    v_mul_f32 v187, v187, v91
    v_mfma_f32_32x32x16_bf16 v[100:115], v[44:47], a[48:51], v[100:115]
    ds_read_b64_tr_b16 v[56:57], v136 offset:13312
    ds_read_b64_tr_b16 v[58:59], v136 offset:13568
    buffer_load_dwordx4 v17, s[20:23], s88 offen offset:2048 lds
    buffer_load_dword v9, off, s[28:31], 0 sc1
    v_mul_f32 v180, v180, v84
    v_exp_f32 v184, v184
    v_mfma_f32_32x32x16_bf16 v[100:115], v[48:51], a[52:55], v[100:115]
    s_waitcnt vmcnt(16)
    s_barrier
    ds_read_b64_tr_b16 v[60:61], v135 offset:16384
    ds_read_b64_tr_b16 v[62:63], v135 offset:16640
    v_mul_f32 v181, v181, v85
    v_exp_f32 v185, v185
    s_waitcnt lgkmcnt(2)
    v_mfma_f32_32x32x16_bf16 v[100:115], v[52:55], a[56:59], v[100:115]
    ds_read_b64_tr_b16 v[64:65], v135 offset:17408
    ds_read_b64_tr_b16 v[66:67], v135 offset:17664
    buffer_load_dwordx4 v18, s[20:23], s88 offen offset:3072 lds
    s_add_u32 s88, s88, 32768
    s_cmp_eq_u32 s88, s78
    s_cselect_b32 s88, 0, s88
    v_mul_f32 v182, v182, v86
    v_exp_f32 v186, v186
    v_mfma_f32_32x32x16_bf16 v[100:115], v[56:59], a[60:63], v[100:115]
    ds_read_b64_tr_b16 v[44:45], v136 offset:16384
    ds_read_b64_tr_b16 v[46:47], v136 offset:16640
    v_mul_f32 v183, v183, v87
    v_exp_f32 v187, v187
    v_cvt_pk_bf16_f32 v188, v180, v181
    v_fma_f32 v184, v184, v152, v152
    s_waitcnt lgkmcnt(2)
    v_smfmac_f32_16x16x64_bf16 v[40:43], v[24:27], v[60:67], v23
    v_cvt_pk_bf16_f32 v189, v182, v183
    v_fma_f32 v185, v185, v152, v152
    v_fma_f32 v186, v186, v152, v152
    v_fma_f32 v187, v187, v152, v152
    v_mfma_f32_32x32x16_bf16 v[100:115], v[60:63], a[64:67], v[100:115]
    s_add_u32 m0, s90, 131072
    ds_read_b64_tr_b16 v[48:49], v136 offset:17408
    ds_read_b64_tr_b16 v[50:51], v136 offset:17664
    buffer_load_dwordx4 v15, s[20:23], s88 offen offset:0 lds
    v_rcp_f32 v184, v184
    v_rcp_f32 v185, v185
    v_mfma_f32_32x32x16_bf16 v[100:115], v[64:67], a[68:71], v[100:115]
    ds_read_b64_tr_b16 v[52:53], v135 offset:20480
    ds_read_b64_tr_b16 v[54:55], v135 offset:20736
    buffer_load_dwordx4 v16, s[20:23], s88 offen offset:1024 lds
    v_rcp_f32 v186, v186
    v_rcp_f32 v187, v187
    s_waitcnt lgkmcnt(2)
    v_mfma_f32_32x32x16_bf16 v[100:115], v[44:47], a[72:75], v[100:115]
    ds_read_b64_tr_b16 v[56:57], v135 offset:21504
    ds_read_b64_tr_b16 v[58:59], v135 offset:21760
    v_mul_f32 v184, v184, v88
    v_mul_f32 v185, v185, v89
    v_mul_f32 v186, v186, v90
    v_mul_f32 v187, v187, v91
    v_cvt_pk_bf16_f32 v190, v184, v185
    v_cvt_pk_bf16_f32 v191, v186, v187
    v_mfma_f32_32x32x16_bf16 v[100:115], v[48:51], a[76:79], v[100:115]
    ds_read_b64_tr_b16 v[60:61], v136 offset:20480
    ds_read_b64_tr_b16 v[62:63], v136 offset:20736
    buffer_load_dwordx4 v17, s[20:23], s88 offen offset:2048 lds
    buffer_store_dwordx4 v[188:191], v8, s[16:19], s76 offen offset:0 sc1
    v_mul_f32 v180, v92, v92
    s_waitcnt lgkmcnt(2)
    v_smfmac_f32_16x16x64_bf16 v[40:43], v[24:27], v[52:59], v23
    v_mul_f32 v181, v93, v93
    v_mul_f32 v182, v94, v94
    v_mul_f32 v183, v95, v95
    v_fma_f32 v180, v180, v148, v144
    v_mfma_f32_32x32x16_bf16 v[100:115], v[52:55], a[80:83], v[100:115]
    ds_read_b64_tr_b16 v[64:65], v136 offset:21504
    ds_read_b64_tr_b16 v[66:67], v136 offset:21760
    buffer_load_dwordx4 v18, s[20:23], s88 offen offset:3072 lds
    s_add_u32 s88, s88, 32768
    s_cmp_eq_u32 s88, s78
    s_cselect_b32 s88, 0, s88
    v_fma_f32 v181, v181, v148, v144
    v_fma_f32 v182, v182, v148, v144
    v_fma_f32 v183, v183, v148, v144
    v_mfma_f32_32x32x16_bf16 v[100:115], v[56:59], a[84:87], v[100:115]
    s_waitcnt vmcnt(12)
    s_barrier
    ds_read_b64_tr_b16 v[44:45], v135 offset:24576
    ds_read_b64_tr_b16 v[46:47], v135 offset:24832
    v_mul_f32 v180, v180, v92
    v_mul_f32 v181, v181, v93
    v_mul_f32 v182, v182, v94
    s_waitcnt lgkmcnt(2)
    v_mfma_f32_32x32x16_bf16 v[100:115], v[60:63], a[88:91], v[100:115]
    s_add_u32 m0, s90, 49152
    ds_read_b64_tr_b16 v[48:49], v135 offset:25600
    ds_read_b64_tr_b16 v[50:51], v135 offset:25856
    buffer_load_dwordx4 v15, s[20:23], s88 offen offset:0 lds
    v_mul_f32 v183, v183, v95
    v_exp_f32 v180, v180
    v_mul_f32 v184, v96, v96
    v_mfma_f32_32x32x16_bf16 v[100:115], v[64:67], a[92:95], v[100:115]
    ds_read_b64_tr_b16 v[52:53], v136 offset:24576
    ds_read_b64_tr_b16 v[54:55], v136 offset:24832
    buffer_load_dwordx4 v16, s[20:23], s88 offen offset:1024 lds
    v_exp_f32 v181, v181
    v_mul_f32 v185, v97, v97
    v_exp_f32 v182, v182
    s_waitcnt lgkmcnt(2)
    v_smfmac_f32_16x16x64_bf16 v[40:43], v[24:27], v[44:51], v23
    v_mul_f32 v186, v98, v98
    v_exp_f32 v183, v183
    v_mul_f32 v187, v99, v99
    v_mfma_f32_32x32x16_bf16 v[100:115], v[44:47], a[96:99], v[100:115]
    ds_read_b64_tr_b16 v[56:57], v136 offset:25600
    ds_read_b64_tr_b16 v[58:59], v136 offset:25856
    v_fma_f32 v180, v180, v152, v152
    v_fma_f32 v184, v184, v148, v144
    v_fma_f32 v181, v181, v152, v152
    v_fma_f32 v185, v185, v148, v144
    v_fma_f32 v182, v182, v152, v152
    v_fma_f32 v186, v186, v148, v144
    v_fma_f32 v183, v183, v152, v152
    v_mfma_f32_32x32x16_bf16 v[100:115], v[48:51], a[100:103], v[100:115]
    ds_read_b64_tr_b16 v[60:61], v135 offset:28672
    ds_read_b64_tr_b16 v[62:63], v135 offset:28928
    buffer_load_dwordx4 v17, s[20:23], s88 offen offset:2048 lds
    v_fma_f32 v187, v187, v148, v144
    v_rcp_f32 v180, v180
    v_mul_f32 v184, v184, v96
    s_waitcnt lgkmcnt(2)
    v_mfma_f32_32x32x16_bf16 v[100:115], v[52:55], a[104:107], v[100:115]
    ds_read_b64_tr_b16 v[64:65], v135 offset:29696
    ds_read_b64_tr_b16 v[66:67], v135 offset:29952
    buffer_load_dwordx4 v18, s[20:23], s88 offen offset:3072 lds
    s_add_u32 s88, s88, 32768
    s_cmp_eq_u32 s88, s78
    s_cselect_b32 s88, 0, s88
    v_rcp_f32 v181, v181
    v_mul_f32 v185, v185, v97
    v_mfma_f32_32x32x16_bf16 v[100:115], v[56:59], a[108:111], v[100:115]
    ds_read_b64_tr_b16 v[44:45], v136 offset:28672
    ds_read_b64_tr_b16 v[46:47], v136 offset:28928
    v_rcp_f32 v182, v182
    v_mul_f32 v186, v186, v98
    v_rcp_f32 v183, v183
    v_mul_f32 v187, v187, v99
    s_waitcnt lgkmcnt(2)
    v_smfmac_f32_16x16x64_bf16 v[40:43], v[24:27], v[60:67], v23
    v_mul_f32 v180, v180, v92
    v_exp_f32 v184, v184
    v_mul_f32 v181, v181, v93
    v_mfma_f32_32x32x16_bf16 v[100:115], v[60:63], a[112:115], v[100:115]
    ds_read_b64_tr_b16 v[48:49], v136 offset:29696
    ds_read_b64_tr_b16 v[50:51], v136 offset:29952
    v_exp_f32 v185, v185
    v_mul_f32 v182, v182, v94
    v_exp_f32 v186, v186
    v_mul_f32 v183, v183, v95
    v_exp_f32 v187, v187
    v_mfma_f32_32x32x16_bf16 v[100:115], v[64:67], a[116:119], v[100:115]
    v_cvt_pk_bf16_f32 v192, v180, v181
    v_fma_f32 v184, v184, v152, v152
    v_cvt_pk_bf16_f32 v193, v182, v183
    v_fma_f32 v185, v185, v152, v152
    v_fma_f32 v186, v186, v152, v152
    v_fma_f32 v187, v187, v152, v152
    v_rcp_f32 v184, v184
    s_waitcnt lgkmcnt(0)
    v_mfma_f32_32x32x16_bf16 v[100:115], v[44:47], a[120:123], v[100:115]
    v_add_f32 v1, v40, v41
    v_rcp_f32 v185, v185
    v_rcp_f32 v186, v186
    v_rcp_f32 v187, v187
    v_mul_f32 v184, v184, v96
    v_mul_f32 v185, v185, v97
    v_mfma_f32_32x32x16_bf16 v[100:115], v[48:51], a[124:127], v[100:115]
    ds_write_b32 v132, v1
    v_mul_f32 v186, v186, v98
    v_mul_f32 v187, v187, v99
    v_cvt_pk_bf16_f32 v194, v184, v185
    v_cvt_pk_bf16_f32 v195, v186, v187
    buffer_store_dwordx4 v[192:195], v8, s[16:19], s76 offen offset:2048 sc1
    s_waitcnt lgkmcnt(0)
    s_barrier
    ds_read_b32 v2, v133
    s_waitcnt lgkmcnt(0)
    v_add_f32 v1, v1, v2
    v_and_b32 v2, 0xffff0000, v1
    v_sub_f32 v1, v1, v2
    v_cvt_pk_bf16_f32 v36, v2, v1
    v_mov_b32 v37, v140
    s_nop 1
    v_mfma_f32_32x32x16_bf16 v[100:115], v[36:39], v[28:31], v[100:115]
    s_add_u32 m0, s90, 0
    s_nop 0
    buffer_load_dwordx4 v15, s[20:23], s88 offen offset:0 lds
    s_nop 8
    v_pk_mul_f32 v[180:181], v[100:101], v[100:101]
    v_pk_mul_f32 v[184:185], v[104:105], v[104:105]
    v_pk_mul_f32 v[182:183], v[102:103], v[102:103]
    v_pk_mul_f32 v[186:187], v[106:107], v[106:107]
    v_pk_fma_f32 v[180:181], v[180:181], v[146:147], v[142:143] op_sel_hi:[1,0,0]
    v_pk_fma_f32 v[184:185], v[184:185], v[146:147], v[142:143] op_sel_hi:[1,0,0]
    v_pk_fma_f32 v[182:183], v[182:183], v[146:147], v[142:143] op_sel_hi:[1,0,0]
    v_pk_fma_f32 v[186:187], v[186:187], v[146:147], v[142:143] op_sel_hi:[1,0,0]
    v_pk_mul_f32 v[180:181], v[180:181], v[100:101]
    v_pk_mul_f32 v[184:185], v[184:185], v[104:105]
    v_pk_mul_f32 v[182:183], v[182:183], v[102:103]
    v_pk_mul_f32 v[186:187], v[186:187], v[106:107]
    v_exp_f32 v180, v180
    v_exp_f32 v184, v184
    v_exp_f32 v181, v181
    v_exp_f32 v185, v185
    v_exp_f32 v182, v182
    v_exp_f32 v186, v186
    v_exp_f32 v183, v183
    v_exp_f32 v187, v187
    v_pk_fma_f32 v[180:181], v[180:181], v[150:151], v[150:151] op_sel_hi:[1,0,0]
    v_pk_fma_f32 v[184:185], v[184:185], v[150:151], v[150:151] op_sel_hi:[1,0,0]
    v_pk_fma_f32 v[182:183], v[182:183], v[150:151], v[150:151] op_sel_hi:[1,0,0]
    v_pk_fma_f32 v[186:187], v[186:187], v[150:151], v[150:151] op_sel_hi:[1,0,0]
    v_rcp_f32 v180, v180
    v_rcp_f32 v184, v184
    v_rcp_f32 v181, v181
    v_rcp_f32 v185, v185
    v_rcp_f32 v182, v182
    v_rcp_f32 v186, v186
    v_rcp_f32 v183, v183
    v_rcp_f32 v187, v187
    v_pk_mul_f32 v[180:181], v[180:181], v[100:101]
    v_pk_mul_f32 v[184:185], v[184:185], v[104:105]
    v_pk_mul_f32 v[182:183], v[182:183], v[102:103]
    buffer_load_dwordx4 v16, s[20:23], s88 offen offset:1024 lds
    v_pk_mul_f32 v[186:187], v[186:187], v[106:107]
    v_cvt_pk_bf16_f32 v188, v180, v181
    v_cvt_pk_bf16_f32 v190, v184, v185
    v_cvt_pk_bf16_f32 v189, v182, v183
    v_cvt_pk_bf16_f32 v191, v186, v187
    buffer_store_dwordx4 v[188:191], v8, s[16:19], s91 offen offset:0 sc1
    v_pk_mul_f32 v[180:181], v[108:109], v[108:109]
    v_pk_mul_f32 v[184:185], v[112:113], v[112:113]
    v_pk_mul_f32 v[182:183], v[110:111], v[110:111]
    v_pk_mul_f32 v[186:187], v[114:115], v[114:115]
    v_pk_fma_f32 v[180:181], v[180:181], v[146:147], v[142:143] op_sel_hi:[1,0,0]
    v_pk_fma_f32 v[184:185], v[184:185], v[146:147], v[142:143] op_sel_hi:[1,0,0]
    v_pk_fma_f32 v[182:183], v[182:183], v[146:147], v[142:143] op_sel_hi:[1,0,0]
    v_pk_fma_f32 v[186:187], v[186:187], v[146:147], v[142:143] op_sel_hi:[1,0,0]
    v_pk_mul_f32 v[180:181], v[180:181], v[108:109]
    v_pk_mul_f32 v[184:185], v[184:185], v[112:113]
    v_pk_mul_f32 v[182:183], v[182:183], v[110:111]
    v_pk_mul_f32 v[186:187], v[186:187], v[114:115]
    v_exp_f32 v180, v180
    v_exp_f32 v184, v184
    v_exp_f32 v181, v181
    v_exp_f32 v185, v185
    v_exp_f32 v182, v182
    v_exp_f32 v186, v186
    v_exp_f32 v183, v183
    v_exp_f32 v187, v187
    v_pk_fma_f32 v[180:181], v[180:181], v[150:151], v[150:151] op_sel_hi:[1,0,0]
    v_pk_fma_f32 v[184:185], v[184:185], v[150:151], v[150:151] op_sel_hi:[1,0,0]
    v_pk_fma_f32 v[182:183], v[182:183], v[150:151], v[150:151] op_sel_hi:[1,0,0]
    v_pk_fma_f32 v[186:187], v[186:187], v[150:151], v[150:151] op_sel_hi:[1,0,0]
    v_rcp_f32 v180, v180
    v_rcp_f32 v184, v184
    v_rcp_f32 v181, v181
    v_rcp_f32 v185, v185
    v_rcp_f32 v182, v182
    v_rcp_f32 v186, v186
    v_rcp_f32 v183, v183
    v_rcp_f32 v187, v187
    v_pk_mul_f32 v[180:181], v[180:181], v[108:109]
    v_pk_mul_f32 v[184:185], v[184:185], v[112:113]
    v_pk_mul_f32 v[182:183], v[182:183], v[110:111]
    v_pk_mul_f32 v[186:187], v[186:187], v[114:115]
    v_cvt_pk_bf16_f32 v192, v180, v181
    v_cvt_pk_bf16_f32 v194, v184, v185
    v_cvt_pk_bf16_f32 v193, v182, v183
    v_cvt_pk_bf16_f32 v195, v186, v187
    buffer_store_dwordx4 v[192:195], v8, s[16:19], s91 offen offset:2048 sc1
    buffer_load_dwordx4 v17, s[20:23], s88 offen offset:2048 lds
    ds_read_b64_tr_b16 a[160:161], v21 offset:32768
    ds_read_b64_tr_b16 a[162:163], v21 offset:33792
    ds_read_b64_tr_b16 a[164:165], v22 offset:32768
    ds_read_b64_tr_b16 a[166:167], v22 offset:33792
    buffer_load_dwordx4 v18, s[20:23], s88 offen offset:3072 lds
    s_add_u32 s88, s88, 32768
    s_cmp_eq_u32 s88, s78
    s_cselect_b32 s88, 0, s88
    ds_read_b64_tr_b16 a[168:169], v19 offset:32768
    ds_read_b64_tr_b16 a[170:171], v19 offset:33792
    ds_read_b64_tr_b16 a[172:173], v20 offset:32768
    ds_read_b64_tr_b16 a[174:175], v20 offset:33792
    v_mov_b32 v4, 1
    s_add_u32 m0, s90, 16384
    s_nop 0
    buffer_load_dwordx4 v15, s[20:23], s88 offen offset:0 lds
    s_lshl_b32 s83, s83, 8
    s_add_u32 s83, s83, 10485760
    s_cmp_eq_u32 s4, 0
    s_cselect_b32 s42, 12582912, 0
    buffer_load_dwordx4 v16, s[20:23], s88 offen offset:1024 lds
    buffer_load_dwordx4 v17, s[20:23], s88 offen offset:2048 lds
    buffer_load_dwordx4 v18, s[20:23], s88 offen offset:3072 lds
    s_add_u32 s88, s88, 32768
    s_cmp_eq_u32 s88, s78
    s_cselect_b32 s88, 0, s88
    s_waitcnt lgkmcnt(0)
    s_add_u32 m0, s90, 98304
    s_nop 0
    buffer_load_dwordx4 v15, s[20:23], s88 offen offset:0 lds
    buffer_load_dwordx4 v16, s[20:23], s88 offen offset:1024 lds
    s_waitcnt vmcnt(23)
    v_readfirstlane_b32 s3, v9
    s_nop 3
    s_cmp_eq_u32 s3, 0
    s_cbranch_scc1 L_f_rdy_retry
L_f_rdy_ok:
    s_waitcnt vmcnt(8)
    s_barrier
    buffer_store_dword v4, off, s[40:43], s83 sc1
    s_cmp_eq_u32 s4, 0
    s_cbranch_scc1 L_f_w0
    v_and_b32 v1, 15, v0
    s_lshl_b32 s77, s71, 7
    v_lshl_add_u32 v1, v1, 3, s77
    s_lshl_b32 s77, s70, 5
    s_add_u32 s77, s77, s4
    s_lshl_b32 s77, s77, 11
    v_and_b32 v2, 48, v0
    v_lshlrev_b32 v2, 9, v2
    v_add3_u32 v25, v1, v2, s77
    s_mov_b32 s76, 0x8000
    buffer_load_dwordx2 v[112:113], v1, s[36:39], 0 offen
    ds_read_b64_tr_b16 a[176:177], v21 offset:49152
    ds_read_b64_tr_b16 a[178:179], v21 offset:50176
    ds_read_b64_tr_b16 a[180:181], v22 offset:49152
    ds_read_b64_tr_b16 a[182:183], v22 offset:50176
    ds_read_b64_tr_b16 a[184:185], v19 offset:49152
    ds_read_b64_tr_b16 a[186:187], v19 offset:50176
    buffer_load_dwordx2 v[104:105], v25, s[8:11], 0 offen offset:0
    ds_read_b64_tr_b16 a[188:189], v20 offset:49152
    ds_read_b64_tr_b16 a[190:191], v20 offset:50176
    v_add_u32 v30, 65536, v21
    v_add_u32 v31, 65536, v22
    v_add_u32 v32, 65536, v19
    v_add_u32 v33, 65536, v20
    buffer_load_dwordx2 v[106:107], v25, s[8:11], s76 offen offset:0
    ds_read_b64_tr_b16 a[192:193], v30 offset:16384
    ds_read_b64_tr_b16 a[194:195], v30 offset:17408
    ds_read_b64_tr_b16 a[196:197], v31 offset:16384
    ds_read_b64_tr_b16 a[198:199], v31 offset:17408
    ds_read_b64_tr_b16 a[200:201], v32 offset:16384
    ds_read_b64_tr_b16 a[202:203], v32 offset:17408
    ds_read_b64_tr_b16 a[204:205], v33 offset:16384
    buffer_load_dwordx2 v[108:109], v25, s[8:11], 0 offen offset:1024
    ds_read_b64_tr_b16 a[206:207], v33 offset:17408
    ds_read_b64_tr_b16 a[208:209], v21 offset:0
    ds_read_b64_tr_b16 a[210:211], v21 offset:1024
    ds_read_b64_tr_b16 a[212:213], v22 offset:0
    ds_read_b64_tr_b16 a[214:215], v22 offset:1024
    ds_read_b64_tr_b16 a[216:217], v19 offset:0
    buffer_load_dwordx2 v[110:111], v25, s[8:11], s76 offen offset:1024
    ds_read_b64_tr_b16 a[218:219], v19 offset:1024
    ds_read_b64_tr_b16 a[220:221], v20 offset:0
    ds_read_b64_tr_b16 a[222:223], v20 offset:1024
    ds_read_b64_tr_b16 a[224:225], v21 offset:16384
    ds_read_b64_tr_b16 a[226:227], v21 offset:17408
    ds_read_b64_tr_b16 a[228:229], v22 offset:16384
    buffer_load_dwordx4 v17, s[20:23], s88 offen offset:2048 lds
    ds_read_b64_tr_b16 a[230:231], v22 offset:17408
    ds_read_b64_tr_b16 a[232:233], v19 offset:16384
    ds_read_b64_tr_b16 a[234:235], v19 offset:17408
    ds_read_b64_tr_b16 a[236:237], v20 offset:16384
    ds_read_b64_tr_b16 a[238:239], v20 offset:17408
    v_add_u32 v26, -65536, v21
    v_add_u32 v27, -65536, v22
    buffer_load_dwordx4 v18, s[20:23], s88 offen offset:3072 lds
    s_add_u32 s88, s88, 32768
    s_cmp_eq_u32 s88, s78
    s_cselect_b32 s88, 0, s88
    v_add_u32 v28, -65536, v19
    v_add_u32 v29, -65536, v20
    ds_read_b64_tr_b16 a[240:241], v26 offset:32768
    ds_read_b64_tr_b16 a[242:243], v26 offset:33792
    ds_read_b64_tr_b16 a[244:245], v27 offset:32768
    ds_read_b64_tr_b16 a[246:247], v27 offset:33792
    s_waitcnt lgkmcnt(15)
    s_add_u32 m0, s90, 114688
    s_nop 0
    buffer_load_dwordx4 v15, s[20:23], s88 offen offset:0 lds
    ds_read_b64_tr_b16 a[248:249], v28 offset:32768
    ds_read_b64_tr_b16 a[250:251], v28 offset:33792
    ds_read_b64_tr_b16 a[252:253], v29 offset:32768
    ds_read_b64_tr_b16 a[254:255], v29 offset:33792
    s_lshr_b32 s91, s70, 1
    s_lshl_b32 s91, s91, 12
    s_add_u32 s91, s91, 10485760
    buffer_load_dwordx4 v16, s[20:23], s88 offen offset:1024 lds
    v_lshlrev_b32 v3, 8, v0
    s_mov_b32 s93, 0
    s_cmp_eq_u32 s4, 2
    s_cselect_b32 s92, 0x3c, 7
    s_cmp_eq_u32 s4, 3
    s_cselect_b32 s92, 0xe0, s92
    buffer_load_dwordx4 v17, s[20:23], s88 offen offset:2048 lds
    ds_read_b64_tr_b16 a[0:1], v30 offset:0
    ds_read_b64_tr_b16 a[2:3], v30 offset:1024
    ds_read_b64_tr_b16 a[4:5], v31 offset:0
    ds_read_b64_tr_b16 a[6:7], v31 offset:1024
    ds_read_b64_tr_b16 a[8:9], v32 offset:0
    ds_read_b64_tr_b16 a[10:11], v32 offset:1024
    ds_read_b64_tr_b16 a[12:13], v33 offset:0
    buffer_load_dwordx4 v18, s[20:23], s88 offen offset:3072 lds
    s_add_u32 s88, s88, 32768
    s_cmp_eq_u32 s88, s78
    s_cselect_b32 s88, 0, s88
    ds_read_b64_tr_b16 a[14:15], v33 offset:1024
    ds_read_b64_tr_b16 a[16:17], v26 offset:49152
    ds_read_b64_tr_b16 a[18:19], v26 offset:50176
    ds_read_b64_tr_b16 a[20:21], v27 offset:49152
    ds_read_b64_tr_b16 a[22:23], v27 offset:50176
    ds_read_b64_tr_b16 a[24:25], v28 offset:49152
    s_add_u32 m0, s90, 147456
    s_nop 0
    buffer_load_dwordx4 v15, s[20:23], s88 offen offset:0 lds
    ds_read_b64_tr_b16 a[26:27], v28 offset:50176
    ds_read_b64_tr_b16 a[28:29], v29 offset:49152
    ds_read_b64_tr_b16 a[30:31], v29 offset:50176
    s_waitcnt vmcnt(19)
    ds_read_b64_tr_b16 a[32:33], v26 offset:0
    ds_read_b64_tr_b16 a[34:35], v26 offset:1024
    ds_read_b64_tr_b16 a[36:37], v27 offset:0
    buffer_load_dwordx4 v16, s[20:23], s88 offen offset:1024 lds
    ds_read_b64_tr_b16 a[38:39], v27 offset:1024
    ds_read_b64_tr_b16 a[40:41], v28 offset:0
    ds_read_b64_tr_b16 a[42:43], v28 offset:1024
    ds_read_b64_tr_b16 a[44:45], v29 offset:0
    ds_read_b64_tr_b16 a[46:47], v29 offset:1024
    s_waitcnt vmcnt(16)
    ds_read_b64_tr_b16 a[48:49], v26 offset:16384
    buffer_load_dwordx4 v17, s[20:23], s88 offen offset:2048 lds
    ds_read_b64_tr_b16 a[50:51], v26 offset:17408
    ds_read_b64_tr_b16 a[52:53], v27 offset:16384
    ds_read_b64_tr_b16 a[54:55], v27 offset:17408
    ds_read_b64_tr_b16 a[56:57], v28 offset:16384
    ds_read_b64_tr_b16 a[58:59], v28 offset:17408
    ds_read_b64_tr_b16 a[60:61], v29 offset:16384
    ds_read_b64_tr_b16 a[62:63], v29 offset:17408
    buffer_load_dwordx4 v18, s[20:23], s88 offen offset:3072 lds
    s_add_u32 s88, s88, 32768
    s_cmp_eq_u32 s88, s78
    s_cselect_b32 s88, 0, s88
    v_and_b32 v23, 15, v0
    v_lshlrev_b32 v23, 4, v23
    v_and_b32 v24, 16, v0
    v_lshl_add_u32 v23, v24, 5, v23
    v_and_b32 v24, 32, v0
    v_lshl_add_u32 v34, v24, 6, v23
    v_bfe_u32 v24, v0, 2, 1
    s_waitcnt lgkmcnt(15)
    s_add_u32 m0, s90, 65536
    s_nop 0
    buffer_load_dwordx4 v15, s[20:23], s88 offen offset:0 lds
    v_xor_b32 v24, v24, v0
    v_and_b32 v24, 3, v24
    v_and_b32 v23, 12, v0
    v_lshlrev_b32 v23, 8, v23
    v_lshl_add_u32 v23, v24, 4, v23
    v_and_b32 v24, 48, v0
    v_lshl_add_u32 v23, v24, 2, v23
    buffer_load_dwordx4 v16, s[20:23], s88 offen offset:1024 lds
    s_waitcnt vmcnt(10)
    ds_read_b64_tr_b16 a[64:65], v21 offset:32768
    ds_read_b64_tr_b16 a[66:67], v21 offset:33792
    ds_read_b64_tr_b16 a[68:69], v22 offset:32768
    ds_read_b64_tr_b16 a[70:71], v22 offset:33792
    ds_read_b64_tr_b16 a[72:73], v19 offset:32768
    ds_read_b64_tr_b16 a[74:75], v19 offset:33792
    buffer_load_dwordx4 v17, s[20:23], s88 offen offset:2048 lds
    ds_read_b64_tr_b16 a[76:77], v20 offset:32768
    ds_read_b64_tr_b16 a[78:79], v20 offset:33792
    v_lshl_add_u32 v23, s4, 8, v23
    v_mov_b32 v36, 0xbfb8aa3b
    v_mov_b32 v38, 1.0
    s_add_u32 s52, s89, 4096
    s_cmp_eq_u32 s52, s79
    s_cselect_b32 s52, 0, s52
    buffer_load_dwordx4 v18, s[20:23], s88 offen offset:3072 lds
    s_add_u32 s88, s88, 32768
    s_cmp_eq_u32 s88, s78
    s_cselect_b32 s88, 0, s88
    s_add_u32 s53, s52, 4096
    s_cmp_eq_u32 s53, s79
    s_cselect_b32 s53, 0, s53
    s_add_u32 s54, s53, 4096
    s_cmp_eq_u32 s54, s79
    s_cselect_b32 s54, 0, s54
    s_add_u32 s55, s54, 4096
    s_cmp_eq_u32 s55, s79
    s_cselect_b32 s55, 0, s55
    s_add_u32 m0, s90, 81920
    s_nop 0
    buffer_load_dwordx4 v15, s[20:23], s88 offen offset:0 lds
    s_add_u32 s56, s55, 4096
    s_cmp_eq_u32 s56, s79
    s_cselect_b32 s56, 0, s56
    s_add_u32 s57, s56, 4096
    s_cmp_eq_u32 s57, s79
    s_cselect_b32 s57, 0, s57
    s_add_u32 s58, s57, 4096
    s_cmp_eq_u32 s58, s79
    s_cselect_b32 s58, 0, s58
    buffer_load_dwordx4 v16, s[20:23], s88 offen offset:1024 lds
    s_waitcnt vmcnt(10)
    ds_read_b64_tr_b16 a[80:81], v21 offset:49152
    ds_read_b64_tr_b16 a[82:83], v21 offset:50176
    ds_read_b64_tr_b16 a[84:85], v22 offset:49152
    ds_read_b64_tr_b16 a[86:87], v22 offset:50176
    ds_read_b64_tr_b16 a[88:89], v19 offset:49152
    ds_read_b64_tr_b16 a[90:91], v19 offset:50176
    buffer_load_dwordx4 v17, s[20:23], s88 offen offset:2048 lds
    ds_read_b64_tr_b16 a[92:93], v20 offset:49152
    ds_read_b64_tr_b16 a[94:95], v20 offset:50176
    s_add_u32 s59, s58, 4096
    s_cmp_eq_u32 s59, s79
    s_cselect_b32 s59, 0, s59
    s_add_u32 s60, s59, 4096
    s_cmp_eq_u32 s60, s79
    s_cselect_b32 s60, 0, s60
    buffer_load_dwordx4 v18, s[20:23], s88 offen offset:3072 lds
    s_add_u32 s88, s88, 32768
    s_cmp_eq_u32 s88, s78
    s_cselect_b32 s88, 0, s88
    s_add_u32 s61, s60, 4096
    s_cmp_eq_u32 s61, s79
    s_cselect_b32 s61, 0, s61
    s_add_u32 s62, s61, 4096
    s_cmp_eq_u32 s62, s79
    s_cselect_b32 s62, 0, s62
    s_add_u32 s63, s62, 4096
    s_cmp_eq_u32 s63, s79
    s_cselect_b32 s63, 0, s63
    s_add_u32 m0, s90, 32768
    s_nop 0
    buffer_load_dwordx4 v15, s[20:23], s88 offen offset:0 lds
    s_add_u32 s64, s63, 4096
    s_cmp_eq_u32 s64, s79
    s_cselect_b32 s64, 0, s64
    s_add_u32 s65, s64, 4096
    s_cmp_eq_u32 s65, s79
    s_cselect_b32 s65, 0, s65
    s_add_u32 s66, s65, 4096
    s_cmp_eq_u32 s66, s79
    s_cselect_b32 s66, 0, s66
    buffer_load_dwordx4 v16, s[20:23], s88 offen offset:1024 lds
    s_waitcnt vmcnt(10)
    ds_read_b64_tr_b16 a[96:97], v30 offset:16384
    ds_read_b64_tr_b16 a[98:99], v30 offset:17408
    ds_read_b64_tr_b16 a[100:101], v31 offset:16384
    ds_read_b64_tr_b16 a[102:103], v31 offset:17408
    ds_read_b64_tr_b16 a[104:105], v32 offset:16384
    ds_read_b64_tr_b16 a[106:107], v32 offset:17408
    s_mov_b64 exec, s[92:93]
    buffer_load_dword v4, v3, s[16:19], s91 offen sc1
    s_mov_b64 exec, -1
    ds_read_b64_tr_b16 a[108:109], v33 offset:16384
    ds_read_b64_tr_b16 a[110:111], v33 offset:17408
    s_add_u32 s67, s66, 4096
    s_cmp_eq_u32 s67, s79
    s_cselect_b32 s67, 0, s67
    s_add_u32 s73, s67, 4096
    s_cmp_eq_u32 s73, s79
    s_cselect_b32 s73, 0, s73
    buffer_load_dwordx4 v17, s[20:23], s88 offen offset:2048 lds
    s_add_u32 s75, s73, 4096
    s_cmp_eq_u32 s75, s79
    s_cselect_b32 s75, 0, s75
    buffer_load_dwordx4 v18, s[20:23], s88 offen offset:3072 lds
    s_add_u32 s88, s88, 32768
    s_cmp_eq_u32 s88, s78
    s_cselect_b32 s88, 0, s88
    s_add_u32 m0, s90, 131072
    s_nop 0
    buffer_load_dwordx4 v15, s[20:23], s88 offen offset:0 lds
    s_waitcnt vmcnt(10)
    ds_read_b64_tr_b16 a[112:113], v21 offset:0
    ds_read_b64_tr_b16 a[114:115], v21 offset:1024
    ds_read_b64_tr_b16 a[116:117], v22 offset:0
    ds_read_b64_tr_b16 a[118:119], v22 offset:1024
    ds_read_b64_tr_b16 a[120:121], v19 offset:0
    ds_read_b64_tr_b16 a[122:123], v19 offset:1024
    buffer_load_dwordx4 v16, s[20:23], s88 offen offset:1024 lds
    ds_read_b64_tr_b16 a[124:125], v20 offset:0
    ds_read_b64_tr_b16 a[126:127], v20 offset:1024
    buffer_load_dwordx4 v17, s[20:23], s88 offen offset:2048 lds
    buffer_load_dwordx4 v18, s[20:23], s88 offen offset:3072 lds
    s_add_u32 s88, s88, 32768
    s_cmp_eq_u32 s88, s78
    s_cselect_b32 s88, 0, s88
    s_waitcnt vmcnt(9)
    ds_read_b64_tr_b16 v[208:209], v21 offset:16384
    ds_read_b64_tr_b16 v[210:211], v21 offset:17408
    ds_read_b64_tr_b16 v[212:213], v22 offset:16384
    ds_read_b64_tr_b16 v[214:215], v22 offset:17408
    ds_read_b64_tr_b16 v[216:217], v19 offset:16384
    ds_read_b64_tr_b16 v[218:219], v19 offset:17408
    ds_read_b64_tr_b16 v[220:221], v20 offset:16384
    ds_read_b64_tr_b16 v[222:223], v20 offset:17408
    s_waitcnt vmcnt(6)
    v_cmp_ne_u32 vcc, 1, v4
    s_nop 4
    s_cbranch_vccnz L_f0_go_retry
L_f0_go_ok:
    buffer_load_dwordx4 v[140:143], v34, s[84:87], s89 offen offset:0 sc1
    buffer_load_dwordx4 v[144:147], v34, s[84:87], s52 offen offset:0 sc1
    buffer_load_dwordx4 v[148:151], v34, s[84:87], s53 offen offset:0 sc1
    buffer_load_dwordx4 v[152:155], v34, s[84:87], s54 offen offset:0 sc1
    buffer_load_dwordx4 v[156:159], v34, s[84:87], s55 offen offset:0 sc1
    buffer_load_dwordx4 v[160:163], v34, s[84:87], s56 offen offset:0 sc1
    buffer_load_dwordx4 v[164:167], v34, s[84:87], s57 offen offset:0 sc1
    buffer_load_dwordx4 v[168:171], v34, s[84:87], s58 offen offset:0 sc1
    buffer_load_dwordx4 v[172:175], v34, s[84:87], s59 offen offset:0 sc1
    buffer_load_dwordx4 v[176:179], v34, s[84:87], s60 offen offset:0 sc1
    buffer_load_dwordx4 v[180:183], v34, s[84:87], s61 offen offset:0 sc1
    buffer_load_dwordx4 v[184:187], v34, s[84:87], s62 offen offset:0 sc1
    s_mov_b32 m0, s90
    v_lshlrev_b32 v124, 16, v104
    v_and_b32 v125, 0xffff0000, v104
    v_lshlrev_b32 v126, 16, v105
    v_and_b32 v127, 0xffff0000, v105
    v_lshlrev_b32 v128, 16, v106
    v_and_b32 v129, 0xffff0000, v106
    v_lshlrev_b32 v130, 16, v107
    v_and_b32 v131, 0xffff0000, v107
    v_lshlrev_b32 v132, 16, v108
    v_and_b32 v133, 0xffff0000, v108
    v_lshlrev_b32 v134, 16, v109
    v_and_b32 v135, 0xffff0000, v109
    v_lshlrev_b32 v136, 16, v110
    v_and_b32 v137, 0xffff0000, v110
    v_lshlrev_b32 v138, 16, v111
    v_and_b32 v139, 0xffff0000, v111
    v_lshlrev_b32 v116, 16, v112
    v_and_b32 v117, 0xffff0000, v112
    v_lshlrev_b32 v118, 16, v113
    v_and_b32 v119, 0xffff0000, v113
    s_waitcnt vmcnt(11)
    v_mfma_f32_16x16x32_bf16 v[40:43], v[140:143], a[128:131], 0
    buffer_load_dwordx4 v[188:191], v34, s[84:87], s63 offen offset:0 sc1
    v_mfma_f32_16x16x32_bf16 v[44:47], v[140:143], a[132:135], 0
    ds_read_b64_tr_b16 v[224:225], v26 offset:32768
    ds_read_b64_tr_b16 v[226:227], v26 offset:33792
    v_mfma_f32_16x16x32_bf16 v[48:51], v[140:143], a[136:139], 0
    ds_read_b64_tr_b16 v[228:229], v27 offset:32768
    v_mfma_f32_16x16x32_bf16 v[52:55], v[140:143], a[140:143], 0
    ds_read_b64_tr_b16 v[230:231], v27 offset:33792
    s_waitcnt vmcnt(11)
    v_mfma_f32_16x16x32_bf16 v[40:43], v[144:147], a[144:147], v[40:43]
    buffer_load_dwordx4 v[192:195], v34, s[84:87], s64 offen offset:0 sc1
    v_mfma_f32_16x16x32_bf16 v[44:47], v[144:147], a[148:151], v[44:47]
    ds_read_b64_tr_b16 v[232:233], v28 offset:32768
    ds_read_b64_tr_b16 v[234:235], v28 offset:33792
    v_mfma_f32_16x16x32_bf16 v[48:51], v[144:147], a[152:155], v[48:51]
    ds_read_b64_tr_b16 v[236:237], v29 offset:32768
    v_mfma_f32_16x16x32_bf16 v[52:55], v[144:147], a[156:159], v[52:55]
    ds_read_b64_tr_b16 v[238:239], v29 offset:33792
    s_waitcnt vmcnt(11)
    v_mfma_f32_16x16x32_bf16 v[40:43], v[148:151], a[160:163], v[40:43]
    buffer_load_dwordx4 v[140:143], v34, s[84:87], s65 offen offset:0 sc1
    v_mfma_f32_16x16x32_bf16 v[44:47], v[148:151], a[164:167], v[44:47]
    ds_read_b64_tr_b16 v[240:241], v30 offset:0
    ds_read_b64_tr_b16 v[242:243], v30 offset:1024
    v_mfma_f32_16x16x32_bf16 v[48:51], v[148:151], a[168:171], v[48:51]
    ds_read_b64_tr_b16 v[244:245], v31 offset:0
    v_mfma_f32_16x16x32_bf16 v[52:55], v[148:151], a[172:175], v[52:55]
    ds_read_b64_tr_b16 v[246:247], v31 offset:1024
    s_waitcnt vmcnt(11)
    v_mfma_f32_16x16x32_bf16 v[40:43], v[152:155], a[176:179], v[40:43]
    buffer_load_dwordx4 v[144:147], v34, s[84:87], s66 offen offset:0 sc1
    v_mfma_f32_16x16x32_bf16 v[44:47], v[152:155], a[180:183], v[44:47]
    ds_read_b64_tr_b16 v[248:249], v32 offset:0
    ds_read_b64_tr_b16 v[250:251], v32 offset:1024
    v_mfma_f32_16x16x32_bf16 v[48:51], v[152:155], a[184:187], v[48:51]
    ds_read_b64_tr_b16 v[252:253], v33 offset:0
    v_mfma_f32_16x16x32_bf16 v[52:55], v[152:155], a[188:191], v[52:55]
    ds_read_b64_tr_b16 v[254:255], v33 offset:1024
    s_waitcnt vmcnt(11)
    v_mfma_f32_16x16x32_bf16 v[40:43], v[156:159], a[192:195], v[40:43]
    buffer_load_dwordx4 v[148:151], v34, s[84:87], s67 offen offset:0 sc1
    v_mfma_f32_16x16x32_bf16 v[44:47], v[156:159], a[196:199], v[44:47]
    v_mfma_f32_16x16x32_bf16 v[48:51], v[156:159], a[200:203], v[48:51]
    v_mfma_f32_16x16x32_bf16 v[52:55], v[156:159], a[204:207], v[52:55]
    s_waitcnt vmcnt(11)
    v_mfma_f32_16x16x32_bf16 v[40:43], v[160:163], a[208:211], v[40:43]
    buffer_load_dwordx4 v[152:155], v34, s[84:87], s73 offen offset:0 sc1
    v_mfma_f32_16x16x32_bf16 v[44:47], v[160:163], a[212:215], v[44:47]
    v_mfma_f32_16x16x32_bf16 v[48:51], v[160:163], a[216:219], v[48:51]
    v_mfma_f32_16x16x32_bf16 v[52:55], v[160:163], a[220:223], v[52:55]
    s_waitcnt vmcnt(11)
    v_mfma_f32_16x16x32_bf16 v[40:43], v[164:167], a[224:227], v[40:43]
    buffer_load_dwordx4 v[156:159], v34, s[84:87], s75 offen offset:0 sc1
    v_mfma_f32_16x16x32_bf16 v[44:47], v[164:167], a[228:231], v[44:47]
    v_mfma_f32_16x16x32_bf16 v[48:51], v[164:167], a[232:235], v[48:51]
    v_mfma_f32_16x16x32_bf16 v[52:55], v[164:167], a[236:239], v[52:55]
    s_waitcnt vmcnt(11)
    v_mfma_f32_16x16x32_bf16 v[40:43], v[168:171], a[240:243], v[40:43]
    buffer_load_dwordx4 v[160:163], v34, s[84:87], s89 offen offset:256 sc1
    v_mfma_f32_16x16x32_bf16 v[44:47], v[168:171], a[244:247], v[44:47]
    v_mfma_f32_16x16x32_bf16 v[48:51], v[168:171], a[248:251], v[48:51]
    v_mfma_f32_16x16x32_bf16 v[52:55], v[168:171], a[252:255], v[52:55]
    s_waitcnt vmcnt(11)
    v_mfma_f32_16x16x32_bf16 v[40:43], v[172:175], a[0:3], v[40:43]
    buffer_load_dwordx4 v[164:167], v34, s[84:87], s52 offen offset:256 sc1
    v_mfma_f32_16x16x32_bf16 v[44:47], v[172:175], a[4:7], v[44:47]
    v_mfma_f32_16x16x32_bf16 v[48:51], v[172:175], a[8:11], v[48:51]
    v_mfma_f32_16x16x32_bf16 v[52:55], v[172:175], a[12:15], v[52:55]
    s_waitcnt vmcnt(11)
    v_mfma_f32_16x16x32_bf16 v[40:43], v[176:179], a[16:19], v[40:43]
    buffer_load_dwordx4 v[168:171], v34, s[84:87], s53 offen offset:256 sc1
    v_mfma_f32_16x16x32_bf16 v[44:47], v[176:179], a[20:23], v[44:47]
    v_mfma_f32_16x16x32_bf16 v[48:51], v[176:179], a[24:27], v[48:51]
    v_mfma_f32_16x16x32_bf16 v[52:55], v[176:179], a[28:31], v[52:55]
    s_waitcnt vmcnt(11) lgkmcnt(15)
    v_mfma_f32_16x16x32_bf16 v[40:43], v[180:183], a[32:35], v[40:43]
    buffer_load_dwordx4 v[172:175], v34, s[84:87], s54 offen offset:256 sc1
    v_mfma_f32_16x16x32_bf16 v[44:47], v[180:183], a[36:39], v[44:47]
    v_mfma_f32_16x16x32_bf16 v[48:51], v[180:183], a[40:43], v[48:51]
    v_mfma_f32_16x16x32_bf16 v[52:55], v[180:183], a[44:47], v[52:55]
    s_waitcnt vmcnt(11)
    v_mfma_f32_16x16x32_bf16 v[40:43], v[184:187], a[48:51], v[40:43]
    buffer_load_dwordx4 v[176:179], v34, s[84:87], s55 offen offset:256 sc1
    v_mfma_f32_16x16x32_bf16 v[44:47], v[184:187], a[52:55], v[44:47]
    v_mfma_f32_16x16x32_bf16 v[48:51], v[184:187], a[56:59], v[48:51]
    v_mfma_f32_16x16x32_bf16 v[52:55], v[184:187], a[60:63], v[52:55]
    s_waitcnt vmcnt(11)
    v_mfma_f32_16x16x32_bf16 v[40:43], v[188:191], a[64:67], v[40:43]
    buffer_load_dwordx4 v[180:183], v34, s[84:87], s56 offen offset:256 sc1
    v_mfma_f32_16x16x32_bf16 v[44:47], v[188:191], a[68:71], v[44:47]
    v_mfma_f32_16x16x32_bf16 v[48:51], v[188:191], a[72:75], v[48:51]
    v_mfma_f32_16x16x32_bf16 v[52:55], v[188:191], a[76:79], v[52:55]
    s_waitcnt vmcnt(11)
    v_mfma_f32_16x16x32_bf16 v[40:43], v[192:195], a[80:83], v[40:43]
    buffer_load_dwordx4 v[184:187], v34, s[84:87], s57 offen offset:256 sc1
    v_mfma_f32_16x16x32_bf16 v[44:47], v[192:195], a[84:87], v[44:47]
    v_mfma_f32_16x16x32_bf16 v[48:51], v[192:195], a[88:91], v[48:51]
    v_mfma_f32_16x16x32_bf16 v[52:55], v[192:195], a[92:95], v[52:55]
    s_waitcnt vmcnt(11)
    v_mfma_f32_16x16x32_bf16 v[40:43], v[140:143], a[96:99], v[40:43]
    buffer_load_dwordx4 v[188:191], v34, s[84:87], s58 offen offset:256 sc1
    v_mfma_f32_16x16x32_bf16 v[44:47], v[140:143], a[100:103], v[44:47]
    v_mfma_f32_16x16x32_bf16 v[48:51], v[140:143], a[104:107], v[48:51]
    v_mfma_f32_16x16x32_bf16 v[52:55], v[140:143], a[108:111], v[52:55]
    s_waitcnt vmcnt(11)
    v_mfma_f32_16x16x32_bf16 v[40:43], v[144:147], a[112:115], v[40:43]
    buffer_load_dwordx4 v[192:195], v34, s[84:87], s59 offen offset:256 sc1
    v_mfma_f32_16x16x32_bf16 v[44:47], v[144:147], a[116:119], v[44:47]
    v_mfma_f32_16x16x32_bf16 v[48:51], v[144:147], a[120:123], v[48:51]
    v_mfma_f32_16x16x32_bf16 v[52:55], v[144:147], a[124:127], v[52:55]
    s_waitcnt vmcnt(11)
    v_mfma_f32_16x16x32_bf16 v[40:43], v[148:151], v[208:211], v[40:43]
    buffer_load_dwordx4 v[140:143], v34, s[84:87], s60 offen offset:256 sc1
    v_mfma_f32_16x16x32_bf16 v[44:47], v[148:151], v[212:215], v[44:47]
    v_mfma_f32_16x16x32_bf16 v[48:51], v[148:151], v[216:219], v[48:51]
    v_mfma_f32_16x16x32_bf16 v[52:55], v[148:151], v[220:223], v[52:55]
    s_waitcnt vmcnt(11) lgkmcnt(14)
    v_mfma_f32_16x16x32_bf16 v[40:43], v[152:155], v[224:227], v[40:43]
    buffer_load_dwordx4 v[144:147], v34, s[84:87], s61 offen offset:256 sc1
    s_waitcnt lgkmcnt(12)
    v_mfma_f32_16x16x32_bf16 v[44:47], v[152:155], v[228:231], v[44:47]
    s_waitcnt lgkmcnt(10)
    v_mfma_f32_16x16x32_bf16 v[48:51], v[152:155], v[232:235], v[48:51]
    s_waitcnt lgkmcnt(8)
    v_mfma_f32_16x16x32_bf16 v[52:55], v[152:155], v[236:239], v[52:55]
    s_waitcnt vmcnt(11) lgkmcnt(6)
    v_mfma_f32_16x16x32_bf16 v[40:43], v[156:159], v[240:243], v[40:43]
    buffer_load_dwordx4 v[148:151], v34, s[84:87], s62 offen offset:256 sc1
    s_waitcnt lgkmcnt(4)
    v_mfma_f32_16x16x32_bf16 v[44:47], v[156:159], v[244:247], v[44:47]
    s_waitcnt lgkmcnt(2)
    v_mfma_f32_16x16x32_bf16 v[48:51], v[156:159], v[248:251], v[48:51]
    s_waitcnt lgkmcnt(0)
    v_mfma_f32_16x16x32_bf16 v[52:55], v[156:159], v[252:255], v[52:55]
    s_waitcnt vmcnt(11)
    v_mfma_f32_16x16x32_bf16 v[56:59], v[160:163], a[128:131], 0
    buffer_load_dwordx4 v[152:155], v34, s[84:87], s63 offen offset:256 sc1
    v_mfma_f32_16x16x32_bf16 v[60:63], v[160:163], a[132:135], 0
    v_mfma_f32_16x16x32_bf16 v[64:67], v[160:163], a[136:139], 0
    ds_write_addtid_b32 v40 offset:0
    v_mfma_f32_16x16x32_bf16 v[68:71], v[160:163], a[140:143], 0
    ds_write_addtid_b32 v41 offset:256
    s_waitcnt vmcnt(11)
    v_mfma_f32_16x16x32_bf16 v[56:59], v[164:167], a[144:147], v[56:59]
    buffer_load_dwordx4 v[156:159], v34, s[84:87], s64 offen offset:256 sc1
    v_mfma_f32_16x16x32_bf16 v[60:63], v[164:167], a[148:151], v[60:63]
    ds_write_addtid_b32 v42 offset:512
    v_mfma_f32_16x16x32_bf16 v[64:67], v[164:167], a[152:155], v[64:67]
    ds_write_addtid_b32 v43 offset:768
    v_mfma_f32_16x16x32_bf16 v[68:71], v[164:167], a[156:159], v[68:71]
    s_waitcnt vmcnt(11)
    v_mfma_f32_16x16x32_bf16 v[56:59], v[168:171], a[160:163], v[56:59]
    buffer_load_dwordx4 v[160:163], v34, s[84:87], s65 offen offset:256 sc1
    v_mfma_f32_16x16x32_bf16 v[60:63], v[168:171], a[164:167], v[60:63]
    ds_write_addtid_b32 v44 offset:1024
    v_mfma_f32_16x16x32_bf16 v[64:67], v[168:171], a[168:171], v[64:67]
    ds_write_addtid_b32 v45 offset:1280
    v_mfma_f32_16x16x32_bf16 v[68:71], v[168:171], a[172:175], v[68:71]
    ds_write_addtid_b32 v46 offset:1536
    s_waitcnt vmcnt(11)
    v_mfma_f32_16x16x32_bf16 v[56:59], v[172:175], a[176:179], v[56:59]
    buffer_load_dwordx4 v[164:167], v34, s[84:87], s66 offen offset:256 sc1
    v_mfma_f32_16x16x32_bf16 v[60:63], v[172:175], a[180:183], v[60:63]
    ds_write_addtid_b32 v47 offset:1792
    v_mfma_f32_16x16x32_bf16 v[64:67], v[172:175], a[184:187], v[64:67]
    ds_write_addtid_b32 v48 offset:2048
    v_mfma_f32_16x16x32_bf16 v[68:71], v[172:175], a[188:191], v[68:71]
    ds_write_addtid_b32 v49 offset:2304
    s_waitcnt vmcnt(11)
    v_mfma_f32_16x16x32_bf16 v[56:59], v[176:179], a[192:195], v[56:59]
    buffer_load_dwordx4 v[168:171], v34, s[84:87], s67 offen offset:256 sc1
    v_mfma_f32_16x16x32_bf16 v[60:63], v[176:179], a[196:199], v[60:63]
    ds_write_addtid_b32 v50 offset:2560
    v_mfma_f32_16x16x32_bf16 v[64:67], v[176:179], a[200:203], v[64:67]
    ds_write_addtid_b32 v51 offset:2816
    v_mfma_f32_16x16x32_bf16 v[68:71], v[176:179], a[204:207], v[68:71]
    s_waitcnt vmcnt(11)
    v_mfma_f32_16x16x32_bf16 v[56:59], v[180:183], a[208:211], v[56:59]
    buffer_load_dwordx4 v[172:175], v34, s[84:87], s73 offen offset:256 sc1
    v_mfma_f32_16x16x32_bf16 v[60:63], v[180:183], a[212:215], v[60:63]
    ds_write_addtid_b32 v52 offset:3072
    v_mfma_f32_16x16x32_bf16 v[64:67], v[180:183], a[216:219], v[64:67]
    ds_write_addtid_b32 v53 offset:3328
    v_mfma_f32_16x16x32_bf16 v[68:71], v[180:183], a[220:223], v[68:71]
    ds_write_addtid_b32 v54 offset:3584
    s_waitcnt vmcnt(11)
    v_mfma_f32_16x16x32_bf16 v[56:59], v[184:187], a[224:227], v[56:59]
    buffer_load_dwordx4 v[176:179], v34, s[84:87], s75 offen offset:256 sc1
    v_mfma_f32_16x16x32_bf16 v[60:63], v[184:187], a[228:231], v[60:63]
    ds_write_addtid_b32 v55 offset:3840
    v_mfma_f32_16x16x32_bf16 v[64:67], v[184:187], a[232:235], v[64:67]
    v_mfma_f32_16x16x32_bf16 v[68:71], v[184:187], a[236:239], v[68:71]
    s_waitcnt vmcnt(11)
    v_mfma_f32_16x16x32_bf16 v[56:59], v[188:191], a[240:243], v[56:59]
    buffer_load_dwordx4 v[180:183], v34, s[84:87], s89 offen offset:1024 sc1
    v_mfma_f32_16x16x32_bf16 v[60:63], v[188:191], a[244:247], v[60:63]
    v_mfma_f32_16x16x32_bf16 v[64:67], v[188:191], a[248:251], v[64:67]
    v_mfma_f32_16x16x32_bf16 v[68:71], v[188:191], a[252:255], v[68:71]
    s_waitcnt lgkmcnt(0)
    s_barrier
    s_waitcnt vmcnt(11)
    v_mfma_f32_16x16x32_bf16 v[56:59], v[192:195], a[0:3], v[56:59]
    buffer_load_dwordx4 v[184:187], v34, s[84:87], s52 offen offset:1024 sc1
    v_mfma_f32_16x16x32_bf16 v[60:63], v[192:195], a[4:7], v[60:63]
    ds_read_b128 v[44:47], v23 offset:4096
    ds_read_b128 v[48:51], v23 offset:8192
    v_mfma_f32_16x16x32_bf16 v[64:67], v[192:195], a[8:11], v[64:67]
    ds_read_b128 v[52:55], v23 offset:12288
    v_mfma_f32_16x16x32_bf16 v[68:71], v[192:195], a[12:15], v[68:71]
    ds_read_b128 v[40:43], v23 offset:0
    s_waitcnt vmcnt(11)
    v_mfma_f32_16x16x32_bf16 v[56:59], v[140:143], a[16:19], v[56:59]
    buffer_load_dwordx4 v[188:191], v34, s[84:87], s53 offen offset:1024 sc1
    v_mfma_f32_16x16x32_bf16 v[60:63], v[140:143], a[20:23], v[60:63]
    v_mfma_f32_16x16x32_bf16 v[64:67], v[140:143], a[24:27], v[64:67]
    v_mfma_f32_16x16x32_bf16 v[68:71], v[140:143], a[28:31], v[68:71]
    s_waitcnt vmcnt(11)
    v_mfma_f32_16x16x32_bf16 v[56:59], v[144:147], a[32:35], v[56:59]
    buffer_load_dwordx4 v[192:195], v34, s[84:87], s54 offen offset:1024 sc1
    v_mfma_f32_16x16x32_bf16 v[60:63], v[144:147], a[36:39], v[60:63]
    s_waitcnt lgkmcnt(3)
    v_add_f32 v44, v44, v116
    v_mfma_f32_16x16x32_bf16 v[64:67], v[144:147], a[40:43], v[64:67]
    v_add_f32 v45, v45, v117
    v_mfma_f32_16x16x32_bf16 v[68:71], v[144:147], a[44:47], v[68:71]
    v_add_f32 v46, v46, v118
    s_waitcnt vmcnt(11)
    v_mfma_f32_16x16x32_bf16 v[56:59], v[148:151], a[48:51], v[56:59]
    buffer_load_dwordx4 v[140:143], v34, s[84:87], s55 offen offset:1024 sc1
    v_mfma_f32_16x16x32_bf16 v[60:63], v[148:151], a[52:55], v[60:63]
    v_add_f32 v47, v47, v119
    v_mfma_f32_16x16x32_bf16 v[64:67], v[148:151], a[56:59], v[64:67]
    s_waitcnt lgkmcnt(2)
    v_add_f32 v44, v44, v48
    v_add_f32 v45, v45, v49
    v_mfma_f32_16x16x32_bf16 v[68:71], v[148:151], a[60:63], v[68:71]
    v_add_f32 v46, v46, v50
    s_waitcnt vmcnt(11)
    v_mfma_f32_16x16x32_bf16 v[56:59], v[152:155], a[64:67], v[56:59]
    buffer_load_dwordx4 v[144:147], v34, s[84:87], s56 offen offset:1024 sc1
    v_mfma_f32_16x16x32_bf16 v[60:63], v[152:155], a[68:71], v[60:63]
    v_add_f32 v47, v47, v51
    s_waitcnt lgkmcnt(1)
    v_add_f32 v44, v44, v52
    v_mfma_f32_16x16x32_bf16 v[64:67], v[152:155], a[72:75], v[64:67]
    v_add_f32 v45, v45, v53
    v_mfma_f32_16x16x32_bf16 v[68:71], v[152:155], a[76:79], v[68:71]
    v_add_f32 v46, v46, v54
    s_waitcnt vmcnt(11)
    v_mfma_f32_16x16x32_bf16 v[56:59], v[156:159], a[80:83], v[56:59]
    buffer_load_dwordx4 v[148:151], v34, s[84:87], s57 offen offset:1024 sc1
    v_mfma_f32_16x16x32_bf16 v[60:63], v[156:159], a[84:87], v[60:63]
    v_add_f32 v47, v47, v55
    v_mul_f32 v48, v44, v36
    v_mfma_f32_16x16x32_bf16 v[64:67], v[156:159], a[88:91], v[64:67]
    v_mul_f32 v49, v45, v36
    v_mul_f32 v50, v46, v36
    v_mfma_f32_16x16x32_bf16 v[68:71], v[156:159], a[92:95], v[68:71]
    v_mul_f32 v51, v47, v36
    s_waitcnt vmcnt(11)
    v_mfma_f32_16x16x32_bf16 v[56:59], v[160:163], a[96:99], v[56:59]
    buffer_load_dwordx4 v[152:155], v34, s[84:87], s58 offen offset:1024 sc1
    v_mfma_f32_16x16x32_bf16 v[60:63], v[160:163], a[100:103], v[60:63]
    v_exp_f32 v48, v48
    v_mfma_f32_16x16x32_bf16 v[64:67], v[160:163], a[104:107], v[64:67]
    v_exp_f32 v49, v49
    v_mfma_f32_16x16x32_bf16 v[68:71], v[160:163], a[108:111], v[68:71]
    s_waitcnt vmcnt(11)
    v_mfma_f32_16x16x32_bf16 v[56:59], v[164:167], a[112:115], v[56:59]
    buffer_load_dwordx4 v[156:159], v34, s[84:87], s59 offen offset:1024 sc1
    v_mfma_f32_16x16x32_bf16 v[60:63], v[164:167], a[116:119], v[60:63]
    v_exp_f32 v50, v50
    v_mfma_f32_16x16x32_bf16 v[64:67], v[164:167], a[120:123], v[64:67]
    v_exp_f32 v51, v51
    v_mfma_f32_16x16x32_bf16 v[68:71], v[164:167], a[124:127], v[68:71]
    s_waitcnt vmcnt(11)
    v_mfma_f32_16x16x32_bf16 v[56:59], v[168:171], v[208:211], v[56:59]
    buffer_load_dwordx4 v[160:163], v34, s[84:87], s60 offen offset:1024 sc1
    v_mfma_f32_16x16x32_bf16 v[60:63], v[168:171], v[212:215], v[60:63]
    s_waitcnt lgkmcnt(0)
    v_mul_f32 v44, v44, v40
    v_mfma_f32_16x16x32_bf16 v[64:67], v[168:171], v[216:219], v[64:67]
    v_mul_f32 v45, v45, v41
    v_mul_f32 v46, v46, v42
    v_mfma_f32_16x16x32_bf16 v[68:71], v[168:171], v[220:223], v[68:71]
    v_mul_f32 v47, v47, v43
    s_waitcnt vmcnt(11)
    v_mfma_f32_16x16x32_bf16 v[56:59], v[172:175], v[224:227], v[56:59]
    buffer_load_dwordx4 v[164:167], v34, s[84:87], s61 offen offset:1024 sc1
    v_mfma_f32_16x16x32_bf16 v[60:63], v[172:175], v[228:231], v[60:63]
    v_add_f32 v48, v48, v38
    v_mfma_f32_16x16x32_bf16 v[64:67], v[172:175], v[232:235], v[64:67]
    v_add_f32 v49, v49, v38
    v_add_f32 v50, v50, v38
    v_mfma_f32_16x16x32_bf16 v[68:71], v[172:175], v[236:239], v[68:71]
    v_add_f32 v51, v51, v38
    s_waitcnt vmcnt(11)
    v_mfma_f32_16x16x32_bf16 v[56:59], v[176:179], v[240:243], v[56:59]
    buffer_load_dwordx4 v[168:171], v34, s[84:87], s62 offen offset:1024 sc1
    v_mfma_f32_16x16x32_bf16 v[60:63], v[176:179], v[244:247], v[60:63]
    v_rcp_f32 v48, v48
    v_mfma_f32_16x16x32_bf16 v[64:67], v[176:179], v[248:251], v[64:67]
    v_rcp_f32 v49, v49
    v_mfma_f32_16x16x32_bf16 v[68:71], v[176:179], v[252:255], v[68:71]
    s_waitcnt vmcnt(11)
    v_mfma_f32_16x16x32_bf16 v[72:75], v[180:183], a[128:131], 0
    buffer_load_dwordx4 v[172:175], v34, s[84:87], s63 offen offset:1024 sc1
    v_mfma_f32_16x16x32_bf16 v[76:79], v[180:183], a[132:135], 0
    v_rcp_f32 v50, v50
    v_mfma_f32_16x16x32_bf16 v[80:83], v[180:183], a[136:139], 0
    ds_write_addtid_b32 v56 offset:16384
    v_mfma_f32_16x16x32_bf16 v[84:87], v[180:183], a[140:143], 0
    ds_write_addtid_b32 v57 offset:16640
    s_waitcnt vmcnt(11)
    v_mfma_f32_16x16x32_bf16 v[72:75], v[184:187], a[144:147], v[72:75]
    buffer_load_dwordx4 v[176:179], v34, s[84:87], s64 offen offset:1024 sc1
    v_mfma_f32_16x16x32_bf16 v[76:79], v[184:187], a[148:151], v[76:79]
    ds_write_addtid_b32 v58 offset:16896
    v_mfma_f32_16x16x32_bf16 v[80:83], v[184:187], a[152:155], v[80:83]
    ds_write_addtid_b32 v59 offset:17152
    v_mfma_f32_16x16x32_bf16 v[84:87], v[184:187], a[156:159], v[84:87]
    s_waitcnt vmcnt(11)
    v_mfma_f32_16x16x32_bf16 v[72:75], v[188:191], a[160:163], v[72:75]
    buffer_load_dwordx4 v[180:183], v34, s[84:87], s65 offen offset:1024 sc1
    v_mfma_f32_16x16x32_bf16 v[76:79], v[188:191], a[164:167], v[76:79]
    ds_write_addtid_b32 v60 offset:17408
    v_mfma_f32_16x16x32_bf16 v[80:83], v[188:191], a[168:171], v[80:83]
    ds_write_addtid_b32 v61 offset:17664
    v_mfma_f32_16x16x32_bf16 v[84:87], v[188:191], a[172:175], v[84:87]
    ds_write_addtid_b32 v62 offset:17920
    s_waitcnt vmcnt(11)
    v_mfma_f32_16x16x32_bf16 v[72:75], v[192:195], a[176:179], v[72:75]
    buffer_load_dwordx4 v[184:187], v34, s[84:87], s66 offen offset:1024 sc1
    v_mfma_f32_16x16x32_bf16 v[76:79], v[192:195], a[180:183], v[76:79]
    ds_write_addtid_b32 v63 offset:18176
    v_mfma_f32_16x16x32_bf16 v[80:83], v[192:195], a[184:187], v[80:83]
    ds_write_addtid_b32 v64 offset:18432
    v_mfma_f32_16x16x32_bf16 v[84:87], v[192:195], a[188:191], v[84:87]
    ds_write_addtid_b32 v65 offset:18688
    s_waitcnt vmcnt(11)
    v_mfma_f32_16x16x32_bf16 v[72:75], v[140:143], a[192:195], v[72:75]
    buffer_load_dwordx4 v[188:191], v34, s[84:87], s67 offen offset:1024 sc1
    v_mfma_f32_16x16x32_bf16 v[76:79], v[140:143], a[196:199], v[76:79]
    ds_write_addtid_b32 v66 offset:18944
    v_mfma_f32_16x16x32_bf16 v[80:83], v[140:143], a[200:203], v[80:83]
    ds_write_addtid_b32 v67 offset:19200
    v_rcp_f32 v51, v51
    v_mfma_f32_16x16x32_bf16 v[84:87], v[140:143], a[204:207], v[84:87]
    s_waitcnt vmcnt(11)
    v_mfma_f32_16x16x32_bf16 v[72:75], v[144:147], a[208:211], v[72:75]
    buffer_load_dwordx4 v[192:195], v34, s[84:87], s73 offen offset:1024 sc1
    v_mfma_f32_16x16x32_bf16 v[76:79], v[144:147], a[212:215], v[76:79]
    ds_write_addtid_b32 v68 offset:19456
    v_fma_f32 v44, v44, v48, v124
    v_mfma_f32_16x16x32_bf16 v[80:83], v[144:147], a[216:219], v[80:83]
    ds_write_addtid_b32 v69 offset:19712
    v_fma_f32 v45, v45, v49, v125
    v_mfma_f32_16x16x32_bf16 v[84:87], v[144:147], a[220:223], v[84:87]
    ds_write_addtid_b32 v70 offset:19968
    s_waitcnt vmcnt(11)
    v_mfma_f32_16x16x32_bf16 v[72:75], v[148:151], a[224:227], v[72:75]
    buffer_load_dwordx4 v[140:143], v34, s[84:87], s75 offen offset:1024 sc1
    v_mfma_f32_16x16x32_bf16 v[76:79], v[148:151], a[228:231], v[76:79]
    ds_write_addtid_b32 v71 offset:20224
    v_fma_f32 v46, v46, v50, v126
    v_mfma_f32_16x16x32_bf16 v[80:83], v[148:151], a[232:235], v[80:83]
    v_fma_f32 v47, v47, v51, v127
    v_mfma_f32_16x16x32_bf16 v[84:87], v[148:151], a[236:239], v[84:87]
    v_cvt_pk_bf16_f32 v104, v44, v45
    s_waitcnt vmcnt(11)
    v_mfma_f32_16x16x32_bf16 v[72:75], v[152:155], a[240:243], v[72:75]
    buffer_load_dwordx4 v[144:147], v34, s[84:87], s89 offen offset:1280 sc1
    v_mfma_f32_16x16x32_bf16 v[76:79], v[152:155], a[244:247], v[76:79]
    v_cvt_pk_bf16_f32 v105, v46, v47
    v_mfma_f32_16x16x32_bf16 v[80:83], v[152:155], a[248:251], v[80:83]
    buffer_store_dwordx2 v[104:105], v25, s[24:27], 0 offen offset:0 sc1
    v_mfma_f32_16x16x32_bf16 v[84:87], v[152:155], a[252:255], v[84:87]
    s_waitcnt lgkmcnt(0)
    s_barrier
    s_waitcnt vmcnt(12)
    v_mfma_f32_16x16x32_bf16 v[72:75], v[156:159], a[0:3], v[72:75]
    buffer_load_dwordx4 v[148:151], v34, s[84:87], s52 offen offset:1280 sc1
    v_mfma_f32_16x16x32_bf16 v[76:79], v[156:159], a[4:7], v[76:79]
    ds_read_b128 v[60:63], v23 offset:20480
    ds_read_b128 v[64:67], v23 offset:24576
    v_mfma_f32_16x16x32_bf16 v[80:83], v[156:159], a[8:11], v[80:83]
    ds_read_b128 v[68:71], v23 offset:28672
    v_mfma_f32_16x16x32_bf16 v[84:87], v[156:159], a[12:15], v[84:87]
    ds_read_b128 v[56:59], v23 offset:16384
    s_waitcnt vmcnt(12)
    v_mfma_f32_16x16x32_bf16 v[72:75], v[160:163], a[16:19], v[72:75]
    buffer_load_dwordx4 v[152:155], v34, s[84:87], s53 offen offset:1280 sc1
    v_mfma_f32_16x16x32_bf16 v[76:79], v[160:163], a[20:23], v[76:79]
    v_mfma_f32_16x16x32_bf16 v[80:83], v[160:163], a[24:27], v[80:83]
    v_mfma_f32_16x16x32_bf16 v[84:87], v[160:163], a[28:31], v[84:87]
    s_waitcnt vmcnt(12)
    v_mfma_f32_16x16x32_bf16 v[72:75], v[164:167], a[32:35], v[72:75]
    buffer_load_dwordx4 v[156:159], v34, s[84:87], s54 offen offset:1280 sc1
    v_mfma_f32_16x16x32_bf16 v[76:79], v[164:167], a[36:39], v[76:79]
    s_waitcnt lgkmcnt(3)
    v_add_f32 v60, v60, v116
    v_mfma_f32_16x16x32_bf16 v[80:83], v[164:167], a[40:43], v[80:83]
    v_add_f32 v61, v61, v117
    v_mfma_f32_16x16x32_bf16 v[84:87], v[164:167], a[44:47], v[84:87]
    v_add_f32 v62, v62, v118
    s_waitcnt vmcnt(12)
    v_mfma_f32_16x16x32_bf16 v[72:75], v[168:171], a[48:51], v[72:75]
    buffer_load_dwordx4 v[160:163], v34, s[84:87], s55 offen offset:1280 sc1
    v_mfma_f32_16x16x32_bf16 v[76:79], v[168:171], a[52:55], v[76:79]
    v_add_f32 v63, v63, v119
    s_waitcnt lgkmcnt(2)
    v_add_f32 v60, v60, v64
    v_mfma_f32_16x16x32_bf16 v[80:83], v[168:171], a[56:59], v[80:83]
    v_add_f32 v61, v61, v65
    v_mfma_f32_16x16x32_bf16 v[84:87], v[168:171], a[60:63], v[84:87]
    v_add_f32 v62, v62, v66
    s_waitcnt vmcnt(12)
    v_mfma_f32_16x16x32_bf16 v[72:75], v[172:175], a[64:67], v[72:75]
    buffer_load_dwordx4 v[164:167], v34, s[84:87], s56 offen offset:1280 sc1
    v_mfma_f32_16x16x32_bf16 v[76:79], v[172:175], a[68:71], v[76:79]
    v_add_f32 v63, v63, v67
    s_waitcnt lgkmcnt(1)
    v_add_f32 v60, v60, v68
    v_mfma_f32_16x16x32_bf16 v[80:83], v[172:175], a[72:75], v[80:83]
    v_add_f32 v61, v61, v69
    v_mfma_f32_16x16x32_bf16 v[84:87], v[172:175], a[76:79], v[84:87]
    v_add_f32 v62, v62, v70
    s_waitcnt vmcnt(12)
    v_mfma_f32_16x16x32_bf16 v[72:75], v[176:179], a[80:83], v[72:75]
    buffer_load_dwordx4 v[168:171], v34, s[84:87], s57 offen offset:1280 sc1
    v_mfma_f32_16x16x32_bf16 v[76:79], v[176:179], a[84:87], v[76:79]
    v_add_f32 v63, v63, v71
    v_mul_f32 v64, v60, v36
    v_mfma_f32_16x16x32_bf16 v[80:83], v[176:179], a[88:91], v[80:83]
    v_mul_f32 v65, v61, v36
    v_mul_f32 v66, v62, v36
    v_mfma_f32_16x16x32_bf16 v[84:87], v[176:179], a[92:95], v[84:87]
    v_mul_f32 v67, v63, v36
    s_waitcnt vmcnt(12)
    v_mfma_f32_16x16x32_bf16 v[72:75], v[180:183], a[96:99], v[72:75]
    buffer_load_dwordx4 v[172:175], v34, s[84:87], s58 offen offset:1280 sc1
    v_mfma_f32_16x16x32_bf16 v[76:79], v[180:183], a[100:103], v[76:79]
    v_exp_f32 v64, v64
    v_mfma_f32_16x16x32_bf16 v[80:83], v[180:183], a[104:107], v[80:83]
    v_exp_f32 v65, v65
    v_mfma_f32_16x16x32_bf16 v[84:87], v[180:183], a[108:111], v[84:87]
    s_waitcnt vmcnt(12)
    v_mfma_f32_16x16x32_bf16 v[72:75], v[184:187], a[112:115], v[72:75]
    buffer_load_dwordx4 v[176:179], v34, s[84:87], s59 offen offset:1280 sc1
    v_mfma_f32_16x16x32_bf16 v[76:79], v[184:187], a[116:119], v[76:79]
    v_exp_f32 v66, v66
    v_mfma_f32_16x16x32_bf16 v[80:83], v[184:187], a[120:123], v[80:83]
    v_exp_f32 v67, v67
    v_mfma_f32_16x16x32_bf16 v[84:87], v[184:187], a[124:127], v[84:87]
    s_waitcnt vmcnt(12)
    v_mfma_f32_16x16x32_bf16 v[72:75], v[188:191], v[208:211], v[72:75]
    buffer_load_dwordx4 v[180:183], v34, s[84:87], s60 offen offset:1280 sc1
    v_mfma_f32_16x16x32_bf16 v[76:79], v[188:191], v[212:215], v[76:79]
    s_waitcnt lgkmcnt(0)
    v_mul_f32 v60, v60, v56
    v_mfma_f32_16x16x32_bf16 v[80:83], v[188:191], v[216:219], v[80:83]
    v_mul_f32 v61, v61, v57
    v_mul_f32 v62, v62, v58
    v_mfma_f32_16x16x32_bf16 v[84:87], v[188:191], v[220:223], v[84:87]
    v_mul_f32 v63, v63, v59
    s_waitcnt vmcnt(12)
    v_mfma_f32_16x16x32_bf16 v[72:75], v[192:195], v[224:227], v[72:75]
    buffer_load_dwordx4 v[184:187], v34, s[84:87], s61 offen offset:1280 sc1
    v_mfma_f32_16x16x32_bf16 v[76:79], v[192:195], v[228:231], v[76:79]
    v_add_f32 v64, v64, v38
    v_add_f32 v65, v65, v38
    v_mfma_f32_16x16x32_bf16 v[80:83], v[192:195], v[232:235], v[80:83]
    v_add_f32 v66, v66, v38
    v_mfma_f32_16x16x32_bf16 v[84:87], v[192:195], v[236:239], v[84:87]
    v_add_f32 v67, v67, v38
    s_waitcnt vmcnt(12)
    v_mfma_f32_16x16x32_bf16 v[72:75], v[140:143], v[240:243], v[72:75]
    buffer_load_dwordx4 v[188:191], v34, s[84:87], s62 offen offset:1280 sc1
    v_mfma_f32_16x16x32_bf16 v[76:79], v[140:143], v[244:247], v[76:79]
    v_rcp_f32 v64, v64
    v_mfma_f32_16x16x32_bf16 v[80:83], v[140:143], v[248:251], v[80:83]
    v_rcp_f32 v65, v65
    v_mfma_f32_16x16x32_bf16 v[84:87], v[140:143], v[252:255], v[84:87]
    s_waitcnt vmcnt(12)
    v_mfma_f32_16x16x32_bf16 v[88:91], v[144:147], a[128:131], 0
    buffer_load_dwordx4 v[192:195], v34, s[84:87], s63 offen offset:1280 sc1
    v_mfma_f32_16x16x32_bf16 v[92:95], v[144:147], a[132:135], 0
    v_rcp_f32 v66, v66
    v_mfma_f32_16x16x32_bf16 v[96:99], v[144:147], a[136:139], 0
    ds_write_addtid_b32 v72 offset:32768
    v_mfma_f32_16x16x32_bf16 v[100:103], v[144:147], a[140:143], 0
    ds_write_addtid_b32 v73 offset:33024
    s_waitcnt vmcnt(11)
    v_mfma_f32_16x16x32_bf16 v[88:91], v[148:151], a[144:147], v[88:91]
    buffer_load_dwordx4 v[140:143], v34, s[84:87], s64 offen offset:1280 sc1
    v_mfma_f32_16x16x32_bf16 v[92:95], v[148:151], a[148:151], v[92:95]
    ds_write_addtid_b32 v74 offset:33280
    v_mfma_f32_16x16x32_bf16 v[96:99], v[148:151], a[152:155], v[96:99]
    ds_write_addtid_b32 v75 offset:33536
    v_mfma_f32_16x16x32_bf16 v[100:103], v[148:151], a[156:159], v[100:103]
    s_waitcnt vmcnt(11)
    v_mfma_f32_16x16x32_bf16 v[88:91], v[152:155], a[160:163], v[88:91]
    buffer_load_dwordx4 v[144:147], v34, s[84:87], s65 offen offset:1280 sc1
    v_mfma_f32_16x16x32_bf16 v[92:95], v[152:155], a[164:167], v[92:95]
    ds_write_addtid_b32 v76 offset:33792
    v_mfma_f32_16x16x32_bf16 v[96:99], v[152:155], a[168:171], v[96:99]
    ds_write_addtid_b32 v77 offset:34048
    v_mfma_f32_16x16x32_bf16 v[100:103], v[152:155], a[172:175], v[100:103]
    ds_write_addtid_b32 v78 offset:34304
    s_waitcnt vmcnt(11)
    v_mfma_f32_16x16x32_bf16 v[88:91], v[156:159], a[176:179], v[88:91]
    buffer_load_dwordx4 v[148:151], v34, s[84:87], s66 offen offset:1280 sc1
    v_mfma_f32_16x16x32_bf16 v[92:95], v[156:159], a[180:183], v[92:95]
    ds_write_addtid_b32 v79 offset:34560
    v_mfma_f32_16x16x32_bf16 v[96:99], v[156:159], a[184:187], v[96:99]
    ds_write_addtid_b32 v80 offset:34816
    v_mfma_f32_16x16x32_bf16 v[100:103], v[156:159], a[188:191], v[100:103]
    ds_write_addtid_b32 v81 offset:35072
    s_waitcnt vmcnt(11)
    v_mfma_f32_16x16x32_bf16 v[88:91], v[160:163], a[192:195], v[88:91]
    buffer_load_dwordx4 v[152:155], v34, s[84:87], s67 offen offset:1280 sc1
    v_mfma_f32_16x16x32_bf16 v[92:95], v[160:163], a[196:199], v[92:95]
    ds_write_addtid_b32 v82 offset:35328
    v_mfma_f32_16x16x32_bf16 v[96:99], v[160:163], a[200:203], v[96:99]
    ds_write_addtid_b32 v83 offset:35584
    v_mfma_f32_16x16x32_bf16 v[100:103], v[160:163], a[204:207], v[100:103]
    v_rcp_f32 v67, v67
    s_waitcnt vmcnt(11)
    v_mfma_f32_16x16x32_bf16 v[88:91], v[164:167], a[208:211], v[88:91]
    buffer_load_dwordx4 v[156:159], v34, s[84:87], s73 offen offset:1280 sc1
    v_mfma_f32_16x16x32_bf16 v[92:95], v[164:167], a[212:215], v[92:95]
    ds_write_addtid_b32 v84 offset:35840
    v_mfma_f32_16x16x32_bf16 v[96:99], v[164:167], a[216:219], v[96:99]
    ds_write_addtid_b32 v85 offset:36096
    v_fma_f32 v60, v60, v64, v128
    v_mfma_f32_16x16x32_bf16 v[100:103], v[164:167], a[220:223], v[100:103]
    ds_write_addtid_b32 v86 offset:36352
    s_waitcnt vmcnt(11)
    v_mfma_f32_16x16x32_bf16 v[88:91], v[168:171], a[224:227], v[88:91]
    buffer_load_dwordx4 v[160:163], v34, s[84:87], s75 offen offset:1280 sc1
    v_mfma_f32_16x16x32_bf16 v[92:95], v[168:171], a[228:231], v[92:95]
    ds_write_addtid_b32 v87 offset:36608
    v_fma_f32 v61, v61, v65, v129
    v_mfma_f32_16x16x32_bf16 v[96:99], v[168:171], a[232:235], v[96:99]
    v_fma_f32 v62, v62, v66, v130
    v_mfma_f32_16x16x32_bf16 v[100:103], v[168:171], a[236:239], v[100:103]
    v_fma_f32 v63, v63, v67, v131
    s_waitcnt vmcnt(11)
    v_mfma_f32_16x16x32_bf16 v[88:91], v[172:175], a[240:243], v[88:91]
    v_cvt_pk_bf16_f32 v106, v60, v61
    v_mfma_f32_16x16x32_bf16 v[92:95], v[172:175], a[244:247], v[92:95]
    v_cvt_pk_bf16_f32 v107, v62, v63
    v_mfma_f32_16x16x32_bf16 v[96:99], v[172:175], a[248:251], v[96:99]
    buffer_store_dwordx2 v[106:107], v25, s[24:27], s76 offen offset:0 sc1
    v_mfma_f32_16x16x32_bf16 v[100:103], v[172:175], a[252:255], v[100:103]
    s_waitcnt lgkmcnt(0)
    s_barrier
    s_waitcnt vmcnt(11)
    v_mfma_f32_16x16x32_bf16 v[88:91], v[176:179], a[0:3], v[88:91]
    ds_read_b128 v[76:79], v23 offset:36864
    v_mfma_f32_16x16x32_bf16 v[92:95], v[176:179], a[4:7], v[92:95]
    ds_read_b128 v[80:83], v23 offset:40960
    v_mfma_f32_16x16x32_bf16 v[96:99], v[176:179], a[8:11], v[96:99]
    ds_read_b128 v[84:87], v23 offset:45056
    v_mfma_f32_16x16x32_bf16 v[100:103], v[176:179], a[12:15], v[100:103]
    ds_read_b128 v[72:75], v23 offset:32768
    s_waitcnt vmcnt(10)
    v_mfma_f32_16x16x32_bf16 v[88:91], v[180:183], a[16:19], v[88:91]
    v_mfma_f32_16x16x32_bf16 v[92:95], v[180:183], a[20:23], v[92:95]
    v_mfma_f32_16x16x32_bf16 v[96:99], v[180:183], a[24:27], v[96:99]
    v_mfma_f32_16x16x32_bf16 v[100:103], v[180:183], a[28:31], v[100:103]
    s_waitcnt vmcnt(9)
    v_mfma_f32_16x16x32_bf16 v[88:91], v[184:187], a[32:35], v[88:91]
    s_waitcnt lgkmcnt(3)
    v_add_f32 v76, v76, v116
    v_mfma_f32_16x16x32_bf16 v[92:95], v[184:187], a[36:39], v[92:95]
    v_add_f32 v77, v77, v117
    v_mfma_f32_16x16x32_bf16 v[96:99], v[184:187], a[40:43], v[96:99]
    v_add_f32 v78, v78, v118
    v_add_f32 v79, v79, v119
    v_mfma_f32_16x16x32_bf16 v[100:103], v[184:187], a[44:47], v[100:103]
    s_waitcnt vmcnt(8)
    v_mfma_f32_16x16x32_bf16 v[88:91], v[188:191], a[48:51], v[88:91]
    s_waitcnt lgkmcnt(2)
    v_add_f32 v76, v76, v80
    v_add_f32 v77, v77, v81
    v_mfma_f32_16x16x32_bf16 v[92:95], v[188:191], a[52:55], v[92:95]
    v_add_f32 v78, v78, v82
    v_mfma_f32_16x16x32_bf16 v[96:99], v[188:191], a[56:59], v[96:99]
    v_add_f32 v79, v79, v83
    v_mfma_f32_16x16x32_bf16 v[100:103], v[188:191], a[60:63], v[100:103]
    s_waitcnt lgkmcnt(1)
    v_add_f32 v76, v76, v84
    s_waitcnt vmcnt(7)
    v_mfma_f32_16x16x32_bf16 v[88:91], v[192:195], a[64:67], v[88:91]
    v_add_f32 v77, v77, v85
    v_mfma_f32_16x16x32_bf16 v[92:95], v[192:195], a[68:71], v[92:95]
    v_add_f32 v78, v78, v86
    v_add_f32 v79, v79, v87
    v_mfma_f32_16x16x32_bf16 v[96:99], v[192:195], a[72:75], v[96:99]
    v_mul_f32 v80, v76, v36
    v_mul_f32 v81, v77, v36
    v_mfma_f32_16x16x32_bf16 v[100:103], v[192:195], a[76:79], v[100:103]
    s_waitcnt vmcnt(6)
    v_mfma_f32_16x16x32_bf16 v[88:91], v[140:143], a[80:83], v[88:91]
    v_mul_f32 v82, v78, v36
    v_mul_f32 v83, v79, v36
    v_mfma_f32_16x16x32_bf16 v[92:95], v[140:143], a[84:87], v[92:95]
    v_exp_f32 v80, v80
    v_mfma_f32_16x16x32_bf16 v[96:99], v[140:143], a[88:91], v[96:99]
    v_exp_f32 v81, v81
    v_mfma_f32_16x16x32_bf16 v[100:103], v[140:143], a[92:95], v[100:103]
    s_waitcnt vmcnt(5)
    v_mfma_f32_16x16x32_bf16 v[88:91], v[144:147], a[96:99], v[88:91]
    v_exp_f32 v82, v82
    v_mfma_f32_16x16x32_bf16 v[92:95], v[144:147], a[100:103], v[92:95]
    v_exp_f32 v83, v83
    v_mfma_f32_16x16x32_bf16 v[96:99], v[144:147], a[104:107], v[96:99]
    v_mfma_f32_16x16x32_bf16 v[100:103], v[144:147], a[108:111], v[100:103]
    s_waitcnt lgkmcnt(0)
    v_mul_f32 v76, v76, v72
    s_waitcnt vmcnt(4)
    v_mfma_f32_16x16x32_bf16 v[88:91], v[148:151], a[112:115], v[88:91]
    v_mul_f32 v77, v77, v73
    v_mfma_f32_16x16x32_bf16 v[92:95], v[148:151], a[116:119], v[92:95]
    v_mul_f32 v78, v78, v74
    v_mul_f32 v79, v79, v75
    v_mfma_f32_16x16x32_bf16 v[96:99], v[148:151], a[120:123], v[96:99]
    v_add_f32 v80, v80, v38
    v_add_f32 v81, v81, v38
    v_mfma_f32_16x16x32_bf16 v[100:103], v[148:151], a[124:127], v[100:103]
    s_waitcnt vmcnt(3)
    v_mfma_f32_16x16x32_bf16 v[88:91], v[152:155], v[208:211], v[88:91]
    v_add_f32 v82, v82, v38
    v_add_f32 v83, v83, v38
    v_mfma_f32_16x16x32_bf16 v[92:95], v[152:155], v[212:215], v[92:95]
    v_rcp_f32 v80, v80
    v_mfma_f32_16x16x32_bf16 v[96:99], v[152:155], v[216:219], v[96:99]
    v_rcp_f32 v81, v81
    v_mfma_f32_16x16x32_bf16 v[100:103], v[152:155], v[220:223], v[100:103]
    s_waitcnt vmcnt(2)
    v_mfma_f32_16x16x32_bf16 v[88:91], v[156:159], v[224:227], v[88:91]
    v_rcp_f32 v82, v82
    v_mfma_f32_16x16x32_bf16 v[92:95], v[156:159], v[228:231], v[92:95]
    v_rcp_f32 v83, v83
    v_mfma_f32_16x16x32_bf16 v[96:99], v[156:159], v[232:235], v[96:99]
    v_fma_f32 v76, v76, v80, v132
    v_mfma_f32_16x16x32_bf16 v[100:103], v[156:159], v[236:239], v[100:103]
    v_fma_f32 v77, v77, v81, v133
    s_waitcnt vmcnt(1)
    v_mfma_f32_16x16x32_bf16 v[88:91], v[160:163], v[240:243], v[88:91]
    v_fma_f32 v78, v78, v82, v134
    v_mfma_f32_16x16x32_bf16 v[92:95], v[160:163], v[244:247], v[92:95]
    v_fma_f32 v79, v79, v83, v135
    v_cvt_pk_bf16_f32 v108, v76, v77
    v_mfma_f32_16x16x32_bf16 v[96:99], v[160:163], v[248:251], v[96:99]
    v_cvt_pk_bf16_f32 v109, v78, v79
    v_mfma_f32_16x16x32_bf16 v[100:103], v[160:163], v[252:255], v[100:103]
    buffer_store_dwordx2 v[108:109], v25, s[24:27], 0 offen offset:1024 sc1
    ds_write_addtid_b32 v88 offset:49152
    ds_write_addtid_b32 v89 offset:49408
    ds_write_addtid_b32 v90 offset:49664
    ds_write_addtid_b32 v91 offset:49920
    ds_write_addtid_b32 v92 offset:50176
    ds_write_addtid_b32 v93 offset:50432
    ds_write_addtid_b32 v94 offset:50688
    ds_write_addtid_b32 v95 offset:50944
    ds_write_addtid_b32 v96 offset:51200
    ds_write_addtid_b32 v97 offset:51456
    ds_write_addtid_b32 v98 offset:51712
    ds_write_addtid_b32 v99 offset:51968
    ds_write_addtid_b32 v100 offset:52224
    ds_write_addtid_b32 v101 offset:52480
    ds_write_addtid_b32 v102 offset:52736
    ds_write_addtid_b32 v103 offset:52992
    s_waitcnt lgkmcnt(0)
    s_barrier
    ds_read_b128 v[92:95], v23 offset:53248
    ds_read_b128 v[96:99], v23 offset:57344
    ds_read_b128 v[100:103], v23 offset:61440
    ds_read_b128 v[88:91], v23 offset:49152
    s_waitcnt lgkmcnt(3)
    v_pk_add_f32 v[92:93], v[92:93], v[116:117]
    v_pk_add_f32 v[94:95], v[94:95], v[118:119]
    s_waitcnt lgkmcnt(2)
    v_pk_add_f32 v[92:93], v[92:93], v[96:97]
    v_pk_add_f32 v[94:95], v[94:95], v[98:99]
    s_waitcnt lgkmcnt(1)
    v_pk_add_f32 v[92:93], v[92:93], v[100:101]
    v_pk_add_f32 v[94:95], v[94:95], v[102:103]
    v_pk_mul_f32 v[96:97], v[92:93], v[36:37] op_sel_hi:[1,0]
    v_pk_mul_f32 v[98:99], v[94:95], v[36:37] op_sel_hi:[1,0]
    v_exp_f32 v96, v96
    v_exp_f32 v97, v97
    v_exp_f32 v98, v98
    v_exp_f32 v99, v99
    s_waitcnt lgkmcnt(0)
    v_pk_mul_f32 v[92:93], v[92:93], v[88:89]
    v_pk_mul_f32 v[94:95], v[94:95], v[90:91]
    v_pk_add_f32 v[96:97], v[96:97], v[38:39] op_sel_hi:[1,0]
    v_pk_add_f32 v[98:99], v[98:99], v[38:39] op_sel_hi:[1,0]
    v_rcp_f32 v96, v96
    v_rcp_f32 v97, v97
    v_rcp_f32 v98, v98
    v_rcp_f32 v99, v99
    v_pk_fma_f32 v[92:93], v[92:93], v[96:97], v[136:137]
    v_pk_fma_f32 v[94:95], v[94:95], v[98:99], v[138:139]
    v_cvt_pk_bf16_f32 v110, v92, v93
    v_cvt_pk_bf16_f32 v111, v94, v95
    buffer_store_dwordx2 v[110:111], v25, s[24:27], s76 offen offset:1024 sc1
    s_endpgm
L_f_w0:
    v_and_b32 v1, 15, v0
    s_lshl_b32 s77, s71, 7
    v_lshl_add_u32 v1, v1, 3, s77
    s_lshl_b32 s77, s70, 5
    s_add_u32 s77, s77, s4
    s_lshl_b32 s77, s77, 11
    v_and_b32 v2, 48, v0
    v_lshlrev_b32 v2, 9, v2
    v_add3_u32 v25, v1, v2, s77
    s_mov_b32 s76, 0x8000
    s_lshr_b32 s3, s2, 3
    s_lshl_b32 s77, s3, 7
    v_lshl_add_u32 v124, v0, 12, s77
    v_min_u32 v124, s50, v124
    v_mov_b32 v125, 0
    v_lshl_add_u64 v[124:125], v[124:125], 0, s[48:49]
    buffer_load_dwordx2 v[112:113], v1, s[36:39], 0 offen
    ds_read_b64_tr_b16 a[176:177], v21 offset:49152
    ds_read_b64_tr_b16 a[178:179], v21 offset:50176
    ds_read_b64_tr_b16 a[180:181], v22 offset:49152
    ds_read_b64_tr_b16 a[182:183], v22 offset:50176
    ds_read_b64_tr_b16 a[184:185], v19 offset:49152
    ds_read_b64_tr_b16 a[186:187], v19 offset:50176
    buffer_load_dwordx2 v[104:105], v25, s[8:11], 0 offen offset:0
    ds_read_b64_tr_b16 a[188:189], v20 offset:49152
    ds_read_b64_tr_b16 a[190:191], v20 offset:50176
    v_add_u32 v30, 65536, v21
    v_add_u32 v31, 65536, v22
    v_add_u32 v32, 65536, v19
    v_add_u32 v33, 65536, v20
    buffer_load_dwordx2 v[106:107], v25, s[8:11], s76 offen offset:0
    ds_read_b64_tr_b16 a[192:193], v30 offset:16384
    ds_read_b64_tr_b16 a[194:195], v30 offset:17408
    ds_read_b64_tr_b16 a[196:197], v31 offset:16384
    ds_read_b64_tr_b16 a[198:199], v31 offset:17408
    ds_read_b64_tr_b16 a[200:201], v32 offset:16384
    ds_read_b64_tr_b16 a[202:203], v32 offset:17408
    ds_read_b64_tr_b16 a[204:205], v33 offset:16384
    buffer_load_dwordx2 v[108:109], v25, s[8:11], 0 offen offset:1024
    ds_read_b64_tr_b16 a[206:207], v33 offset:17408
    s_lshr_b32 s91, s70, 1
    s_lshl_b32 s91, s91, 12
    s_add_u32 s91, s91, 10485760
    v_lshlrev_b32 v3, 8, v0
    s_mov_b32 s93, 0
    s_mov_b32 s92, 0xff00
    buffer_load_dwordx2 v[110:111], v25, s[8:11], s76 offen offset:1024
    ds_read_b64_tr_b16 a[208:209], v21 offset:0
    ds_read_b64_tr_b16 a[210:211], v21 offset:1024
    ds_read_b64_tr_b16 a[212:213], v22 offset:0
    ds_read_b64_tr_b16 a[214:215], v22 offset:1024
    ds_read_b64_tr_b16 a[216:217], v19 offset:0
    ds_read_b64_tr_b16 a[218:219], v19 offset:1024
    global_load_dword v9, v[124:125], off
    ds_read_b64_tr_b16 a[220:221], v20 offset:0
    ds_read_b64_tr_b16 a[222:223], v20 offset:1024
    ds_read_b64_tr_b16 a[224:225], v21 offset:16384
    ds_read_b64_tr_b16 a[226:227], v21 offset:17408
    ds_read_b64_tr_b16 a[228:229], v22 offset:16384
    ds_read_b64_tr_b16 a[230:231], v22 offset:17408
    buffer_load_dwordx4 v17, s[20:23], s88 offen offset:2048 lds
    ds_read_b64_tr_b16 a[232:233], v19 offset:16384
    ds_read_b64_tr_b16 a[234:235], v19 offset:17408
    ds_read_b64_tr_b16 a[236:237], v20 offset:16384
    ds_read_b64_tr_b16 a[238:239], v20 offset:17408
    v_add_u32 v26, -65536, v21
    v_add_u32 v27, -65536, v22
    v_add_u32 v28, -65536, v19
    buffer_load_dwordx4 v18, s[20:23], s88 offen offset:3072 lds
    s_add_u32 s88, s88, 32768
    s_cmp_eq_u32 s88, s78
    s_cselect_b32 s88, 0, s88
    v_add_u32 v29, -65536, v20
    ds_read_b64_tr_b16 a[240:241], v26 offset:32768
    ds_read_b64_tr_b16 a[242:243], v26 offset:33792
    ds_read_b64_tr_b16 a[244:245], v27 offset:32768
    ds_read_b64_tr_b16 a[246:247], v27 offset:33792
    ds_read_b64_tr_b16 a[248:249], v28 offset:32768
    s_waitcnt lgkmcnt(15)
    s_add_u32 m0, s90, 114688
    s_nop 0
    buffer_load_dwordx4 v15, s[20:23], s88 offen offset:0 lds
    ds_read_b64_tr_b16 a[250:251], v28 offset:33792
    ds_read_b64_tr_b16 a[252:253], v29 offset:32768
    ds_read_b64_tr_b16 a[254:255], v29 offset:33792
    ds_read_b64_tr_b16 a[0:1], v30 offset:0
    ds_read_b64_tr_b16 a[2:3], v30 offset:1024
    ds_read_b64_tr_b16 a[4:5], v31 offset:0
    buffer_load_dwordx4 v16, s[20:23], s88 offen offset:1024 lds
    ds_read_b64_tr_b16 a[6:7], v31 offset:1024
    ds_read_b64_tr_b16 a[8:9], v32 offset:0
    ds_read_b64_tr_b16 a[10:11], v32 offset:1024
    ds_read_b64_tr_b16 a[12:13], v33 offset:0
    ds_read_b64_tr_b16 a[14:15], v33 offset:1024
    ds_read_b64_tr_b16 a[16:17], v26 offset:49152
    buffer_load_dwordx4 v17, s[20:23], s88 offen offset:2048 lds
    ds_read_b64_tr_b16 a[18:19], v26 offset:50176
    ds_read_b64_tr_b16 a[20:21], v27 offset:49152
    ds_read_b64_tr_b16 a[22:23], v27 offset:50176
    ds_read_b64_tr_b16 a[24:25], v28 offset:49152
    ds_read_b64_tr_b16 a[26:27], v28 offset:50176
    ds_read_b64_tr_b16 a[28:29], v29 offset:49152
    ds_read_b64_tr_b16 a[30:31], v29 offset:50176
    buffer_load_dwordx4 v18, s[20:23], s88 offen offset:3072 lds
    s_add_u32 s88, s88, 32768
    s_cmp_eq_u32 s88, s78
    s_cselect_b32 s88, 0, s88
    s_waitcnt vmcnt(19)
    ds_read_b64_tr_b16 a[32:33], v26 offset:0
    ds_read_b64_tr_b16 a[34:35], v26 offset:1024
    ds_read_b64_tr_b16 a[36:37], v27 offset:0
    ds_read_b64_tr_b16 a[38:39], v27 offset:1024
    ds_read_b64_tr_b16 a[40:41], v28 offset:0
    ds_read_b64_tr_b16 a[42:43], v28 offset:1024
    s_add_u32 m0, s90, 147456
    s_nop 0
    buffer_load_dwordx4 v15, s[20:23], s88 offen offset:0 lds
    ds_read_b64_tr_b16 a[44:45], v29 offset:0
    ds_read_b64_tr_b16 a[46:47], v29 offset:1024
    s_waitcnt vmcnt(16)
    ds_read_b64_tr_b16 a[48:49], v26 offset:16384
    ds_read_b64_tr_b16 a[50:51], v26 offset:17408
    ds_read_b64_tr_b16 a[52:53], v27 offset:16384
    ds_read_b64_tr_b16 a[54:55], v27 offset:17408
    buffer_load_dwordx4 v16, s[20:23], s88 offen offset:1024 lds
    ds_read_b64_tr_b16 a[56:57], v28 offset:16384
    ds_read_b64_tr_b16 a[58:59], v28 offset:17408
    ds_read_b64_tr_b16 a[60:61], v29 offset:16384
    ds_read_b64_tr_b16 a[62:63], v29 offset:17408
    v_and_b32 v23, 15, v0
    v_lshlrev_b32 v23, 4, v23
    v_and_b32 v24, 16, v0
    s_mov_b64 exec, s[92:93]
    buffer_load_dword v4, v3, s[16:19], s91 offen sc1
    s_mov_b64 exec, -1
    v_lshl_add_u32 v23, v24, 5, v23
    v_and_b32 v24, 32, v0
    v_lshl_add_u32 v34, v24, 6, v23
    v_bfe_u32 v24, v0, 2, 1
    v_xor_b32 v24, v24, v0
    v_and_b32 v24, 3, v24
    v_and_b32 v23, 12, v0
    buffer_load_dwordx4 v17, s[20:23], s88 offen offset:2048 lds
    v_lshlrev_b32 v23, 8, v23
    v_lshl_add_u32 v23, v24, 4, v23
    v_and_b32 v24, 48, v0
    v_lshl_add_u32 v23, v24, 2, v23
    v_lshl_add_u32 v23, s4, 8, v23
    v_mov_b32 v36, 0xbfb8aa3b
    v_mov_b32 v38, 1.0
    buffer_load_dwordx4 v18, s[20:23], s88 offen offset:3072 lds
    s_add_u32 s88, s88, 32768
    s_cmp_eq_u32 s88, s78
    s_cselect_b32 s88, 0, s88
    s_add_u32 s52, s89, 4096
    s_cmp_eq_u32 s52, s79
    s_cselect_b32 s52, 0, s52
    s_add_u32 s53, s52, 4096
    s_cmp_eq_u32 s53, s79
    s_cselect_b32 s53, 0, s53
    s_add_u32 s54, s53, 4096
    s_cmp_eq_u32 s54, s79
    s_cselect_b32 s54, 0, s54
    s_waitcnt lgkmcnt(15)
    s_add_u32 m0, s90, 65536
    s_nop 0
    buffer_load_dwordx4 v15, s[20:23], s88 offen offset:0 lds
    s_waitcnt vmcnt(10)
    ds_read_b64_tr_b16 a[64:65], v21 offset:32768
    ds_read_b64_tr_b16 a[66:67], v21 offset:33792
    ds_read_b64_tr_b16 a[68:69], v22 offset:32768
    ds_read_b64_tr_b16 a[70:71], v22 offset:33792
    ds_read_b64_tr_b16 a[72:73], v19 offset:32768
    ds_read_b64_tr_b16 a[74:75], v19 offset:33792
    buffer_load_dwordx4 v16, s[20:23], s88 offen offset:1024 lds
    ds_read_b64_tr_b16 a[76:77], v20 offset:32768
    ds_read_b64_tr_b16 a[78:79], v20 offset:33792
    s_add_u32 s55, s54, 4096
    s_cmp_eq_u32 s55, s79
    s_cselect_b32 s55, 0, s55
    s_add_u32 s56, s55, 4096
    s_cmp_eq_u32 s56, s79
    s_cselect_b32 s56, 0, s56
    buffer_load_dwordx4 v17, s[20:23], s88 offen offset:2048 lds
    s_add_u32 s57, s56, 4096
    s_cmp_eq_u32 s57, s79
    s_cselect_b32 s57, 0, s57
    s_add_u32 s58, s57, 4096
    s_cmp_eq_u32 s58, s79
    s_cselect_b32 s58, 0, s58
    s_add_u32 s59, s58, 4096
    s_cmp_eq_u32 s59, s79
    s_cselect_b32 s59, 0, s59
    buffer_load_dwordx4 v18, s[20:23], s88 offen offset:3072 lds
    s_add_u32 s88, s88, 32768
    s_cmp_eq_u32 s88, s78
    s_cselect_b32 s88, 0, s88
    s_add_u32 s60, s59, 4096
    s_cmp_eq_u32 s60, s79
    s_cselect_b32 s60, 0, s60
    s_add_u32 s61, s60, 4096
    s_cmp_eq_u32 s61, s79
    s_cselect_b32 s61, 0, s61
    s_add_u32 s62, s61, 4096
    s_cmp_eq_u32 s62, s79
    s_cselect_b32 s62, 0, s62
    s_waitcnt vmcnt(9)
    ds_read_b64_tr_b16 a[80:81], v21 offset:49152
    ds_read_b64_tr_b16 a[82:83], v21 offset:50176
    ds_read_b64_tr_b16 a[84:85], v22 offset:49152
    ds_read_b64_tr_b16 a[86:87], v22 offset:50176
    ds_read_b64_tr_b16 a[88:89], v19 offset:49152
    ds_read_b64_tr_b16 a[90:91], v19 offset:50176
    ds_read_b64_tr_b16 a[92:93], v20 offset:49152
    ds_read_b64_tr_b16 a[94:95], v20 offset:50176
    s_add_u32 s63, s62, 4096
    s_cmp_eq_u32 s63, s79
    s_cselect_b32 s63, 0, s63
    s_add_u32 s64, s63, 4096
    s_cmp_eq_u32 s64, s79
    s_cselect_b32 s64, 0, s64
    s_add_u32 s65, s64, 4096
    s_cmp_eq_u32 s65, s79
    s_cselect_b32 s65, 0, s65
    s_add_u32 s66, s65, 4096
    s_cmp_eq_u32 s66, s79
    s_cselect_b32 s66, 0, s66
    s_waitcnt vmcnt(6)
    v_cmp_ne_u32 vcc, 1, v4
    s_nop 4
    s_cbranch_vccnz L_f1_go_retry
L_f1_go_ok:
    buffer_load_dwordx4 v[140:143], v34, s[84:87], s89 offen offset:0 sc1
    buffer_load_dwordx4 v[144:147], v34, s[84:87], s52 offen offset:0 sc1
    buffer_load_dwordx4 v[148:151], v34, s[84:87], s53 offen offset:0 sc1
    buffer_load_dwordx4 v[152:155], v34, s[84:87], s54 offen offset:0 sc1
    buffer_load_dwordx4 v[156:159], v34, s[84:87], s55 offen offset:0 sc1
    buffer_load_dwordx4 v[160:163], v34, s[84:87], s56 offen offset:0 sc1
    buffer_load_dwordx4 v[164:167], v34, s[84:87], s57 offen offset:0 sc1
    buffer_load_dwordx4 v[168:171], v34, s[84:87], s58 offen offset:0 sc1
    buffer_load_dwordx4 v[172:175], v34, s[84:87], s59 offen offset:0 sc1
    buffer_load_dwordx4 v[176:179], v34, s[84:87], s60 offen offset:0 sc1
    buffer_load_dwordx4 v[180:183], v34, s[84:87], s61 offen offset:0 sc1
    buffer_load_dwordx4 v[184:187], v34, s[84:87], s62 offen offset:0 sc1
    s_mov_b32 m0, s90
    v_lshlrev_b32 v124, 16, v104
    v_and_b32 v125, 0xffff0000, v104
    v_lshlrev_b32 v126, 16, v105
    v_and_b32 v127, 0xffff0000, v105
    v_lshlrev_b32 v128, 16, v106
    v_and_b32 v129, 0xffff0000, v106
    v_lshlrev_b32 v130, 16, v107
    v_and_b32 v131, 0xffff0000, v107
    v_lshlrev_b32 v132, 16, v108
    v_and_b32 v133, 0xffff0000, v108
    v_lshlrev_b32 v134, 16, v109
    v_and_b32 v135, 0xffff0000, v109
    v_lshlrev_b32 v136, 16, v110
    v_and_b32 v137, 0xffff0000, v110
    v_lshlrev_b32 v138, 16, v111
    v_and_b32 v139, 0xffff0000, v111
    v_lshlrev_b32 v116, 16, v112
    v_and_b32 v117, 0xffff0000, v112
    v_lshlrev_b32 v118, 16, v113
    v_and_b32 v119, 0xffff0000, v113
    s_waitcnt vmcnt(11)
    v_mfma_f32_16x16x32_bf16 v[40:43], v[140:143], a[128:131], 0
    buffer_load_dwordx4 v[188:191], v34, s[84:87], s63 offen offset:0 sc1
    v_mfma_f32_16x16x32_bf16 v[44:47], v[140:143], a[132:135], 0
    ds_read_b64_tr_b16 a[96:97], v30 offset:16384
    ds_read_b64_tr_b16 a[98:99], v30 offset:17408
    v_mfma_f32_16x16x32_bf16 v[48:51], v[140:143], a[136:139], 0
    ds_read_b64_tr_b16 a[100:101], v31 offset:16384
    v_mfma_f32_16x16x32_bf16 v[52:55], v[140:143], a[140:143], 0
    ds_read_b64_tr_b16 a[102:103], v31 offset:17408
    s_waitcnt vmcnt(11)
    v_mfma_f32_16x16x32_bf16 v[40:43], v[144:147], a[144:147], v[40:43]
    buffer_load_dwordx4 v[192:195], v34, s[84:87], s64 offen offset:0 sc1
    v_mfma_f32_16x16x32_bf16 v[44:47], v[144:147], a[148:151], v[44:47]
    ds_read_b64_tr_b16 a[104:105], v32 offset:16384
    ds_read_b64_tr_b16 a[106:107], v32 offset:17408
    v_mfma_f32_16x16x32_bf16 v[48:51], v[144:147], a[152:155], v[48:51]
    ds_read_b64_tr_b16 a[108:109], v33 offset:16384
    v_mfma_f32_16x16x32_bf16 v[52:55], v[144:147], a[156:159], v[52:55]
    ds_read_b64_tr_b16 a[110:111], v33 offset:17408
    s_waitcnt vmcnt(11)
    v_mfma_f32_16x16x32_bf16 v[40:43], v[148:151], a[160:163], v[40:43]
    buffer_load_dwordx4 v[140:143], v34, s[84:87], s65 offen offset:0 sc1
    v_mfma_f32_16x16x32_bf16 v[44:47], v[148:151], a[164:167], v[44:47]
    ds_read_b64_tr_b16 a[112:113], v21 offset:0
    ds_read_b64_tr_b16 a[114:115], v21 offset:1024
    v_mfma_f32_16x16x32_bf16 v[48:51], v[148:151], a[168:171], v[48:51]
    ds_read_b64_tr_b16 a[116:117], v22 offset:0
    v_mfma_f32_16x16x32_bf16 v[52:55], v[148:151], a[172:175], v[52:55]
    ds_read_b64_tr_b16 a[118:119], v22 offset:1024
    s_waitcnt vmcnt(11)
    v_mfma_f32_16x16x32_bf16 v[40:43], v[152:155], a[176:179], v[40:43]
    buffer_load_dwordx4 v[144:147], v34, s[84:87], s66 offen offset:0 sc1
    v_mfma_f32_16x16x32_bf16 v[44:47], v[152:155], a[180:183], v[44:47]
    ds_read_b64_tr_b16 a[120:121], v19 offset:0
    ds_read_b64_tr_b16 a[122:123], v19 offset:1024
    v_mfma_f32_16x16x32_bf16 v[48:51], v[152:155], a[184:187], v[48:51]
    ds_read_b64_tr_b16 a[124:125], v20 offset:0
    v_mfma_f32_16x16x32_bf16 v[52:55], v[152:155], a[188:191], v[52:55]
    ds_read_b64_tr_b16 a[126:127], v20 offset:1024
    s_waitcnt vmcnt(11)
    v_mfma_f32_16x16x32_bf16 v[40:43], v[156:159], a[192:195], v[40:43]
    buffer_load_dwordx4 v[148:151], v34, s[84:87], s89 offen offset:256 sc1
    v_mfma_f32_16x16x32_bf16 v[44:47], v[156:159], a[196:199], v[44:47]
    v_mfma_f32_16x16x32_bf16 v[48:51], v[156:159], a[200:203], v[48:51]
    v_mfma_f32_16x16x32_bf16 v[52:55], v[156:159], a[204:207], v[52:55]
    s_waitcnt vmcnt(11)
    v_mfma_f32_16x16x32_bf16 v[40:43], v[160:163], a[208:211], v[40:43]
    buffer_load_dwordx4 v[152:155], v34, s[84:87], s52 offen offset:256 sc1
    v_mfma_f32_16x16x32_bf16 v[44:47], v[160:163], a[212:215], v[44:47]
    v_mfma_f32_16x16x32_bf16 v[48:51], v[160:163], a[216:219], v[48:51]
    v_mfma_f32_16x16x32_bf16 v[52:55], v[160:163], a[220:223], v[52:55]
    s_waitcnt vmcnt(11)
    v_mfma_f32_16x16x32_bf16 v[40:43], v[164:167], a[224:227], v[40:43]
    buffer_load_dwordx4 v[156:159], v34, s[84:87], s53 offen offset:256 sc1
    v_mfma_f32_16x16x32_bf16 v[44:47], v[164:167], a[228:231], v[44:47]
    v_mfma_f32_16x16x32_bf16 v[48:51], v[164:167], a[232:235], v[48:51]
    v_mfma_f32_16x16x32_bf16 v[52:55], v[164:167], a[236:239], v[52:55]
    s_waitcnt vmcnt(11)
    v_mfma_f32_16x16x32_bf16 v[40:43], v[168:171], a[240:243], v[40:43]
    buffer_load_dwordx4 v[160:163], v34, s[84:87], s54 offen offset:256 sc1
    v_mfma_f32_16x16x32_bf16 v[44:47], v[168:171], a[244:247], v[44:47]
    v_mfma_f32_16x16x32_bf16 v[48:51], v[168:171], a[248:251], v[48:51]
    v_mfma_f32_16x16x32_bf16 v[52:55], v[168:171], a[252:255], v[52:55]
    s_waitcnt vmcnt(11)
    v_mfma_f32_16x16x32_bf16 v[40:43], v[172:175], a[0:3], v[40:43]
    buffer_load_dwordx4 v[164:167], v34, s[84:87], s55 offen offset:256 sc1
    v_mfma_f32_16x16x32_bf16 v[44:47], v[172:175], a[4:7], v[44:47]
    v_mfma_f32_16x16x32_bf16 v[48:51], v[172:175], a[8:11], v[48:51]
    v_mfma_f32_16x16x32_bf16 v[52:55], v[172:175], a[12:15], v[52:55]
    s_waitcnt vmcnt(11)
    v_mfma_f32_16x16x32_bf16 v[40:43], v[176:179], a[16:19], v[40:43]
    buffer_load_dwordx4 v[168:171], v34, s[84:87], s56 offen offset:256 sc1
    v_mfma_f32_16x16x32_bf16 v[44:47], v[176:179], a[20:23], v[44:47]
    v_mfma_f32_16x16x32_bf16 v[48:51], v[176:179], a[24:27], v[48:51]
    v_mfma_f32_16x16x32_bf16 v[52:55], v[176:179], a[28:31], v[52:55]
    s_waitcnt vmcnt(11) lgkmcnt(15)
    v_mfma_f32_16x16x32_bf16 v[40:43], v[180:183], a[32:35], v[40:43]
    buffer_load_dwordx4 v[172:175], v34, s[84:87], s57 offen offset:256 sc1
    v_mfma_f32_16x16x32_bf16 v[44:47], v[180:183], a[36:39], v[44:47]
    v_mfma_f32_16x16x32_bf16 v[48:51], v[180:183], a[40:43], v[48:51]
    v_mfma_f32_16x16x32_bf16 v[52:55], v[180:183], a[44:47], v[52:55]
    s_waitcnt vmcnt(11)
    v_mfma_f32_16x16x32_bf16 v[40:43], v[184:187], a[48:51], v[40:43]
    buffer_load_dwordx4 v[176:179], v34, s[84:87], s58 offen offset:256 sc1
    v_mfma_f32_16x16x32_bf16 v[44:47], v[184:187], a[52:55], v[44:47]
    v_mfma_f32_16x16x32_bf16 v[48:51], v[184:187], a[56:59], v[48:51]
    v_mfma_f32_16x16x32_bf16 v[52:55], v[184:187], a[60:63], v[52:55]
    s_waitcnt vmcnt(11)
    v_mfma_f32_16x16x32_bf16 v[40:43], v[188:191], a[64:67], v[40:43]
    buffer_load_dwordx4 v[180:183], v34, s[84:87], s59 offen offset:256 sc1
    v_mfma_f32_16x16x32_bf16 v[44:47], v[188:191], a[68:71], v[44:47]
    v_mfma_f32_16x16x32_bf16 v[48:51], v[188:191], a[72:75], v[48:51]
    v_mfma_f32_16x16x32_bf16 v[52:55], v[188:191], a[76:79], v[52:55]
    s_waitcnt vmcnt(11)
    v_mfma_f32_16x16x32_bf16 v[40:43], v[192:195], a[80:83], v[40:43]
    buffer_load_dwordx4 v[184:187], v34, s[84:87], s60 offen offset:256 sc1
    v_mfma_f32_16x16x32_bf16 v[44:47], v[192:195], a[84:87], v[44:47]
    v_mfma_f32_16x16x32_bf16 v[48:51], v[192:195], a[88:91], v[48:51]
    v_mfma_f32_16x16x32_bf16 v[52:55], v[192:195], a[92:95], v[52:55]
    s_waitcnt vmcnt(11) lgkmcnt(14)
    v_mfma_f32_16x16x32_bf16 v[40:43], v[140:143], a[96:99], v[40:43]
    buffer_load_dwordx4 v[188:191], v34, s[84:87], s61 offen offset:256 sc1
    s_waitcnt lgkmcnt(12)
    v_mfma_f32_16x16x32_bf16 v[44:47], v[140:143], a[100:103], v[44:47]
    s_waitcnt lgkmcnt(10)
    v_mfma_f32_16x16x32_bf16 v[48:51], v[140:143], a[104:107], v[48:51]
    s_waitcnt lgkmcnt(8)
    v_mfma_f32_16x16x32_bf16 v[52:55], v[140:143], a[108:111], v[52:55]
    s_waitcnt vmcnt(11) lgkmcnt(6)
    v_mfma_f32_16x16x32_bf16 v[40:43], v[144:147], a[112:115], v[40:43]
    buffer_load_dwordx4 v[192:195], v34, s[84:87], s62 offen offset:256 sc1
    s_waitcnt lgkmcnt(4)
    v_mfma_f32_16x16x32_bf16 v[44:47], v[144:147], a[116:119], v[44:47]
    s_waitcnt lgkmcnt(2)
    v_mfma_f32_16x16x32_bf16 v[48:51], v[144:147], a[120:123], v[48:51]
    s_waitcnt lgkmcnt(0)
    v_mfma_f32_16x16x32_bf16 v[52:55], v[144:147], a[124:127], v[52:55]
    s_waitcnt vmcnt(11)
    v_mfma_f32_16x16x32_bf16 v[56:59], v[148:151], a[128:131], 0
    buffer_load_dwordx4 v[140:143], v34, s[84:87], s63 offen offset:256 sc1
    v_mfma_f32_16x16x32_bf16 v[60:63], v[148:151], a[132:135], 0
    v_mfma_f32_16x16x32_bf16 v[64:67], v[148:151], a[136:139], 0
    ds_write_addtid_b32 v40 offset:0
    v_mfma_f32_16x16x32_bf16 v[68:71], v[148:151], a[140:143], 0
    ds_write_addtid_b32 v41 offset:256
    s_waitcnt vmcnt(11)
    v_mfma_f32_16x16x32_bf16 v[56:59], v[152:155], a[144:147], v[56:59]
    buffer_load_dwordx4 v[144:147], v34, s[84:87], s64 offen offset:256 sc1
    v_mfma_f32_16x16x32_bf16 v[60:63], v[152:155], a[148:151], v[60:63]
    ds_write_addtid_b32 v42 offset:512
    v_mfma_f32_16x16x32_bf16 v[64:67], v[152:155], a[152:155], v[64:67]
    ds_write_addtid_b32 v43 offset:768
    v_mfma_f32_16x16x32_bf16 v[68:71], v[152:155], a[156:159], v[68:71]
    s_waitcnt vmcnt(11)
    v_mfma_f32_16x16x32_bf16 v[56:59], v[156:159], a[160:163], v[56:59]
    buffer_load_dwordx4 v[148:151], v34, s[84:87], s65 offen offset:256 sc1
    v_mfma_f32_16x16x32_bf16 v[60:63], v[156:159], a[164:167], v[60:63]
    ds_write_addtid_b32 v44 offset:1024
    v_mfma_f32_16x16x32_bf16 v[64:67], v[156:159], a[168:171], v[64:67]
    ds_write_addtid_b32 v45 offset:1280
    v_mfma_f32_16x16x32_bf16 v[68:71], v[156:159], a[172:175], v[68:71]
    ds_write_addtid_b32 v46 offset:1536
    s_waitcnt vmcnt(11)
    v_mfma_f32_16x16x32_bf16 v[56:59], v[160:163], a[176:179], v[56:59]
    buffer_load_dwordx4 v[152:155], v34, s[84:87], s66 offen offset:256 sc1
    v_mfma_f32_16x16x32_bf16 v[60:63], v[160:163], a[180:183], v[60:63]
    ds_write_addtid_b32 v47 offset:1792
    v_mfma_f32_16x16x32_bf16 v[64:67], v[160:163], a[184:187], v[64:67]
    ds_write_addtid_b32 v48 offset:2048
    v_mfma_f32_16x16x32_bf16 v[68:71], v[160:163], a[188:191], v[68:71]
    ds_write_addtid_b32 v49 offset:2304
    s_waitcnt vmcnt(11)
    v_mfma_f32_16x16x32_bf16 v[56:59], v[164:167], a[192:195], v[56:59]
    buffer_load_dwordx4 v[156:159], v34, s[84:87], s89 offen offset:1024 sc1
    v_mfma_f32_16x16x32_bf16 v[60:63], v[164:167], a[196:199], v[60:63]
    ds_write_addtid_b32 v50 offset:2560
    v_mfma_f32_16x16x32_bf16 v[64:67], v[164:167], a[200:203], v[64:67]
    ds_write_addtid_b32 v51 offset:2816
    v_mfma_f32_16x16x32_bf16 v[68:71], v[164:167], a[204:207], v[68:71]
    s_waitcnt vmcnt(11)
    v_mfma_f32_16x16x32_bf16 v[56:59], v[168:171], a[208:211], v[56:59]
    buffer_load_dwordx4 v[160:163], v34, s[84:87], s52 offen offset:1024 sc1
    v_mfma_f32_16x16x32_bf16 v[60:63], v[168:171], a[212:215], v[60:63]
    ds_write_addtid_b32 v52 offset:3072
    v_mfma_f32_16x16x32_bf16 v[64:67], v[168:171], a[216:219], v[64:67]
    ds_write_addtid_b32 v53 offset:3328
    v_mfma_f32_16x16x32_bf16 v[68:71], v[168:171], a[220:223], v[68:71]
    ds_write_addtid_b32 v54 offset:3584
    s_waitcnt vmcnt(11)
    v_mfma_f32_16x16x32_bf16 v[56:59], v[172:175], a[224:227], v[56:59]
    buffer_load_dwordx4 v[164:167], v34, s[84:87], s53 offen offset:1024 sc1
    v_mfma_f32_16x16x32_bf16 v[60:63], v[172:175], a[228:231], v[60:63]
    ds_write_addtid_b32 v55 offset:3840
    v_mfma_f32_16x16x32_bf16 v[64:67], v[172:175], a[232:235], v[64:67]
    v_mfma_f32_16x16x32_bf16 v[68:71], v[172:175], a[236:239], v[68:71]
    s_waitcnt vmcnt(11)
    v_mfma_f32_16x16x32_bf16 v[56:59], v[176:179], a[240:243], v[56:59]
    buffer_load_dwordx4 v[168:171], v34, s[84:87], s54 offen offset:1024 sc1
    v_mfma_f32_16x16x32_bf16 v[60:63], v[176:179], a[244:247], v[60:63]
    v_mfma_f32_16x16x32_bf16 v[64:67], v[176:179], a[248:251], v[64:67]
    v_mfma_f32_16x16x32_bf16 v[68:71], v[176:179], a[252:255], v[68:71]
    s_waitcnt vmcnt(11)
    v_mfma_f32_16x16x32_bf16 v[56:59], v[180:183], a[0:3], v[56:59]
    buffer_load_dwordx4 v[172:175], v34, s[84:87], s55 offen offset:1024 sc1
    v_mfma_f32_16x16x32_bf16 v[60:63], v[180:183], a[4:7], v[60:63]
    v_mfma_f32_16x16x32_bf16 v[64:67], v[180:183], a[8:11], v[64:67]
    v_mfma_f32_16x16x32_bf16 v[68:71], v[180:183], a[12:15], v[68:71]
    s_waitcnt vmcnt(11)
    v_mfma_f32_16x16x32_bf16 v[56:59], v[184:187], a[16:19], v[56:59]
    buffer_load_dwordx4 v[176:179], v34, s[84:87], s56 offen offset:1024 sc1
    v_mfma_f32_16x16x32_bf16 v[60:63], v[184:187], a[20:23], v[60:63]
    v_mfma_f32_16x16x32_bf16 v[64:67], v[184:187], a[24:27], v[64:67]
    v_mfma_f32_16x16x32_bf16 v[68:71], v[184:187], a[28:31], v[68:71]
    s_waitcnt vmcnt(11)
    v_mfma_f32_16x16x32_bf16 v[56:59], v[188:191], a[32:35], v[56:59]
    buffer_load_dwordx4 v[180:183], v34, s[84:87], s57 offen offset:1024 sc1
    v_mfma_f32_16x16x32_bf16 v[60:63], v[188:191], a[36:39], v[60:63]
    v_mfma_f32_16x16x32_bf16 v[64:67], v[188:191], a[40:43], v[64:67]
    v_mfma_f32_16x16x32_bf16 v[68:71], v[188:191], a[44:47], v[68:71]
    s_waitcnt vmcnt(11)
    v_mfma_f32_16x16x32_bf16 v[56:59], v[192:195], a[48:51], v[56:59]
    buffer_load_dwordx4 v[184:187], v34, s[84:87], s58 offen offset:1024 sc1
    v_mfma_f32_16x16x32_bf16 v[60:63], v[192:195], a[52:55], v[60:63]
    v_mfma_f32_16x16x32_bf16 v[64:67], v[192:195], a[56:59], v[64:67]
    v_mfma_f32_16x16x32_bf16 v[68:71], v[192:195], a[60:63], v[68:71]
    s_waitcnt vmcnt(11)
    v_mfma_f32_16x16x32_bf16 v[56:59], v[140:143], a[64:67], v[56:59]
    buffer_load_dwordx4 v[188:191], v34, s[84:87], s59 offen offset:1024 sc1
    v_mfma_f32_16x16x32_bf16 v[60:63], v[140:143], a[68:71], v[60:63]
    v_mfma_f32_16x16x32_bf16 v[64:67], v[140:143], a[72:75], v[64:67]
    v_mfma_f32_16x16x32_bf16 v[68:71], v[140:143], a[76:79], v[68:71]
    s_waitcnt vmcnt(11)
    v_mfma_f32_16x16x32_bf16 v[56:59], v[144:147], a[80:83], v[56:59]
    buffer_load_dwordx4 v[192:195], v34, s[84:87], s60 offen offset:1024 sc1
    v_mfma_f32_16x16x32_bf16 v[60:63], v[144:147], a[84:87], v[60:63]
    v_mfma_f32_16x16x32_bf16 v[64:67], v[144:147], a[88:91], v[64:67]
    v_mfma_f32_16x16x32_bf16 v[68:71], v[144:147], a[92:95], v[68:71]
    s_waitcnt vmcnt(11)
    v_mfma_f32_16x16x32_bf16 v[56:59], v[148:151], a[96:99], v[56:59]
    buffer_load_dwordx4 v[140:143], v34, s[84:87], s61 offen offset:1024 sc1
    v_mfma_f32_16x16x32_bf16 v[60:63], v[148:151], a[100:103], v[60:63]
    v_mfma_f32_16x16x32_bf16 v[64:67], v[148:151], a[104:107], v[64:67]
    v_mfma_f32_16x16x32_bf16 v[68:71], v[148:151], a[108:111], v[68:71]
    s_waitcnt vmcnt(11)
    v_mfma_f32_16x16x32_bf16 v[56:59], v[152:155], a[112:115], v[56:59]
    buffer_load_dwordx4 v[144:147], v34, s[84:87], s62 offen offset:1024 sc1
    v_mfma_f32_16x16x32_bf16 v[60:63], v[152:155], a[116:119], v[60:63]
    v_mfma_f32_16x16x32_bf16 v[64:67], v[152:155], a[120:123], v[64:67]
    v_mfma_f32_16x16x32_bf16 v[68:71], v[152:155], a[124:127], v[68:71]
    s_waitcnt vmcnt(11)
    v_mfma_f32_16x16x32_bf16 v[72:75], v[156:159], a[128:131], 0
    buffer_load_dwordx4 v[148:151], v34, s[84:87], s63 offen offset:1024 sc1
    v_mfma_f32_16x16x32_bf16 v[76:79], v[156:159], a[132:135], 0
    v_mfma_f32_16x16x32_bf16 v[80:83], v[156:159], a[136:139], 0
    ds_write_addtid_b32 v56 offset:16384
    v_mfma_f32_16x16x32_bf16 v[84:87], v[156:159], a[140:143], 0
    s_waitcnt lgkmcnt(1)
    s_barrier
    s_waitcnt vmcnt(11)
    v_mfma_f32_16x16x32_bf16 v[72:75], v[160:163], a[144:147], v[72:75]
    buffer_load_dwordx4 v[152:155], v34, s[84:87], s64 offen offset:1024 sc1
    v_mfma_f32_16x16x32_bf16 v[76:79], v[160:163], a[148:151], v[76:79]
    ds_write_addtid_b32 v57 offset:16640
    ds_read_b128 v[44:47], v23 offset:4096
    ds_read_b128 v[48:51], v23 offset:8192
    v_mfma_f32_16x16x32_bf16 v[80:83], v[160:163], a[152:155], v[80:83]
    ds_write_addtid_b32 v58 offset:16896
    ds_write_addtid_b32 v59 offset:17152
    v_mfma_f32_16x16x32_bf16 v[84:87], v[160:163], a[156:159], v[84:87]
    ds_read_b128 v[52:55], v23 offset:12288
    ds_read_b128 v[40:43], v23 offset:0
    s_waitcnt vmcnt(11)
    v_mfma_f32_16x16x32_bf16 v[72:75], v[164:167], a[160:163], v[72:75]
    buffer_load_dwordx4 v[156:159], v34, s[84:87], s65 offen offset:1024 sc1
    v_mfma_f32_16x16x32_bf16 v[76:79], v[164:167], a[164:167], v[76:79]
    ds_write_addtid_b32 v60 offset:17408
    v_mfma_f32_16x16x32_bf16 v[80:83], v[164:167], a[168:171], v[80:83]
    ds_write_addtid_b32 v61 offset:17664
    v_mfma_f32_16x16x32_bf16 v[84:87], v[164:167], a[172:175], v[84:87]
    ds_write_addtid_b32 v62 offset:17920
    s_waitcnt vmcnt(11)
    v_mfma_f32_16x16x32_bf16 v[72:75], v[168:171], a[176:179], v[72:75]
    buffer_load_dwordx4 v[160:163], v34, s[84:87], s66 offen offset:1024 sc1
    v_mfma_f32_16x16x32_bf16 v[76:79], v[168:171], a[180:183], v[76:79]
    ds_write_addtid_b32 v63 offset:18176
    v_mfma_f32_16x16x32_bf16 v[80:83], v[168:171], a[184:187], v[80:83]
    ds_write_addtid_b32 v64 offset:18432
    s_waitcnt lgkmcnt(10)
    v_add_f32 v44, v44, v116
    v_mfma_f32_16x16x32_bf16 v[84:87], v[168:171], a[188:191], v[84:87]
    v_add_f32 v45, v45, v117
    s_waitcnt vmcnt(11)
    v_mfma_f32_16x16x32_bf16 v[72:75], v[172:175], a[192:195], v[72:75]
    buffer_load_dwordx4 v[164:167], v34, s[84:87], s89 offen offset:1280 sc1
    v_mfma_f32_16x16x32_bf16 v[76:79], v[172:175], a[196:199], v[76:79]
    ds_write_addtid_b32 v65 offset:18688
    ds_write_addtid_b32 v66 offset:18944
    v_mfma_f32_16x16x32_bf16 v[80:83], v[172:175], a[200:203], v[80:83]
    ds_write_addtid_b32 v67 offset:19200
    v_mfma_f32_16x16x32_bf16 v[84:87], v[172:175], a[204:207], v[84:87]
    v_add_f32 v46, v46, v118
    s_waitcnt vmcnt(11)
    v_mfma_f32_16x16x32_bf16 v[72:75], v[176:179], a[208:211], v[72:75]
    buffer_load_dwordx4 v[168:171], v34, s[84:87], s52 offen offset:1280 sc1
    v_mfma_f32_16x16x32_bf16 v[76:79], v[176:179], a[212:215], v[76:79]
    ds_write_addtid_b32 v68 offset:19456
    v_mfma_f32_16x16x32_bf16 v[80:83], v[176:179], a[216:219], v[80:83]
    ds_write_addtid_b32 v69 offset:19712
    v_add_f32 v47, v47, v119
    v_mfma_f32_16x16x32_bf16 v[84:87], v[176:179], a[220:223], v[84:87]
    ds_write_addtid_b32 v70 offset:19968
    s_waitcnt vmcnt(11)
    v_mfma_f32_16x16x32_bf16 v[72:75], v[180:183], a[224:227], v[72:75]
    buffer_load_dwordx4 v[172:175], v34, s[84:87], s53 offen offset:1280 sc1
    v_mfma_f32_16x16x32_bf16 v[76:79], v[180:183], a[228:231], v[76:79]
    ds_write_addtid_b32 v71 offset:20224
    s_waitcnt lgkmcnt(15)
    v_add_f32 v44, v44, v48
    v_mfma_f32_16x16x32_bf16 v[80:83], v[180:183], a[232:235], v[80:83]
    v_add_f32 v45, v45, v49
    v_mfma_f32_16x16x32_bf16 v[84:87], v[180:183], a[236:239], v[84:87]
    s_waitcnt vmcnt(11)
    v_mfma_f32_16x16x32_bf16 v[72:75], v[184:187], a[240:243], v[72:75]
    buffer_load_dwordx4 v[176:179], v34, s[84:87], s54 offen offset:1280 sc1
    v_mfma_f32_16x16x32_bf16 v[76:79], v[184:187], a[244:247], v[76:79]
    v_add_f32 v46, v46, v50
    v_add_f32 v47, v47, v51
    v_mfma_f32_16x16x32_bf16 v[80:83], v[184:187], a[248:251], v[80:83]
    s_waitcnt lgkmcnt(13)
    v_add_f32 v44, v44, v52
    v_add_f32 v45, v45, v53
    v_mfma_f32_16x16x32_bf16 v[84:87], v[184:187], a[252:255], v[84:87]
    v_add_f32 v46, v46, v54
    s_waitcnt vmcnt(11)
    v_mfma_f32_16x16x32_bf16 v[72:75], v[188:191], a[0:3], v[72:75]
    buffer_load_dwordx4 v[180:183], v34, s[84:87], s55 offen offset:1280 sc1
    v_mfma_f32_16x16x32_bf16 v[76:79], v[188:191], a[4:7], v[76:79]
    v_add_f32 v47, v47, v55
    v_mul_f32 v48, v44, v36
    v_mfma_f32_16x16x32_bf16 v[80:83], v[188:191], a[8:11], v[80:83]
    v_mul_f32 v49, v45, v36
    v_mul_f32 v50, v46, v36
    v_mfma_f32_16x16x32_bf16 v[84:87], v[188:191], a[12:15], v[84:87]
    v_mul_f32 v51, v47, v36
    s_waitcnt vmcnt(11)
    v_mfma_f32_16x16x32_bf16 v[72:75], v[192:195], a[16:19], v[72:75]
    buffer_load_dwordx4 v[184:187], v34, s[84:87], s56 offen offset:1280 sc1
    v_mfma_f32_16x16x32_bf16 v[76:79], v[192:195], a[20:23], v[76:79]
    v_exp_f32 v48, v48
    v_mfma_f32_16x16x32_bf16 v[80:83], v[192:195], a[24:27], v[80:83]
    v_exp_f32 v49, v49
    v_mfma_f32_16x16x32_bf16 v[84:87], v[192:195], a[28:31], v[84:87]
    s_waitcnt vmcnt(11)
    v_mfma_f32_16x16x32_bf16 v[72:75], v[140:143], a[32:35], v[72:75]
    buffer_load_dwordx4 v[188:191], v34, s[84:87], s57 offen offset:1280 sc1
    v_mfma_f32_16x16x32_bf16 v[76:79], v[140:143], a[36:39], v[76:79]
    v_exp_f32 v50, v50
    v_mfma_f32_16x16x32_bf16 v[80:83], v[140:143], a[40:43], v[80:83]
    v_exp_f32 v51, v51
    v_mfma_f32_16x16x32_bf16 v[84:87], v[140:143], a[44:47], v[84:87]
    s_waitcnt vmcnt(11)
    v_mfma_f32_16x16x32_bf16 v[72:75], v[144:147], a[48:51], v[72:75]
    buffer_load_dwordx4 v[192:195], v34, s[84:87], s58 offen offset:1280 sc1
    v_mfma_f32_16x16x32_bf16 v[76:79], v[144:147], a[52:55], v[76:79]
    s_waitcnt lgkmcnt(12)
    v_mul_f32 v44, v44, v40
    v_mfma_f32_16x16x32_bf16 v[80:83], v[144:147], a[56:59], v[80:83]
    v_mul_f32 v45, v45, v41
    v_mfma_f32_16x16x32_bf16 v[84:87], v[144:147], a[60:63], v[84:87]
    v_mul_f32 v46, v46, v42
    s_waitcnt vmcnt(11)
    v_mfma_f32_16x16x32_bf16 v[72:75], v[148:151], a[64:67], v[72:75]
    buffer_load_dwordx4 v[140:143], v34, s[84:87], s59 offen offset:1280 sc1
    v_mfma_f32_16x16x32_bf16 v[76:79], v[148:151], a[68:71], v[76:79]
    v_mul_f32 v47, v47, v43
    v_add_f32 v48, v48, v38
    v_mfma_f32_16x16x32_bf16 v[80:83], v[148:151], a[72:75], v[80:83]
    v_add_f32 v49, v49, v38
    v_add_f32 v50, v50, v38
    v_mfma_f32_16x16x32_bf16 v[84:87], v[148:151], a[76:79], v[84:87]
    v_add_f32 v51, v51, v38
    s_waitcnt vmcnt(11)
    v_mfma_f32_16x16x32_bf16 v[72:75], v[152:155], a[80:83], v[72:75]
    buffer_load_dwordx4 v[144:147], v34, s[84:87], s60 offen offset:1280 sc1
    v_mfma_f32_16x16x32_bf16 v[76:79], v[152:155], a[84:87], v[76:79]
    v_rcp_f32 v48, v48
    v_mfma_f32_16x16x32_bf16 v[80:83], v[152:155], a[88:91], v[80:83]
    v_rcp_f32 v49, v49
    v_mfma_f32_16x16x32_bf16 v[84:87], v[152:155], a[92:95], v[84:87]
    s_waitcnt vmcnt(11)
    v_mfma_f32_16x16x32_bf16 v[72:75], v[156:159], a[96:99], v[72:75]
    buffer_load_dwordx4 v[148:151], v34, s[84:87], s61 offen offset:1280 sc1
    v_mfma_f32_16x16x32_bf16 v[76:79], v[156:159], a[100:103], v[76:79]
    v_rcp_f32 v50, v50
    v_mfma_f32_16x16x32_bf16 v[80:83], v[156:159], a[104:107], v[80:83]
    v_rcp_f32 v51, v51
    v_mfma_f32_16x16x32_bf16 v[84:87], v[156:159], a[108:111], v[84:87]
    v_fma_f32 v44, v44, v48, v124
    s_waitcnt vmcnt(11)
    v_mfma_f32_16x16x32_bf16 v[72:75], v[160:163], a[112:115], v[72:75]
    buffer_load_dwordx4 v[152:155], v34, s[84:87], s62 offen offset:1280 sc1
    v_mfma_f32_16x16x32_bf16 v[76:79], v[160:163], a[116:119], v[76:79]
    v_fma_f32 v45, v45, v49, v125
    v_fma_f32 v46, v46, v50, v126
    v_mfma_f32_16x16x32_bf16 v[80:83], v[160:163], a[120:123], v[80:83]
    v_fma_f32 v47, v47, v51, v127
    v_cvt_pk_bf16_f32 v104, v44, v45
    v_mfma_f32_16x16x32_bf16 v[84:87], v[160:163], a[124:127], v[84:87]
    v_cvt_pk_bf16_f32 v105, v46, v47
    s_waitcnt vmcnt(11)
    v_mfma_f32_16x16x32_bf16 v[88:91], v[164:167], a[128:131], 0
    buffer_load_dwordx4 v[156:159], v34, s[84:87], s63 offen offset:1280 sc1
    v_mfma_f32_16x16x32_bf16 v[92:95], v[164:167], a[132:135], 0
    buffer_store_dwordx2 v[104:105], v25, s[24:27], 0 offen offset:0 sc1
    v_mfma_f32_16x16x32_bf16 v[96:99], v[164:167], a[136:139], 0
    ds_write_addtid_b32 v72 offset:32768
    v_mfma_f32_16x16x32_bf16 v[100:103], v[164:167], a[140:143], 0
    s_waitcnt vmcnt(12)
    v_mfma_f32_16x16x32_bf16 v[88:91], v[168:171], a[144:147], v[88:91]
    buffer_load_dwordx4 v[160:163], v34, s[84:87], s64 offen offset:1280 sc1
    v_mfma_f32_16x16x32_bf16 v[92:95], v[168:171], a[148:151], v[92:95]
    ds_write_addtid_b32 v73 offset:33024
    v_mfma_f32_16x16x32_bf16 v[96:99], v[168:171], a[152:155], v[96:99]
    ds_write_addtid_b32 v74 offset:33280
    v_mfma_f32_16x16x32_bf16 v[100:103], v[168:171], a[156:159], v[100:103]
    ds_write_addtid_b32 v75 offset:33536
    s_waitcnt vmcnt(12)
    v_mfma_f32_16x16x32_bf16 v[88:91], v[172:175], a[160:163], v[88:91]
    buffer_load_dwordx4 v[164:167], v34, s[84:87], s65 offen offset:1280 sc1
    v_mfma_f32_16x16x32_bf16 v[92:95], v[172:175], a[164:167], v[92:95]
    ds_write_addtid_b32 v76 offset:33792
    v_mfma_f32_16x16x32_bf16 v[96:99], v[172:175], a[168:171], v[96:99]
    ds_write_addtid_b32 v77 offset:34048
    v_mfma_f32_16x16x32_bf16 v[100:103], v[172:175], a[172:175], v[100:103]
    s_waitcnt vmcnt(12)
    v_mfma_f32_16x16x32_bf16 v[88:91], v[176:179], a[176:179], v[88:91]
    buffer_load_dwordx4 v[168:171], v34, s[84:87], s66 offen offset:1280 sc1
    v_mfma_f32_16x16x32_bf16 v[92:95], v[176:179], a[180:183], v[92:95]
    ds_write_addtid_b32 v78 offset:34304
    v_mfma_f32_16x16x32_bf16 v[96:99], v[176:179], a[184:187], v[96:99]
    ds_write_addtid_b32 v79 offset:34560
    v_mfma_f32_16x16x32_bf16 v[100:103], v[176:179], a[188:191], v[100:103]
    s_waitcnt lgkmcnt(8)
    s_barrier
    s_waitcnt vmcnt(12)
    v_mfma_f32_16x16x32_bf16 v[88:91], v[180:183], a[192:195], v[88:91]
    ds_write_addtid_b32 v80 offset:34816
    ds_read_b128 v[60:63], v23 offset:20480
    v_mfma_f32_16x16x32_bf16 v[92:95], v[180:183], a[196:199], v[92:95]
    ds_write_addtid_b32 v81 offset:35072
    ds_read_b128 v[64:67], v23 offset:24576
    v_mfma_f32_16x16x32_bf16 v[96:99], v[180:183], a[200:203], v[96:99]
    ds_write_addtid_b32 v82 offset:35328
    ds_read_b128 v[68:71], v23 offset:28672
    v_mfma_f32_16x16x32_bf16 v[100:103], v[180:183], a[204:207], v[100:103]
    ds_read_b128 v[56:59], v23 offset:16384
    s_waitcnt vmcnt(11)
    v_mfma_f32_16x16x32_bf16 v[88:91], v[184:187], a[208:211], v[88:91]
    ds_write_addtid_b32 v83 offset:35584
    v_mfma_f32_16x16x32_bf16 v[92:95], v[184:187], a[212:215], v[92:95]
    ds_write_addtid_b32 v84 offset:35840
    v_mfma_f32_16x16x32_bf16 v[96:99], v[184:187], a[216:219], v[96:99]
    ds_write_addtid_b32 v85 offset:36096
    v_mfma_f32_16x16x32_bf16 v[100:103], v[184:187], a[220:223], v[100:103]
    ds_write_addtid_b32 v86 offset:36352
    s_waitcnt vmcnt(10)
    v_mfma_f32_16x16x32_bf16 v[88:91], v[188:191], a[224:227], v[88:91]
    s_waitcnt lgkmcnt(9)
    v_add_f32 v60, v60, v116
    v_mfma_f32_16x16x32_bf16 v[92:95], v[188:191], a[228:231], v[92:95]
    ds_write_addtid_b32 v87 offset:36608
    v_mfma_f32_16x16x32_bf16 v[96:99], v[188:191], a[232:235], v[96:99]
    v_add_f32 v61, v61, v117
    v_add_f32 v62, v62, v118
    v_mfma_f32_16x16x32_bf16 v[100:103], v[188:191], a[236:239], v[100:103]
    v_add_f32 v63, v63, v119
    s_waitcnt vmcnt(9)
    v_mfma_f32_16x16x32_bf16 v[88:91], v[192:195], a[240:243], v[88:91]
    v_mfma_f32_16x16x32_bf16 v[92:95], v[192:195], a[244:247], v[92:95]
    s_waitcnt lgkmcnt(8)
    v_add_f32 v60, v60, v64
    v_add_f32 v61, v61, v65
    v_mfma_f32_16x16x32_bf16 v[96:99], v[192:195], a[248:251], v[96:99]
    v_add_f32 v62, v62, v66
    v_mfma_f32_16x16x32_bf16 v[100:103], v[192:195], a[252:255], v[100:103]
    s_waitcnt vmcnt(8)
    v_mfma_f32_16x16x32_bf16 v[88:91], v[140:143], a[0:3], v[88:91]
    v_add_f32 v63, v63, v67
    s_waitcnt lgkmcnt(6)
    v_add_f32 v60, v60, v68
    v_mfma_f32_16x16x32_bf16 v[92:95], v[140:143], a[4:7], v[92:95]
    v_add_f32 v61, v61, v69
    v_mfma_f32_16x16x32_bf16 v[96:99], v[140:143], a[8:11], v[96:99]
    v_add_f32 v62, v62, v70
    v_add_f32 v63, v63, v71
    v_mfma_f32_16x16x32_bf16 v[100:103], v[140:143], a[12:15], v[100:103]
    s_waitcnt vmcnt(7)
    v_mfma_f32_16x16x32_bf16 v[88:91], v[144:147], a[16:19], v[88:91]
    v_mul_f32 v64, v60, v36
    v_mul_f32 v65, v61, v36
    v_mfma_f32_16x16x32_bf16 v[92:95], v[144:147], a[20:23], v[92:95]
    v_mul_f32 v66, v62, v36
    v_mul_f32 v67, v63, v36
    v_mfma_f32_16x16x32_bf16 v[96:99], v[144:147], a[24:27], v[96:99]
    v_exp_f32 v64, v64
    v_mfma_f32_16x16x32_bf16 v[100:103], v[144:147], a[28:31], v[100:103]
    s_waitcnt vmcnt(6)
    v_mfma_f32_16x16x32_bf16 v[88:91], v[148:151], a[32:35], v[88:91]
    v_mfma_f32_16x16x32_bf16 v[92:95], v[148:151], a[36:39], v[92:95]
    v_exp_f32 v65, v65
    v_mfma_f32_16x16x32_bf16 v[96:99], v[148:151], a[40:43], v[96:99]
    v_exp_f32 v66, v66
    v_mfma_f32_16x16x32_bf16 v[100:103], v[148:151], a[44:47], v[100:103]
    s_waitcnt vmcnt(5)
    v_mfma_f32_16x16x32_bf16 v[88:91], v[152:155], a[48:51], v[88:91]
    v_mfma_f32_16x16x32_bf16 v[92:95], v[152:155], a[52:55], v[92:95]
    v_exp_f32 v67, v67
    v_mfma_f32_16x16x32_bf16 v[96:99], v[152:155], a[56:59], v[96:99]
    s_waitcnt lgkmcnt(5)
    v_mul_f32 v60, v60, v56
    v_mul_f32 v61, v61, v57
    v_mfma_f32_16x16x32_bf16 v[100:103], v[152:155], a[60:63], v[100:103]
    v_mul_f32 v62, v62, v58
    s_waitcnt vmcnt(4)
    v_mfma_f32_16x16x32_bf16 v[88:91], v[156:159], a[64:67], v[88:91]
    v_mul_f32 v63, v63, v59
    v_mfma_f32_16x16x32_bf16 v[92:95], v[156:159], a[68:71], v[92:95]
    v_add_f32 v64, v64, v38
    v_add_f32 v65, v65, v38
    v_mfma_f32_16x16x32_bf16 v[96:99], v[156:159], a[72:75], v[96:99]
    v_add_f32 v66, v66, v38
    v_mfma_f32_16x16x32_bf16 v[100:103], v[156:159], a[76:79], v[100:103]
    v_add_f32 v67, v67, v38
    s_waitcnt vmcnt(2)
    v_mfma_f32_16x16x32_bf16 v[88:91], v[160:163], a[80:83], v[88:91]
    v_rcp_f32 v64, v64
    v_mfma_f32_16x16x32_bf16 v[92:95], v[160:163], a[84:87], v[92:95]
    v_mfma_f32_16x16x32_bf16 v[96:99], v[160:163], a[88:91], v[96:99]
    v_rcp_f32 v65, v65
    v_mfma_f32_16x16x32_bf16 v[100:103], v[160:163], a[92:95], v[100:103]
    s_waitcnt vmcnt(1)
    v_mfma_f32_16x16x32_bf16 v[88:91], v[164:167], a[96:99], v[88:91]
    v_rcp_f32 v66, v66
    v_mfma_f32_16x16x32_bf16 v[92:95], v[164:167], a[100:103], v[92:95]
    v_rcp_f32 v67, v67
    v_mfma_f32_16x16x32_bf16 v[96:99], v[164:167], a[104:107], v[96:99]
    v_fma_f32 v60, v60, v64, v128
    v_mfma_f32_16x16x32_bf16 v[100:103], v[164:167], a[108:111], v[100:103]
    v_fma_f32 v61, v61, v65, v129
    s_waitcnt vmcnt(0)
    v_mfma_f32_16x16x32_bf16 v[88:91], v[168:171], a[112:115], v[88:91]
    v_fma_f32 v62, v62, v66, v130
    v_fma_f32 v63, v63, v67, v131
    v_mfma_f32_16x16x32_bf16 v[92:95], v[168:171], a[116:119], v[92:95]
    v_cvt_pk_bf16_f32 v106, v60, v61
    v_mfma_f32_16x16x32_bf16 v[96:99], v[168:171], a[120:123], v[96:99]
    v_cvt_pk_bf16_f32 v107, v62, v63
    v_mfma_f32_16x16x32_bf16 v[100:103], v[168:171], a[124:127], v[100:103]
    buffer_store_dwordx2 v[106:107], v25, s[24:27], s76 offen offset:0 sc1
    ds_write_addtid_b32 v88 offset:49152
    ds_write_addtid_b32 v89 offset:49408
    ds_write_addtid_b32 v90 offset:49664
    ds_write_addtid_b32 v91 offset:49920
    ds_write_addtid_b32 v92 offset:50176
    ds_write_addtid_b32 v93 offset:50432
    ds_write_addtid_b32 v94 offset:50688
    ds_write_addtid_b32 v95 offset:50944
    ds_write_addtid_b32 v96 offset:51200
    ds_write_addtid_b32 v97 offset:51456
    ds_write_addtid_b32 v98 offset:51712
    ds_write_addtid_b32 v99 offset:51968
    ds_write_addtid_b32 v100 offset:52224
    ds_write_addtid_b32 v101 offset:52480
    ds_write_addtid_b32 v102 offset:52736
    ds_write_addtid_b32 v103 offset:52992
    s_waitcnt lgkmcnt(15)
    s_barrier
    ds_read_b128 v[76:79], v23 offset:36864
    ds_read_b128 v[80:83], v23 offset:40960
    ds_read_b128 v[84:87], v23 offset:45056
    ds_read_b128 v[72:75], v23 offset:32768
    s_waitcnt lgkmcnt(3)
    v_pk_add_f32 v[76:77], v[76:77], v[116:117]
    v_pk_add_f32 v[78:79], v[78:79], v[118:119]
    s_waitcnt lgkmcnt(2)
    v_pk_add_f32 v[76:77], v[76:77], v[80:81]
    v_pk_add_f32 v[78:79], v[78:79], v[82:83]
    s_waitcnt lgkmcnt(1)
    v_pk_add_f32 v[76:77], v[76:77], v[84:85]
    v_pk_add_f32 v[78:79], v[78:79], v[86:87]
    v_pk_mul_f32 v[80:81], v[76:77], v[36:37] op_sel_hi:[1,0]
    v_pk_mul_f32 v[82:83], v[78:79], v[36:37] op_sel_hi:[1,0]
    v_exp_f32 v80, v80
    v_exp_f32 v81, v81
    v_exp_f32 v82, v82
    v_exp_f32 v83, v83
    s_waitcnt lgkmcnt(0)
    v_pk_mul_f32 v[76:77], v[76:77], v[72:73]
    v_pk_mul_f32 v[78:79], v[78:79], v[74:75]
    v_pk_add_f32 v[80:81], v[80:81], v[38:39] op_sel_hi:[1,0]
    v_pk_add_f32 v[82:83], v[82:83], v[38:39] op_sel_hi:[1,0]
    v_rcp_f32 v80, v80
    v_rcp_f32 v81, v81
    v_rcp_f32 v82, v82
    v_rcp_f32 v83, v83
    v_pk_fma_f32 v[76:77], v[76:77], v[80:81], v[132:133]
    v_pk_fma_f32 v[78:79], v[78:79], v[82:83], v[134:135]
    v_cvt_pk_bf16_f32 v108, v76, v77
    v_cvt_pk_bf16_f32 v109, v78, v79
    buffer_store_dwordx2 v[108:109], v25, s[24:27], 0 offen offset:1024 sc1
    s_barrier
    ds_read_b128 v[92:95], v23 offset:53248
    ds_read_b128 v[96:99], v23 offset:57344
    ds_read_b128 v[100:103], v23 offset:61440
    ds_read_b128 v[88:91], v23 offset:49152
    s_waitcnt lgkmcnt(3)
    v_pk_add_f32 v[92:93], v[92:93], v[116:117]
    v_pk_add_f32 v[94:95], v[94:95], v[118:119]
    s_waitcnt lgkmcnt(2)
    v_pk_add_f32 v[92:93], v[92:93], v[96:97]
    v_pk_add_f32 v[94:95], v[94:95], v[98:99]
    s_waitcnt lgkmcnt(1)
    v_pk_add_f32 v[92:93], v[92:93], v[100:101]
    v_pk_add_f32 v[94:95], v[94:95], v[102:103]
    v_pk_mul_f32 v[96:97], v[92:93], v[36:37] op_sel_hi:[1,0]
    v_pk_mul_f32 v[98:99], v[94:95], v[36:37] op_sel_hi:[1,0]
    v_exp_f32 v96, v96
    v_exp_f32 v97, v97
    v_exp_f32 v98, v98
    v_exp_f32 v99, v99
    s_waitcnt lgkmcnt(0)
    v_pk_mul_f32 v[92:93], v[92:93], v[88:89]
    v_pk_mul_f32 v[94:95], v[94:95], v[90:91]
    v_pk_add_f32 v[96:97], v[96:97], v[38:39] op_sel_hi:[1,0]
    v_pk_add_f32 v[98:99], v[98:99], v[38:39] op_sel_hi:[1,0]
    v_rcp_f32 v96, v96
    v_rcp_f32 v97, v97
    v_rcp_f32 v98, v98
    v_rcp_f32 v99, v99
    v_pk_fma_f32 v[92:93], v[92:93], v[96:97], v[136:137]
    v_pk_fma_f32 v[94:95], v[94:95], v[98:99], v[138:139]
    v_cvt_pk_bf16_f32 v110, v92, v93
    v_cvt_pk_bf16_f32 v111, v94, v95
    buffer_store_dwordx2 v[110:111], v25, s[24:27], s76 offen offset:1024 sc1
    s_endpgm
L_f_rdy_retry:
    s_mov_b32 s82, 1048576
L_f_rdy_loop:
    buffer_load_dword v9, off, s[28:31], 0 sc1
    s_sub_u32 s82, s82, 1
    s_cbranch_scc1 L_f_rdy_ok
    s_waitcnt vmcnt(0)
    v_readfirstlane_b32 s3, v9
    s_nop 3
    s_cmp_eq_u32 s3, 0
    s_cbranch_scc1 L_f_rdy_loop
    s_branch L_f_rdy_ok
L_f0_go_retry:
    s_mov_b32 s82, 1048576
L_f0_go_loop:
    s_mov_b64 exec, s[92:93]
    buffer_load_dword v4, v3, s[16:19], s91 offen sc1
    s_mov_b64 exec, -1
    s_sub_u32 s82, s82, 1
    s_cbranch_scc1 L_f0_go_ok
    s_waitcnt vmcnt(0)
    v_cmp_ne_u32 vcc, 1, v4
    s_nop 4
    s_cbranch_vccnz L_f0_go_loop
    s_branch L_f0_go_ok
L_f1_go_retry:
    s_mov_b32 s82, 1048576
L_f1_go_loop:
    s_mov_b64 exec, s[92:93]
    buffer_load_dword v4, v3, s[16:19], s91 offen sc1
    s_mov_b64 exec, -1
    s_sub_u32 s82, s82, 1
    s_cbranch_scc1 L_f1_go_ok
    s_waitcnt vmcnt(0)
    v_cmp_ne_u32 vcc, 1, v4
    s_nop 4
    s_cbranch_vccnz L_f1_go_loop
    s_branch L_f1_go_ok
L_att:
    s_load_dwordx2 s[92:93], s[0:1], 32
    v_lshrrev_b32 v2, 3, v0
    v_and_b32 v2, 6, v2
    v_xor_b32 v2, v2, v0
    v_and_b32 v2, 7, v2
    v_lshlrev_b32 v2, 4, v2
    v_lshl_add_u32 v15, v1, 10, v2
    v_lshlrev_b32 v8, 4, v0
    s_lshl_b32 s74, s4, 10
    s_add_u32 s77, s55, 128
    s_and_b32 s56, s77, 0x380
    s_mul_i32 s64, s56, s91
    s_add_u32 s77, s56, 128
    s_and_b32 s57, s77, 0x380
    s_mul_i32 s65, s57, s91
    s_add_u32 s77, s57, 128
    s_and_b32 s58, s77, 0x380
    s_mul_i32 s66, s58, s91
    s_add_u32 s77, s58, 128
    s_and_b32 s59, s77, 0x380
    s_mul_i32 s67, s59, s91
    v_and_b32 v1, 31, v0
    v_lshrrev_b32 v2, 5, v0
    v_bfe_u32 v3, v0, 1, 3
    v_xor_b32 v3, v3, v2
    v_lshlrev_b32 v3, 4, v3
    v_lshl_add_u32 v3, v1, 7, v3
    s_xor_b32 s7, s69, s68
    s_lshl_b32 s77, s7, 6
    v_xor_b32 v3, s77, v3
    s_lshl_b32 s77, s68, 13
    s_add_u32 s77, s77, 65536
    v_add_u32 v108, s77, v3
    v_xor_b32 v109, 32, v108
    v_xor_b32 v110, 64, v108
    v_xor_b32 v111, 96, v108
    v_bfe_u32 v1, v0, 2, 2
    v_bfe_u32 v3, v0, 4, 1
    v_and_b32 v4, 3, v0
    v_lshlrev_b32 v4, 3, v4
    v_lshl_add_u32 v4, v3, 5, v4
    v_lshl_add_u32 v3, v2, 3, v1
    v_lshl_add_u32 v13, v3, 7, v4
    v_bfe_u32 v5, v0, 3, 1
    v_xor_b32 v5, s69, v5
    v_lshl_add_u32 v13, v5, 6, v13
    s_lshl_b32 s77, s7, 12
    v_add_u32 v13, s77, v13
    v_xor_b32 v14, 4096, v13
    v_mov_b32 v23, 0x44444444
    v_mov_b32 v5, 0xeeeeeeee
    v_and_b32 v1, 1, v0
    v_cmp_eq_u32 vcc, 1, v1
    s_nop 1
    v_cndmask_b32 v23, v23, v5, vcc
    v_and_b32 v1, 4, v0
    v_cmp_eq_u32 vcc, 0, v1
    v_mov_b32 v5, 0x3f803f80
    s_nop 0
    v_cndmask_b32 v24, 0, v5, vcc
    v_mov_b32 v25, v24
    v_sub_u32 v26, v5, v24
    v_mov_b32 v27, v26
    v_mov_b32 v30, 0
    v_mov_b32 v31, 0
    v_mov_b32 v34, 0
    v_mov_b32 v35, 0
    v_mov_b32 v37, 0
    v_mov_b32 v38, 0
    v_mov_b32 v39, 0
    v_mov_b32 v40, 0
    v_mov_b32 v41, 0
    v_mov_b32 v42, 0
    v_mov_b32 v43, 0
    v_mov_b32 v182, 0
    v_mov_b32 v183, 0
    v_mov_b32 v184, 0
    v_mov_b32 v185, 0
    v_mov_b32 v186, 0
    v_mov_b32 v187, 0
    v_mov_b32 v188, 0
    v_mov_b32 v189, 0
    v_mov_b32 v190, 0
    v_mov_b32 v191, 0
    v_mov_b32 v192, 0
    v_mov_b32 v193, 0
    v_mov_b32 v194, 0
    v_mov_b32 v195, 0
    v_mov_b32 v196, 0
    v_mov_b32 v197, 0
    v_mov_b32 v240, 0
    v_mov_b32 v241, 0
    v_mov_b32 v242, 0
    v_mov_b32 v243, 0
    v_mov_b32 v244, 0
    v_mov_b32 v245, 0
    v_mov_b32 v246, 0
    v_mov_b32 v247, 0
    v_mov_b32 v100, 0
    v_mov_b32 v101, 0
    v_mov_b32 v102, 0
    v_mov_b32 v103, 0
    s_waitcnt lgkmcnt(0)
    v_mov_b32 v3, 0x3f803f80
    v_mov_b32 v1, 0
    v_mov_b32 v2, 0
    s_waitcnt vmcnt(8)
    v_dot2c_f32_bf16 v1, v116, v3
    v_dot2c_f32_bf16 v2, v116, v116
    buffer_load_dwordx4 v12, s[12:15], s60 offen offset:1024 lds
    v_dot2c_f32_bf16 v1, v117, v3
    v_dot2c_f32_bf16 v2, v117, v117
    v_dot2c_f32_bf16 v1, v118, v3
    v_dot2c_f32_bf16 v2, v118, v118
    v_dot2c_f32_bf16 v1, v119, v3
    v_dot2c_f32_bf16 v2, v119, v119
    s_waitcnt vmcnt(8)
    v_dot2c_f32_bf16 v1, v120, v3
    v_dot2c_f32_bf16 v2, v120, v120
    v_dot2c_f32_bf16 v1, v121, v3
    v_dot2c_f32_bf16 v2, v121, v121
    s_add_u32 m0, s73, 8192
    s_nop 0
    buffer_load_dwordx4 v11, s[12:15], s61 offen offset:0 lds
    v_dot2c_f32_bf16 v1, v122, v3
    v_dot2c_f32_bf16 v2, v122, v122
    v_dot2c_f32_bf16 v1, v123, v3
    v_dot2c_f32_bf16 v2, v123, v123
    s_waitcnt vmcnt(8)
    v_dot2c_f32_bf16 v1, v124, v3
    v_dot2c_f32_bf16 v2, v124, v124
    v_dot2c_f32_bf16 v1, v125, v3
    v_dot2c_f32_bf16 v2, v125, v125
    v_dot2c_f32_bf16 v1, v126, v3
    v_dot2c_f32_bf16 v2, v126, v126
    buffer_load_dwordx4 v12, s[12:15], s61 offen offset:1024 lds
    v_dot2c_f32_bf16 v1, v127, v3
    v_dot2c_f32_bf16 v2, v127, v127
    s_waitcnt vmcnt(8)
    v_dot2c_f32_bf16 v1, v128, v3
    v_dot2c_f32_bf16 v2, v128, v128
    v_dot2c_f32_bf16 v1, v129, v3
    v_dot2c_f32_bf16 v2, v129, v129
    v_dot2c_f32_bf16 v1, v130, v3
    v_dot2c_f32_bf16 v2, v130, v130
    v_dot2c_f32_bf16 v1, v131, v3
    v_dot2c_f32_bf16 v2, v131, v131
    s_add_u32 m0, s72, 16384
    s_nop 0
    buffer_load_dwordx4 v104, s[8:11], s53 offen offset:0 lds
    v_add_f32_dpp v1, v1, v1 row_ror:8 row_mask:0xf bank_mask:0xf
    v_add_f32_dpp v2, v2, v2 row_ror:8 row_mask:0xf bank_mask:0xf
    s_nop 0
    v_add_f32_dpp v1, v1, v1 row_ror:4 row_mask:0xf bank_mask:0xf
    v_add_f32_dpp v2, v2, v2 row_ror:4 row_mask:0xf bank_mask:0xf
    s_nop 0
    v_add_f32_dpp v1, v1, v1 row_ror:2 row_mask:0xf bank_mask:0xf
    v_add_f32_dpp v2, v2, v2 row_ror:2 row_mask:0xf bank_mask:0xf
    s_nop 0
    v_add_f32_dpp v1, v1, v1 row_ror:1 row_mask:0xf bank_mask:0xf
    v_add_f32_dpp v2, v2, v2 row_ror:1 row_mask:0xf bank_mask:0xf
    v_mul_f32 v1, 0x3b000000, v1
    v_mul_f32 v2, 0x3b000000, v2
    v_fma_f32 v2, -v1, v1, v2
    v_max_f32 v2, 0, v2
    v_cvt_pk_bf16_f32 v144, -v1, -v1
    v_cvt_pk_bf16_f32 v4, v2, v2
    v_and_b32 v4, 0xffff0000, v4
    v_add_f32 v4, 0x3727c5ac, v4
    v_cvt_pk_bf16_f32 v4, v4, v4
    v_and_b32 v4, 0xffff0000, v4
    v_sqrt_f32 v4, v4
    s_nop 0
    v_cvt_pk_bf16_f32 v5, v4, 0
    v_lshlrev_b32 v6, 16, v5
    v_rcp_f32 v142, v6
    v_and_b32 v144, 0xffff0000, v144
    v_mul_f32 v144, v144, v142
    v_lshrrev_b32 v1, 4, v0
    s_lshl_b32 s77, s69, 2
    v_add_u32 v1, s77, v1
    v_cmp_eq_u32 vcc, 0, v1
    s_nop 1
    v_cndmask_b32 v142, v142, v100, vcc
    v_mov_b32 v2, 1.0
    v_cndmask_b32 v144, v144, v2, vcc
    s_lshl_b32 s77, s68, 3
    v_add_u32 v1, s77, v1
    v_mul_u32_u24 v1, 1040, v1
    v_add_u32 v1, 131072, v1
    v_and_b32 v2, 15, v0
    v_lshlrev_b32 v2, 4, v2
    v_subrev_u32 v2, s52, v2
    v_lshlrev_b32 v146, 16, v116
    v_and_b32 v147, 0xffff0000, v116
    v_lshlrev_b32 v148, 16, v117
    v_and_b32 v149, 0xffff0000, v117
    v_lshlrev_b32 v150, 16, v118
    v_and_b32 v151, 0xffff0000, v118
    v_lshlrev_b32 v152, 16, v119
    v_and_b32 v153, 0xffff0000, v119
    v_pk_fma_f32 v[146:147], v[146:147], v[142:143], v[144:145] op_sel_hi:[1,0,0]
    v_pk_fma_f32 v[148:149], v[148:149], v[142:143], v[144:145] op_sel_hi:[1,0,0]
    v_pk_fma_f32 v[150:151], v[150:151], v[142:143], v[144:145] op_sel_hi:[1,0,0]
    v_pk_fma_f32 v[152:153], v[152:153], v[142:143], v[144:145] op_sel_hi:[1,0,0]
    v_cvt_pk_bf16_f32 v116, v146, v147
    v_cvt_pk_bf16_f32 v117, v148, v149
    v_cvt_pk_bf16_f32 v118, v150, v151
    v_cvt_pk_bf16_f32 v119, v152, v153
    v_add_u32 v3, 0, v2
    v_and_b32 v3, 1023, v3
    v_add_u32 v3, v1, v3
    ds_write_b128 v3, v[116:119]
    v_lshlrev_b32 v146, 16, v120
    v_and_b32 v147, 0xffff0000, v120
    v_lshlrev_b32 v148, 16, v121
    v_and_b32 v149, 0xffff0000, v121
    v_lshlrev_b32 v150, 16, v122
    v_and_b32 v151, 0xffff0000, v122
    v_lshlrev_b32 v152, 16, v123
    v_and_b32 v153, 0xffff0000, v123
    v_pk_fma_f32 v[146:147], v[146:147], v[142:143], v[144:145] op_sel_hi:[1,0,0]
    v_pk_fma_f32 v[148:149], v[148:149], v[142:143], v[144:145] op_sel_hi:[1,0,0]
    v_pk_fma_f32 v[150:151], v[150:151], v[142:143], v[144:145] op_sel_hi:[1,0,0]
    v_pk_fma_f32 v[152:153], v[152:153], v[142:143], v[144:145] op_sel_hi:[1,0,0]
    v_cvt_pk_bf16_f32 v120, v146, v147
    v_cvt_pk_bf16_f32 v121, v148, v149
    v_cvt_pk_bf16_f32 v122, v150, v151
    v_cvt_pk_bf16_f32 v123, v152, v153
    v_add_u32 v3, 256, v2
    v_and_b32 v3, 1023, v3
    v_add_u32 v3, v1, v3
    ds_write_b128 v3, v[120:123]
    v_lshlrev_b32 v146, 16, v124
    v_and_b32 v147, 0xffff0000, v124
    v_lshlrev_b32 v148, 16, v125
    v_and_b32 v149, 0xffff0000, v125
    v_lshlrev_b32 v150, 16, v126
    v_and_b32 v151, 0xffff0000, v126
    v_lshlrev_b32 v152, 16, v127
    v_and_b32 v153, 0xffff0000, v127
    v_pk_fma_f32 v[146:147], v[146:147], v[142:143], v[144:145] op_sel_hi:[1,0,0]
    v_pk_fma_f32 v[148:149], v[148:149], v[142:143], v[144:145] op_sel_hi:[1,0,0]
    v_pk_fma_f32 v[150:151], v[150:151], v[142:143], v[144:145] op_sel_hi:[1,0,0]
    v_pk_fma_f32 v[152:153], v[152:153], v[142:143], v[144:145] op_sel_hi:[1,0,0]
    v_cvt_pk_bf16_f32 v124, v146, v147
    v_cvt_pk_bf16_f32 v125, v148, v149
    v_cvt_pk_bf16_f32 v126, v150, v151
    v_cvt_pk_bf16_f32 v127, v152, v153
    v_add_u32 v3, 512, v2
    v_and_b32 v3, 1023, v3
    v_add_u32 v3, v1, v3
    ds_write_b128 v3, v[124:127]
    v_lshlrev_b32 v146, 16, v128
    v_and_b32 v147, 0xffff0000, v128
    v_lshlrev_b32 v148, 16, v129
    v_and_b32 v149, 0xffff0000, v129
    v_lshlrev_b32 v150, 16, v130
    v_and_b32 v151, 0xffff0000, v130
    v_lshlrev_b32 v152, 16, v131
    v_and_b32 v153, 0xffff0000, v131
    v_pk_fma_f32 v[146:147], v[146:147], v[142:143], v[144:145] op_sel_hi:[1,0,0]
    v_pk_fma_f32 v[148:149], v[148:149], v[142:143], v[144:145] op_sel_hi:[1,0,0]
    v_pk_fma_f32 v[150:151], v[150:151], v[142:143], v[144:145] op_sel_hi:[1,0,0]
    v_pk_fma_f32 v[152:153], v[152:153], v[142:143], v[144:145] op_sel_hi:[1,0,0]
    v_cvt_pk_bf16_f32 v128, v146, v147
    v_cvt_pk_bf16_f32 v129, v148, v149
    v_cvt_pk_bf16_f32 v130, v150, v151
    v_cvt_pk_bf16_f32 v131, v152, v153
    v_add_u32 v3, 768, v2
    v_and_b32 v3, 1023, v3
    v_add_u32 v3, v1, v3
    ds_write_b128 v3, v[128:131]
    s_xor_b32 s71, s6, 4
    s_lshr_b32 s77, s3, 4
    buffer_load_dwordx4 v105, s[8:11], s53 offen offset:1024 lds
    s_and_b32 s70, s2, 3
    s_lshl1_add_u32 s70, s70, s77
    s_and_b32 s77, s3, 3
    s_lshl2_add_u32 s70, s70, s77
    s_lshl_b32 s77, s71, 7
    v_add_u32 v15, s77, v15
    s_mov_b32 s18, 12582912
    s_mov_b32 s26, 2097152
    s_mov_b32 s30, 256
    s_mov_b32 s34, 3584
    s_mov_b32 s38, 1024
    s_mov_b32 s19, s51
    s_mov_b32 s23, s51
    s_mov_b32 s27, s51
    buffer_load_dwordx4 v106, s[8:11], s53 offen offset:2048 lds
    s_mov_b32 s31, s51
    s_mov_b32 s35, s51
    s_mov_b32 s39, s51
    s_mov_b32 s43, s51
    s_mov_b32 s47, s51
    s_mov_b32 s87, s51
    s_mov_b32 s40, s16
    s_mov_b32 s41, s17
    s_cmp_eq_u32 s2, 128
    s_cselect_b32 s42, 12582912, 0
    s_cselect_b32 s46, 256, 0
    s_mov_b32 s44, s28
    s_mov_b32 s45, s29
    s_lshl_b32 s77, s4, 14
    buffer_load_dwordx4 v107, s[8:11], s53 offen offset:3072 lds
    s_add_u32 s77, s77, 10485760
    v_lshl_add_u32 v174, v0, 8, s77
    s_lshl_b32 s77, s4, 8
    s_add_u32 s77, s77, 159744
    v_lshl_add_u32 v176, v0, 2, s77
    v_xor_b32 v175, 256, v176
    v_bfe_u32 v1, v0, 3, 1
    v_and_b32 v2, 3, v0
    v_lshl_add_u32 v1, v1, 2, v2
    s_lshl_b32 s77, s68, 3
    v_add_u32 v1, s77, v1
    v_bfe_u32 v2, v0, 4, 1
    v_bfe_u32 v3, v0, 2, 1
    v_cmp_eq_u32 vcc, v2, v3
    s_add_u32 m0, s72, 32768
    s_nop 0
    buffer_load_dwordx4 v104, s[8:11], s54 offen offset:0 lds
    v_cndmask_b32 v1, 16, v1, vcc
    v_mul_u32_u24 v1, 1040, v1
    v_lshrrev_b32 v2, 5, v0
    v_lshl_add_u32 v1, v2, 4, v1
    s_lshl_b32 s77, s7, 6
    s_add_u32 s82, s77, 131072
    v_add_u32 v132, s82, v1
    s_sub_u32 s82, 131136, s77
    v_add_u32 v133, s82, v1
    v_add_u32 v1, 147712, v8
    ds_write_b128 v1, v[100:103]
    v_and_b32 v1, 31, v0
    v_lshlrev_b32 v2, 2, v2
    v_sub_u32 v7, v1, v2
    buffer_load_dwordx4 v105, s[8:11], s54 offen offset:1024 lds
    s_lshl_b32 s77, s4, 9
    s_add_u32 s82, s77, 155680
    v_lshl_add_u32 v140, v1, 2, s82
    s_cmp_eq_u32 s5, 0
    s_cselect_b32 s99, 0xf149f2ca, 0
    v_mov_b32 v3, 1.0
    v_subrev_u32 v4, 32, v140
    ds_write_b32 v4, v3
    s_add_u32 s82, s77, 157696
    v_lshrrev_b32 v2, 5, v0
    v_lshlrev_b32 v3, 1, v1
    v_lshl_add_u32 v3, v2, 8, v3
    v_add_u32 v139, s82, v3
    s_mov_b32 s91, s82
    buffer_load_dwordx4 v106, s[8:11], s54 offen offset:2048 lds
    s_lshl_b32 s77, s6, 13
    s_lshl_b32 s82, s69, 12
    s_add_u32 s77, s77, s82
    s_lshl_b32 s82, s68, 10
    s_add_u32 s77, s77, s82
    s_mul_i32 s75, s5, 598016
    s_add_u32 s75, s75, s77
    s_add_u32 s76, s75, 299008
    s_lshl_b32 s83, s5, 4
    s_add_u32 s83, s83, s6
    s_add_u32 s83, s83, 8
    v_add_u32 v134, s74, v8
    v_add_u32 v134, 151552, v134
    v_add_u32 v16, 7168, v15
    buffer_load_dwordx4 v107, s[8:11], s54 offen offset:3072 lds
    v_add_u32 v17, 14336, v15
    v_add_u32 v18, 21504, v15
    s_mul_i32 s77, s4, 37
    s_add_u32 s77, s77, -4
    s_cmp_eq_u32 s4, 1
    s_cselect_b32 s77, 32, s77
    s_cselect_b32 s82, 38, 37
    s_cmp_eq_u32 s4, 0
    s_cselect_b32 s77, 0, s77
    s_cselect_b32 s82, 32, s82
    s_cselect_b32 s20, s80, s20
    s_cselect_b32 s21, s81, s21
    s_cselect_b32 s3, 0, 32
    s_sub_u32 s3, s77, s3
    s_add_u32 m0, s73, 16384
    s_nop 0
    buffer_load_dwordx4 v11, s[12:15], s62 offen offset:0 lds
    s_lshl_b32 s3, s3, 14
    s_add_u32 s20, s20, s3
    s_addc_u32 s21, s21, 0
    s_lshl_b32 s22, s82, 14
    s_lshl_b32 s86, s82, 11
    s_mul_i32 s3, s70, 299008
    s_lshl_b32 s77, s77, 11
    s_add_u32 s3, s3, s77
    s_add_u32 s84, s16, s3
    s_addc_u32 s85, s17, 0
    s_lshl_b32 s90, s4, 12
    s_add_u32 s82, s82, 1
    s_lshr_b32 s82, s82, 1
    s_and_b32 s3, s70, 3
    buffer_load_dwordx4 v12, s[12:15], s62 offen offset:1024 lds
    s_mul_i32 s3, s3, s82
    s_add_u32 s3, s3, 3
    s_lshr_b32 s3, s3, 2
    s_lshl_b32 s88, s3, 15
    s_lshl_b32 s89, s3, 12
    s_lshl_b32 s78, s82, 15
    s_lshl_b32 s79, s82, 12
    v_bfe_u32 v1, v0, 2, 3
    v_and_b32 v2, 32, v0
    v_lshlrev_b32 v2, 6, v2
    v_lshl_add_u32 v2, v1, 7, v2
    v_and_b32 v1, 24, v0
    v_lshl_add_u32 v2, v1, 2, v2
    v_and_b32 v1, 3, v0
    s_add_u32 m0, s72, 49152
    s_nop 0
    buffer_load_dwordx4 v104, s[8:11], s55 offen offset:0 lds
    v_lshl_add_u32 v2, v1, 3, v2
    v_add_u32 v21, s72, v2
    v_xor_b32 v22, 40, v21
    s_lshr_b32 s3, s2, 3
    s_and_b32 s77, s2, 3
    s_lshl2_add_u32 s3, s3, s77
    s_and_b32 s77, s3, 63
    s_mul_i32 s77, s77, 38
    v_add_u32 v1, s77, v0
    v_lshrrev_b32 v2, 2, v1
    v_and_b32 v1, 3, v1
    v_lshl_add_u32 v1, v2, 3, v1
    s_and_b32 s77, s71, 4
    v_add_lshl_u32 v1, v1, s77, 7
    buffer_load_dwordx4 v105, s[8:11], s55 offen offset:1024 lds
    v_cmp_gt_u32 vcc, 38, v0
    s_nop 1
    v_cndmask_b32 v19, -1, v1, vcc
    buffer_load_dword v5, v8, s[36:39], 0 offen
    s_and_b32 s3, s3, 63
    s_lshl2_add_u32 s3, s3, s4
    v_bfe_u32 v2, v0, 2, 1
    v_lshl_add_u32 v2, s3, 1, v2
    v_mul_u32_u24 v2, 3072, v2
    v_and_b32 v1, 11, v0
    v_xor_b32 v1, 8, v1
    s_and_b32 s77, s6, 4
    s_add_u32 s77, s77, 8
    v_add_lshl_u32 v1, v1, s77, 7
    v_add_u32 v1, v1, v2
    buffer_load_dwordx4 v106, s[8:11], s55 offen offset:2048 lds
    v_cmp_gt_u32 vcc, 8, v0
    s_nop 1
    v_cndmask_b32 v20, -1, v1, vcc
    v_lshl_add_u32 v1, s3, 2, v0
    v_lshrrev_b32 v2, 1, v1
    v_mul_u32_u24 v2, 3584, v2
    v_and_b32 v1, 1, v1
    v_mul_u32_u24 v1, 896, v1
    s_and_b32 s77, s6, 4
    s_mul_i32 s77, s77, 448
    s_add_u32 s77, s77, 384
    v_add3_u32 v1, v1, v2, s77
    v_cmp_gt_u32 vcc, 4, v0
    s_nop 1
    v_cndmask_b32 v177, -1, v1, vcc
    v_lshlrev_b32 v1, 7, v0
    buffer_load_dwordx4 v107, s[8:11], s55 offen offset:3072 lds
    buffer_load_dword v6, v1, s[32:35], 0 offen
    s_mov_b64 s[32:33], s[92:93]
    s_mov_b32 s34, 1835008
    s_waitcnt vmcnt(18)
    s_barrier
    ds_read_b64_tr_b16 v[44:45], v13 offset:0
    ds_read_b64_tr_b16 v[46:47], v13 offset:512
    ds_read_b128 a[0:3], v108 offset:0
    ds_read_b128 a[128:131], v108 offset:4096
    ds_read_b64_tr_b16 v[48:49], v13 offset:2048
    ds_read_b64_tr_b16 v[50:51], v13 offset:2560
    ds_read_b128 a[4:7], v109 offset:0
    ds_read_b128 a[132:135], v109 offset:4096
    ds_read_b64_tr_b16 v[52:53], v14 offset:0
    ds_read_b64_tr_b16 v[54:55], v14 offset:512
    ds_read_b128 a[8:11], v110 offset:0
    ds_read_b128 a[136:139], v110 offset:4096
    s_waitcnt lgkmcnt(6)
    v_smfmac_f32_16x16x64_bf16 v[40:43], v[24:27], v[44:51], v23
    v_mfma_f32_32x32x16_bf16 v[68:83], v[44:47], a[0:3], 0
    s_add_u32 m0, s73, 24576
    ds_read_b64_tr_b16 v[56:57], v14 offset:2048
    ds_read_b64_tr_b16 v[58:59], v14 offset:2560
    buffer_load_dwordx4 v11, s[12:15], s63 offen offset:0 lds
    v_mfma_f32_32x32x16_bf16 v[84:99], v[44:47], a[128:131], 0
    ds_read_b128 a[12:15], v111 offset:0
    ds_read_b128 a[140:143], v111 offset:4096
    buffer_load_dwordx4 v12, s[12:15], s63 offen offset:1024 lds
    s_waitcnt lgkmcnt(9)
    v_mfma_f32_32x32x16_bf16 v[68:83], v[48:51], a[4:7], v[68:83]
    s_waitcnt lgkmcnt(8)
    v_mfma_f32_32x32x16_bf16 v[84:99], v[48:51], a[132:135], v[84:99]
    s_waitcnt lgkmcnt(2)
    v_mfma_f32_32x32x16_bf16 v[68:83], v[52:55], a[8:11], v[68:83]
    s_waitcnt vmcnt(14) lgkmcnt(0)
    s_barrier
    ds_read_b64_tr_b16 v[60:61], v13 offset:8192
    ds_read_b64_tr_b16 v[62:63], v13 offset:8704
    ds_read_b128 a[16:19], v108 offset:16384
    ds_read_b128 a[144:147], v108 offset:20480
    v_mfma_f32_32x32x16_bf16 v[84:99], v[52:55], a[136:139], v[84:99]
    s_add_u32 m0, s72, 0
    ds_read_b64_tr_b16 v[64:65], v13 offset:10240
    ds_read_b64_tr_b16 v[66:67], v13 offset:10752
    ds_read_b128 a[20:23], v109 offset:16384
    ds_read_b128 a[148:151], v109 offset:20480
    buffer_load_dwordx4 v104, s[8:11], s56 offen offset:0 lds
    v_mfma_f32_32x32x16_bf16 v[68:83], v[56:59], a[12:15], v[68:83]
    ds_read_b64_tr_b16 v[44:45], v14 offset:8192
    ds_read_b64_tr_b16 v[46:47], v14 offset:8704
    buffer_load_dwordx4 v105, s[8:11], s56 offen offset:1024 lds
    v_mfma_f32_32x32x16_bf16 v[84:99], v[56:59], a[140:143], v[84:99]
    ds_read_b128 a[24:27], v110 offset:16384
    ds_read_b128 a[152:155], v110 offset:20480
    buffer_load_dwordx4 v106, s[8:11], s56 offen offset:2048 lds
    s_waitcnt lgkmcnt(6)
    v_smfmac_f32_16x16x64_bf16 v[40:43], v[24:27], v[60:67], v23
    v_mfma_f32_32x32x16_bf16 v[68:83], v[60:63], a[16:19], v[68:83]
    ds_read_b64_tr_b16 v[48:49], v14 offset:10240
    ds_read_b64_tr_b16 v[50:51], v14 offset:10752
    buffer_load_dwordx4 v107, s[8:11], s56 offen offset:3072 lds
    v_mfma_f32_32x32x16_bf16 v[84:99], v[60:63], a[144:147], v[84:99]
    s_add_u32 m0, s73, 32768
    ds_read_b128 a[28:31], v111 offset:16384
    ds_read_b128 a[156:159], v111 offset:20480
    buffer_load_dwordx4 v11, s[12:15], s64 offen offset:0 lds
    s_waitcnt lgkmcnt(9)
    v_mfma_f32_32x32x16_bf16 v[68:83], v[64:67], a[20:23], v[68:83]
    buffer_load_dwordx4 v12, s[12:15], s64 offen offset:1024 lds
    s_waitcnt lgkmcnt(8)
    v_mfma_f32_32x32x16_bf16 v[84:99], v[64:67], a[148:151], v[84:99]
    s_waitcnt lgkmcnt(2)
    v_mfma_f32_32x32x16_bf16 v[68:83], v[44:47], a[24:27], v[68:83]
    s_waitcnt vmcnt(14) lgkmcnt(0)
    s_barrier
    ds_read_b64_tr_b16 v[52:53], v13 offset:16384
    ds_read_b64_tr_b16 v[54:55], v13 offset:16896
    ds_read_b128 a[32:35], v108 offset:32768
    ds_read_b128 a[160:163], v108 offset:36864
    v_mfma_f32_32x32x16_bf16 v[84:99], v[44:47], a[152:155], v[84:99]
    s_add_u32 m0, s72, 16384
    ds_read_b64_tr_b16 v[56:57], v13 offset:18432
    ds_read_b64_tr_b16 v[58:59], v13 offset:18944
    ds_read_b128 a[36:39], v109 offset:32768
    ds_read_b128 a[164:167], v109 offset:36864
    buffer_load_dwordx4 v104, s[8:11], s57 offen offset:0 lds
    v_mfma_f32_32x32x16_bf16 v[68:83], v[48:51], a[28:31], v[68:83]
    ds_read_b64_tr_b16 v[60:61], v14 offset:16384
    ds_read_b64_tr_b16 v[62:63], v14 offset:16896
    buffer_load_dwordx4 v105, s[8:11], s57 offen offset:1024 lds
    v_mfma_f32_32x32x16_bf16 v[84:99], v[48:51], a[156:159], v[84:99]
    ds_read_b128 a[40:43], v110 offset:32768
    ds_read_b128 a[168:171], v110 offset:36864
    buffer_load_dwordx4 v106, s[8:11], s57 offen offset:2048 lds
    s_waitcnt lgkmcnt(6)
    v_smfmac_f32_16x16x64_bf16 v[40:43], v[24:27], v[52:59], v23
    v_mfma_f32_32x32x16_bf16 v[68:83], v[52:55], a[32:35], v[68:83]
    ds_read_b64_tr_b16 v[64:65], v14 offset:18432
    ds_read_b64_tr_b16 v[66:67], v14 offset:18944
    buffer_load_dwordx4 v107, s[8:11], s57 offen offset:3072 lds
    v_mfma_f32_32x32x16_bf16 v[84:99], v[52:55], a[160:163], v[84:99]
    s_add_u32 m0, s73, 40960
    ds_read_b128 a[44:47], v111 offset:32768
    ds_read_b128 a[172:175], v111 offset:36864
    buffer_load_dwordx4 v11, s[12:15], s65 offen offset:0 lds
    s_waitcnt lgkmcnt(9)
    v_mfma_f32_32x32x16_bf16 v[68:83], v[56:59], a[36:39], v[68:83]
    buffer_load_dwordx4 v12, s[12:15], s65 offen offset:1024 lds
    s_waitcnt lgkmcnt(8)
    v_mfma_f32_32x32x16_bf16 v[84:99], v[56:59], a[164:167], v[84:99]
    s_waitcnt lgkmcnt(2)
    v_mfma_f32_32x32x16_bf16 v[68:83], v[60:63], a[40:43], v[68:83]
    s_waitcnt vmcnt(12) lgkmcnt(0)
    s_barrier
    ds_read_b64_tr_b16 v[44:45], v13 offset:24576
    ds_read_b64_tr_b16 v[46:47], v13 offset:25088
    ds_read_b128 a[48:51], v108 offset:49152
    ds_read_b128 a[176:179], v108 offset:53248
    v_mfma_f32_32x32x16_bf16 v[84:99], v[60:63], a[168:171], v[84:99]
    s_add_u32 m0, s72, 32768
    ds_read_b64_tr_b16 v[48:49], v13 offset:26624
    ds_read_b64_tr_b16 v[50:51], v13 offset:27136
    ds_read_b128 a[52:55], v109 offset:49152
    ds_read_b128 a[180:183], v109 offset:53248
    buffer_load_dwordx4 v104, s[8:11], s58 offen offset:0 lds
    v_mfma_f32_32x32x16_bf16 v[68:83], v[64:67], a[44:47], v[68:83]
    ds_read_b64_tr_b16 v[52:53], v14 offset:24576
    ds_read_b64_tr_b16 v[54:55], v14 offset:25088
    buffer_load_dwordx4 v105, s[8:11], s58 offen offset:1024 lds
    v_mfma_f32_32x32x16_bf16 v[84:99], v[64:67], a[172:175], v[84:99]
    ds_read_b128 a[56:59], v110 offset:49152
    ds_read_b128 a[184:187], v110 offset:53248
    buffer_load_dwordx4 v106, s[8:11], s58 offen offset:2048 lds
    s_waitcnt lgkmcnt(6)
    v_smfmac_f32_16x16x64_bf16 v[40:43], v[24:27], v[44:51], v23
    v_mfma_f32_32x32x16_bf16 v[68:83], v[44:47], a[48:51], v[68:83]
    ds_read_b64_tr_b16 v[56:57], v14 offset:26624
    ds_read_b64_tr_b16 v[58:59], v14 offset:27136
    buffer_load_dwordx4 v107, s[8:11], s58 offen offset:3072 lds
    v_mfma_f32_32x32x16_bf16 v[84:99], v[44:47], a[176:179], v[84:99]
    s_add_u32 m0, s73, 49152
    ds_read_b128 a[60:63], v111 offset:49152
    ds_read_b128 a[188:191], v111 offset:53248
    buffer_load_dwordx4 v11, s[12:15], s66 offen offset:0 lds
    s_waitcnt lgkmcnt(9)
    v_mfma_f32_32x32x16_bf16 v[68:83], v[48:51], a[52:55], v[68:83]
    buffer_load_dwordx4 v12, s[12:15], s66 offen offset:1024 lds
    s_waitcnt lgkmcnt(8)
    v_mfma_f32_32x32x16_bf16 v[84:99], v[48:51], a[180:183], v[84:99]
    s_waitcnt lgkmcnt(2)
    v_mfma_f32_32x32x16_bf16 v[68:83], v[52:55], a[56:59], v[68:83]
    s_waitcnt vmcnt(12) lgkmcnt(0)
    s_barrier
    ds_read_b64_tr_b16 v[60:61], v13 offset:32768
    ds_read_b64_tr_b16 v[62:63], v13 offset:33280
    ds_read_b128 a[64:67], v108 offset:0
    ds_read_b128 a[192:195], v108 offset:4096
    v_mfma_f32_32x32x16_bf16 v[84:99], v[52:55], a[184:187], v[84:99]
    s_add_u32 m0, s72, 49152
    ds_read_b64_tr_b16 v[64:65], v13 offset:34816
    ds_read_b64_tr_b16 v[66:67], v13 offset:35328
    ds_read_b128 a[68:71], v109 offset:0
    ds_read_b128 a[196:199], v109 offset:4096
    buffer_load_dwordx4 v104, s[8:11], s59 offen offset:0 lds
    v_mfma_f32_32x32x16_bf16 v[68:83], v[56:59], a[60:63], v[68:83]
    ds_read_b64_tr_b16 v[44:45], v14 offset:32768
    ds_read_b64_tr_b16 v[46:47], v14 offset:33280
    buffer_load_dwordx4 v105, s[8:11], s59 offen offset:1024 lds
    v_mfma_f32_32x32x16_bf16 v[84:99], v[56:59], a[188:191], v[84:99]
    ds_read_b128 a[72:75], v110 offset:0
    ds_read_b128 a[200:203], v110 offset:4096
    buffer_load_dwordx4 v106, s[8:11], s59 offen offset:2048 lds
    s_waitcnt lgkmcnt(6)
    v_smfmac_f32_16x16x64_bf16 v[40:43], v[24:27], v[60:67], v23
    v_mfma_f32_32x32x16_bf16 v[68:83], v[60:63], a[64:67], v[68:83]
    ds_read_b64_tr_b16 v[48:49], v14 offset:34816
    ds_read_b64_tr_b16 v[50:51], v14 offset:35328
    buffer_load_dwordx4 v107, s[8:11], s59 offen offset:3072 lds
    v_mfma_f32_32x32x16_bf16 v[84:99], v[60:63], a[192:195], v[84:99]
    s_add_u32 m0, s73, 57344
    ds_read_b128 a[76:79], v111 offset:0
    ds_read_b128 a[204:207], v111 offset:4096
    buffer_load_dwordx4 v11, s[12:15], s67 offen offset:0 lds
    s_waitcnt lgkmcnt(9)
    v_mfma_f32_32x32x16_bf16 v[68:83], v[64:67], a[68:71], v[68:83]
    buffer_load_dwordx4 v12, s[12:15], s67 offen offset:1024 lds
    s_waitcnt lgkmcnt(8)
    v_mfma_f32_32x32x16_bf16 v[84:99], v[64:67], a[196:199], v[84:99]
    s_waitcnt lgkmcnt(2)
    v_mfma_f32_32x32x16_bf16 v[68:83], v[44:47], a[72:75], v[68:83]
    s_waitcnt vmcnt(12) lgkmcnt(0)
    s_barrier
    ds_read_b64_tr_b16 v[52:53], v13 offset:40960
    ds_read_b64_tr_b16 v[54:55], v13 offset:41472
    ds_read_b128 a[80:83], v108 offset:16384
    ds_read_b128 a[208:211], v108 offset:20480
    v_add_u32 v11, 1024, v11
    v_add_u32 v12, 1024, v12
    v_mfma_f32_32x32x16_bf16 v[84:99], v[44:47], a[200:203], v[84:99]
    s_add_u32 m0, s73, 0
    ds_read_b64_tr_b16 v[56:57], v13 offset:43008
    ds_read_b64_tr_b16 v[58:59], v13 offset:43520
    ds_read_b128 a[84:87], v109 offset:16384
    ds_read_b128 a[212:215], v109 offset:20480
    buffer_load_dwordx4 v11, s[12:15], s60 offen offset:0 lds
    v_mfma_f32_32x32x16_bf16 v[68:83], v[48:51], a[76:79], v[68:83]
    ds_read_b64_tr_b16 v[60:61], v14 offset:40960
    ds_read_b64_tr_b16 v[62:63], v14 offset:41472
    buffer_load_dwordx4 v12, s[12:15], s60 offen offset:1024 lds
    v_mfma_f32_32x32x16_bf16 v[84:99], v[48:51], a[204:207], v[84:99]
    s_add_u32 m0, s73, 8192
    ds_read_b128 a[88:91], v110 offset:16384
    ds_read_b128 a[216:219], v110 offset:20480
    buffer_load_dwordx4 v11, s[12:15], s61 offen offset:0 lds
    s_waitcnt lgkmcnt(6)
    v_smfmac_f32_16x16x64_bf16 v[40:43], v[24:27], v[52:59], v23
    v_mfma_f32_32x32x16_bf16 v[68:83], v[52:55], a[80:83], v[68:83]
    ds_read_b64_tr_b16 v[64:65], v14 offset:43008
    ds_read_b64_tr_b16 v[66:67], v14 offset:43520
    v_mfma_f32_32x32x16_bf16 v[84:99], v[52:55], a[208:211], v[84:99]
    ds_read_b128 a[92:95], v111 offset:16384
    ds_read_b128 a[220:223], v111 offset:20480
    s_waitcnt lgkmcnt(9)
    v_mfma_f32_32x32x16_bf16 v[68:83], v[56:59], a[84:87], v[68:83]
    buffer_load_dwordx4 v12, s[12:15], s61 offen offset:1024 lds
    s_waitcnt lgkmcnt(8)
    v_mfma_f32_32x32x16_bf16 v[84:99], v[56:59], a[212:215], v[84:99]
    s_waitcnt lgkmcnt(2)
    v_mfma_f32_32x32x16_bf16 v[68:83], v[60:63], a[88:91], v[68:83]
    s_waitcnt vmcnt(10) lgkmcnt(0)
    s_barrier
    ds_read_b64_tr_b16 v[44:45], v13 offset:49152
    ds_read_b64_tr_b16 v[46:47], v13 offset:49664
    ds_read_b128 a[96:99], v108 offset:32768
    ds_read_b128 a[224:227], v108 offset:36864
    buffer_load_dword v9, v19, s[20:23], 0 offen
    v_mfma_f32_32x32x16_bf16 v[84:99], v[60:63], a[216:219], v[84:99]
    ds_read_b64_tr_b16 v[48:49], v13 offset:51200
    ds_read_b64_tr_b16 v[50:51], v13 offset:51712
    ds_read_b128 a[100:103], v109 offset:32768
    ds_read_b128 a[228:231], v109 offset:36864
    buffer_load_dword v20, v20, s[12:15], 0 offen
    v_mfma_f32_32x32x16_bf16 v[68:83], v[64:67], a[92:95], v[68:83]
    ds_read_b64_tr_b16 v[52:53], v14 offset:49152
    ds_read_b64_tr_b16 v[54:55], v14 offset:49664
    v_mfma_f32_32x32x16_bf16 v[84:99], v[64:67], a[220:223], v[84:99]
    ds_read_b128 a[104:107], v110 offset:32768
    ds_read_b128 a[232:235], v110 offset:36864
    buffer_load_dword v177, v177, s[32:35], 0 offen
    s_waitcnt lgkmcnt(6)
    v_smfmac_f32_16x16x64_bf16 v[40:43], v[24:27], v[44:51], v23
    v_mfma_f32_32x32x16_bf16 v[68:83], v[44:47], a[96:99], v[68:83]
    s_add_u32 m0, s73, 16384
    ds_read_b64_tr_b16 v[56:57], v14 offset:51200
    ds_read_b64_tr_b16 v[58:59], v14 offset:51712
    buffer_load_dwordx4 v11, s[12:15], s62 offen offset:0 lds
    v_mfma_f32_32x32x16_bf16 v[84:99], v[44:47], a[224:227], v[84:99]
    ds_read_b128 a[108:111], v111 offset:32768
    ds_read_b128 a[236:239], v111 offset:36864
    s_waitcnt lgkmcnt(9)
    v_mfma_f32_32x32x16_bf16 v[68:83], v[48:51], a[100:103], v[68:83]
    buffer_load_dwordx4 v12, s[12:15], s62 offen offset:1024 lds
    s_waitcnt lgkmcnt(8)
    v_mfma_f32_32x32x16_bf16 v[84:99], v[48:51], a[228:231], v[84:99]
    v_smfmac_f32_16x16x64_bf16 v[182:185], v[24:27], a[0:7], v23
    v_smfmac_f32_16x16x64_bf16 v[186:189], v[24:27], a[128:135], v23
    v_mfma_f32_4x4x4_16b_bf16 v[190:193], a[0:1], a[0:1], v[190:193]
    v_mfma_f32_4x4x4_16b_bf16 v[240:243], a[128:129], a[128:129], v[240:243]
    v_mfma_f32_4x4x4_16b_bf16 v[194:197], a[2:3], a[2:3], v[194:197]
    v_mfma_f32_4x4x4_16b_bf16 v[244:247], a[130:131], a[130:131], v[244:247]
    s_add_u32 m0, s73, 24576
    s_nop 0
    buffer_load_dwordx4 v11, s[12:15], s63 offen offset:0 lds
    v_mfma_f32_4x4x4_16b_bf16 v[190:193], a[4:5], a[4:5], v[190:193]
    v_mfma_f32_4x4x4_16b_bf16 v[240:243], a[132:133], a[132:133], v[240:243]
    v_mfma_f32_4x4x4_16b_bf16 v[194:197], a[6:7], a[6:7], v[194:197]
    v_mfma_f32_4x4x4_16b_bf16 v[244:247], a[134:135], a[134:135], v[244:247]
    s_waitcnt lgkmcnt(2)
    v_mfma_f32_32x32x16_bf16 v[68:83], v[52:55], a[104:107], v[68:83]
    s_waitcnt vmcnt(10) lgkmcnt(0)
    s_barrier
    ds_read_b64_tr_b16 v[60:61], v13 offset:57344
    ds_read_b64_tr_b16 v[62:63], v13 offset:57856
    ds_read_b128 a[112:115], v108 offset:49152
    ds_read_b128 a[240:243], v108 offset:53248
    v_mfma_f32_32x32x16_bf16 v[84:99], v[52:55], a[232:235], v[84:99]
    ds_read_b64_tr_b16 v[64:65], v13 offset:59392
    ds_read_b64_tr_b16 v[66:67], v13 offset:59904
    ds_read_b128 a[116:119], v109 offset:49152
    ds_read_b128 a[244:247], v109 offset:53248
    v_mfma_f32_32x32x16_bf16 v[68:83], v[56:59], a[108:111], v[68:83]
    ds_read_b64_tr_b16 v[44:45], v14 offset:57344
    ds_read_b64_tr_b16 v[46:47], v14 offset:57856
    v_mfma_f32_32x32x16_bf16 v[84:99], v[56:59], a[236:239], v[84:99]
    ds_read_b128 a[120:123], v110 offset:49152
    ds_read_b128 a[248:251], v110 offset:53248
    buffer_load_dwordx4 v12, s[12:15], s63 offen offset:1024 lds
    s_waitcnt lgkmcnt(6)
    v_smfmac_f32_16x16x64_bf16 v[40:43], v[24:27], v[60:67], v23
    v_mfma_f32_32x32x16_bf16 v[68:83], v[60:63], a[112:115], v[68:83]
    ds_read_b64_tr_b16 v[48:49], v14 offset:59392
    ds_read_b64_tr_b16 v[50:51], v14 offset:59904
    v_mfma_f32_32x32x16_bf16 v[84:99], v[60:63], a[240:243], v[84:99]
    ds_read_b128 a[124:127], v111 offset:49152
    ds_read_b128 a[252:255], v111 offset:53248
    s_waitcnt lgkmcnt(9)
    v_mfma_f32_32x32x16_bf16 v[68:83], v[64:67], a[116:119], v[68:83]
    s_add_u32 m0, s73, 32768
    s_nop 0
    buffer_load_dwordx4 v11, s[12:15], s64 offen offset:0 lds
    v_add_f32 v1, v40, v41
    s_waitcnt lgkmcnt(8)
    v_mfma_f32_32x32x16_bf16 v[84:99], v[64:67], a[244:247], v[84:99]
    ds_write_b32 v175, v1
    v_smfmac_f32_16x16x64_bf16 v[182:185], v[24:27], a[16:23], v23
    v_smfmac_f32_16x16x64_bf16 v[186:189], v[24:27], a[144:151], v23
    v_mfma_f32_4x4x4_16b_bf16 v[190:193], a[16:17], a[16:17], v[190:193]
    v_mfma_f32_4x4x4_16b_bf16 v[240:243], a[144:145], a[144:145], v[240:243]
    v_mfma_f32_4x4x4_16b_bf16 v[194:197], a[18:19], a[18:19], v[194:197]
    v_mfma_f32_4x4x4_16b_bf16 v[244:247], a[146:147], a[146:147], v[244:247]
    buffer_load_dwordx4 v12, s[12:15], s64 offen offset:1024 lds
    v_mfma_f32_4x4x4_16b_bf16 v[190:193], a[20:21], a[20:21], v[190:193]
    v_mfma_f32_4x4x4_16b_bf16 v[240:243], a[148:149], a[148:149], v[240:243]
    v_mfma_f32_4x4x4_16b_bf16 v[194:197], a[22:23], a[22:23], v[194:197]
    v_mfma_f32_4x4x4_16b_bf16 v[244:247], a[150:151], a[150:151], v[244:247]
    s_waitcnt lgkmcnt(3)
    v_mfma_f32_32x32x16_bf16 v[68:83], v[44:47], a[120:123], v[68:83]
    s_waitcnt vmcnt(11) lgkmcnt(0)
    s_barrier
    ds_read_b64_tr_b16 v[52:53], v13 offset:0
    ds_read_b64_tr_b16 v[54:55], v13 offset:512
    ds_read_b128 v[142:145], v132 offset:0
    v_mfma_f32_32x32x16_bf16 v[84:99], v[44:47], a[248:251], v[84:99]
    ds_read_b64_tr_b16 v[56:57], v13 offset:2048
    ds_read_b64_tr_b16 v[58:59], v13 offset:2560
    ds_read_b128 v[146:149], v132 offset:32
    v_mfma_f32_32x32x16_bf16 v[68:83], v[48:51], a[124:127], v[68:83]
    ds_read_b64_tr_b16 v[60:61], v14 offset:0
    ds_read_b64_tr_b16 v[62:63], v14 offset:512
    ds_read_b32 v2, v176
    v_mfma_f32_32x32x16_bf16 v[84:99], v[48:51], a[252:255], v[84:99]
    s_add_u32 m0, s73, 40960
    ds_read_b128 v[150:153], v133 offset:0
    buffer_load_dwordx4 v11, s[12:15], s65 offen offset:0 lds
    s_waitcnt lgkmcnt(7)
    v_mfma_f32_16x16x32_bf16 v[40:43], v[142:145], v[52:55], 0
    s_waitcnt lgkmcnt(4)
    v_mfma_f32_16x16x32_bf16 v[40:43], v[146:149], v[56:59], v[40:43]
    v_mfma_f32_32x32x16_bf16 v[100:115], v[52:55], a[0:3], 0
    ds_read_b64_tr_b16 v[64:65], v14 offset:2048
    ds_read_b64_tr_b16 v[66:67], v14 offset:2560
    v_mfma_f32_32x32x16_bf16 v[116:131], v[52:55], a[128:131], 0
    ds_read_b128 v[154:157], v133 offset:32
    s_waitcnt lgkmcnt(3)
    v_mfma_f32_16x16x32_bf16 v[40:43], v[150:153], v[60:63], v[40:43]
    v_add_f32 v1, v1, v2
    v_mov_b32 v4, 0xf149f2ca
    v_mfma_f32_32x32x16_bf16 v[100:115], v[56:59], a[4:7], v[100:115]
    s_waitcnt vmcnt(10)
    s_barrier
    v_mfma_f32_32x32x16_bf16 v[116:131], v[56:59], a[132:135], v[116:131]
    ds_read_b64_tr_b16 v[44:45], v13 offset:8192
    ds_read_b64_tr_b16 v[46:47], v13 offset:8704
    ds_read_b128 v[142:145], v132 offset:128
    buffer_load_dwordx4 v12, s[12:15], s65 offen offset:1024 lds
    v_mov_b32 v5, 0xffff
    v_smfmac_f32_16x16x64_bf16 v[182:185], v[24:27], a[32:39], v23
    v_mov_b32 v6, 0xffff0000
    v_smfmac_f32_16x16x64_bf16 v[186:189], v[24:27], a[160:167], v23
    v_and_b32 v2, 0xffff0000, v1
    v_mfma_f32_4x4x4_16b_bf16 v[190:193], a[32:33], a[32:33], v[190:193]
    v_mfma_f32_4x4x4_16b_bf16 v[240:243], a[160:161], a[160:161], v[240:243]
    v_mfma_f32_4x4x4_16b_bf16 v[194:197], a[34:35], a[34:35], v[194:197]
    v_mfma_f32_4x4x4_16b_bf16 v[244:247], a[162:163], a[162:163], v[244:247]
    v_mfma_f32_4x4x4_16b_bf16 v[190:193], a[36:37], a[36:37], v[190:193]
    v_mfma_f32_4x4x4_16b_bf16 v[240:243], a[164:165], a[164:165], v[240:243]
    v_mfma_f32_4x4x4_16b_bf16 v[194:197], a[38:39], a[38:39], v[194:197]
    v_mfma_f32_4x4x4_16b_bf16 v[244:247], a[166:167], a[166:167], v[244:247]
    s_waitcnt lgkmcnt(3)
    v_mfma_f32_16x16x32_bf16 v[40:43], v[154:157], v[64:67], v[40:43]
    v_sub_f32 v1, v1, v2
    v_subrev_u32 v3, 0, v7
    v_mfma_f32_32x32x16_bf16 v[100:115], v[60:63], a[8:11], v[100:115]
    s_add_u32 m0, s73, 49152
    ds_read_b64_tr_b16 v[48:49], v13 offset:10240
    ds_read_b64_tr_b16 v[50:51], v13 offset:10752
    buffer_load_dwordx4 v11, s[12:15], s66 offen offset:0 lds
    v_ashrrev_i32 v3, 3, v3
    v_mfma_f32_32x32x16_bf16 v[116:131], v[60:63], a[136:139], v[116:131]
    ds_read_b128 v[146:149], v132 offset:160
    v_cvt_pk_bf16_f32 v36, v2, v1
    v_cmp_eq_u32 s[92:93], -1, v3
    v_cmp_eq_u32 vcc, 0, v3
    s_nop 0
    v_cndmask_b32_e64 v214, v4, 0, s[92:93]
    s_waitcnt lgkmcnt(3)
    v_mfma_f32_16x16x32_bf16 v[40:43], v[142:145], v[44:47], v[40:43]
    v_cndmask_b32_e64 v222, 0, v5, s[92:93]
    v_cmp_eq_u32 s[92:93], 1, v3
    v_mfma_f32_32x32x16_bf16 v[100:115], v[64:67], a[12:15], v[100:115]
    ds_read_b64_tr_b16 v[52:53], v14 offset:8192
    ds_read_b64_tr_b16 v[54:55], v14 offset:8704
    buffer_load_dwordx4 v12, s[12:15], s66 offen offset:1024 lds
    v_cndmask_b32_e64 v198, v4, 0, vcc
    v_cndmask_b32_e64 v224, 0, v5, vcc
    v_mfma_f32_32x32x16_bf16 v[116:131], v[64:67], a[140:143], v[116:131]
    ds_read_b128 v[150:153], v133 offset:128
    v_cmp_eq_u32 vcc, 2, v3
    v_cndmask_b32_e64 v202, v4, 0, s[92:93]
    v_cndmask_b32_e64 v226, 0, v5, s[92:93]
    v_cmp_eq_u32 s[92:93], 3, v3
    s_waitcnt lgkmcnt(3)
    v_mfma_f32_16x16x32_bf16 v[40:43], v[146:149], v[48:51], v[40:43]
    v_cndmask_b32_e64 v206, v4, 0, vcc
    v_mfma_f32_32x32x16_bf16 v[100:115], v[44:47], a[16:19], v[100:115]
    s_add_u32 m0, s90, 65536
    ds_read_b64_tr_b16 v[56:57], v14 offset:10240
    ds_read_b64_tr_b16 v[58:59], v14 offset:10752
    buffer_load_dwordx4 v15, s[20:23], s88 offen offset:0 lds
    v_cndmask_b32_e64 v228, 0, v5, vcc
    v_mfma_f32_32x32x16_bf16 v[116:131], v[44:47], a[144:147], v[116:131]
    ds_read_b128 v[154:157], v133 offset:160
    v_cndmask_b32_e64 v210, v4, 0, s[92:93]
    v_cndmask_b32_e64 v230, 0, v5, s[92:93]
    v_min_f32 v218, s99, v214
    v_subrev_u32 v3, 1, v7
    v_ashrrev_i32 v3, 3, v3
    v_smfmac_f32_16x16x64_bf16 v[182:185], v[24:27], a[48:55], v23
    v_cmp_eq_u32 s[92:93], -1, v3
    v_smfmac_f32_16x16x64_bf16 v[186:189], v[24:27], a[176:183], v23
    v_cmp_eq_u32 vcc, 0, v3
    v_mfma_f32_4x4x4_16b_bf16 v[190:193], a[48:49], a[48:49], v[190:193]
    v_mfma_f32_4x4x4_16b_bf16 v[240:243], a[176:177], a[176:177], v[240:243]
    v_mfma_f32_4x4x4_16b_bf16 v[194:197], a[50:51], a[50:51], v[194:197]
    v_mfma_f32_4x4x4_16b_bf16 v[244:247], a[178:179], a[178:179], v[244:247]
    v_mfma_f32_4x4x4_16b_bf16 v[190:193], a[52:53], a[52:53], v[190:193]
    v_mfma_f32_4x4x4_16b_bf16 v[240:243], a[180:181], a[180:181], v[240:243]
    v_mfma_f32_4x4x4_16b_bf16 v[194:197], a[54:55], a[54:55], v[194:197]
    v_mfma_f32_4x4x4_16b_bf16 v[244:247], a[182:183], a[182:183], v[244:247]
    s_waitcnt lgkmcnt(3)
    v_mfma_f32_16x16x32_bf16 v[40:43], v[150:153], v[52:55], v[40:43]
    v_cndmask_b32_e64 v215, v4, 0, s[92:93]
    v_cndmask_b32_e64 v248, 0, v6, s[92:93]
    v_mfma_f32_32x32x16_bf16 v[100:115], v[48:51], a[20:23], v[100:115]
    s_waitcnt vmcnt(7)
    s_barrier
    v_mfma_f32_32x32x16_bf16 v[116:131], v[48:51], a[148:151], v[116:131]
    ds_read_b64_tr_b16 v[60:61], v13 offset:16384
    ds_read_b64_tr_b16 v[62:63], v13 offset:16896
    ds_read_b128 v[142:145], v132 offset:256
    buffer_load_dwordx4 v16, s[20:23], s88 offen offset:1024 lds
    s_waitcnt lgkmcnt(3)
    v_mfma_f32_16x16x32_bf16 v[40:43], v[154:157], v[56:59], v[40:43]
    v_or_b32 v222, v222, v248
    v_cmp_eq_u32 s[92:93], 1, v3
    v_mfma_f32_32x32x16_bf16 v[100:115], v[52:55], a[24:27], v[100:115]
    ds_read_b64_tr_b16 v[64:65], v13 offset:18432
    ds_read_b64_tr_b16 v[66:67], v13 offset:18944
    v_cndmask_b32_e64 v199, v4, 0, vcc
    v_cndmask_b32_e64 v248, 0, v6, vcc
    v_or_b32 v224, v224, v248
    v_cmp_eq_u32 vcc, 2, v3
    v_mfma_f32_32x32x16_bf16 v[116:131], v[52:55], a[152:155], v[116:131]
    ds_read_b128 v[146:149], v132 offset:288
    buffer_store_dword v39, v174, s[40:43], 0 offen sc1
    v_cndmask_b32_e64 v203, v4, 0, s[92:93]
    v_cndmask_b32_e64 v248, 0, v6, s[92:93]
    s_waitcnt lgkmcnt(3)
    v_mfma_f32_16x16x32_bf16 v[40:43], v[142:145], v[60:63], v[40:43]
    v_or_b32 v226, v226, v248
    v_mfma_f32_32x32x16_bf16 v[100:115], v[56:59], a[28:31], v[100:115]
    ds_read_b64_tr_b16 v[44:45], v14 offset:16384
    ds_read_b64_tr_b16 v[46:47], v14 offset:16896
    v_cmp_eq_u32 s[92:93], 3, v3
    v_cndmask_b32_e64 v207, v4, 0, vcc
    v_cndmask_b32_e64 v248, 0, v6, vcc
    v_or_b32 v228, v228, v248
    v_mfma_f32_32x32x16_bf16 v[116:131], v[56:59], a[156:159], v[116:131]
    s_add_u32 m0, s73, 57344
    ds_read_b128 v[150:153], v133 offset:256
    buffer_load_dwordx4 v11, s[12:15], s67 offen offset:0 lds
    v_cndmask_b32_e64 v211, v4, 0, s[92:93]
    v_cndmask_b32_e64 v248, 0, v6, s[92:93]
    v_smfmac_f32_16x16x64_bf16 v[182:185], v[24:27], a[64:71], v23
    v_or_b32 v230, v230, v248
    v_smfmac_f32_16x16x64_bf16 v[186:189], v[24:27], a[192:199], v23
    v_min_f32 v219, s99, v215
    v_mfma_f32_4x4x4_16b_bf16 v[190:193], a[64:65], a[64:65], v[190:193]
    v_mfma_f32_4x4x4_16b_bf16 v[240:243], a[192:193], a[192:193], v[240:243]
    v_mfma_f32_4x4x4_16b_bf16 v[194:197], a[66:67], a[66:67], v[194:197]
    v_mfma_f32_4x4x4_16b_bf16 v[244:247], a[194:195], a[194:195], v[244:247]
    v_mfma_f32_4x4x4_16b_bf16 v[190:193], a[68:69], a[68:69], v[190:193]
    v_mfma_f32_4x4x4_16b_bf16 v[240:243], a[196:197], a[196:197], v[240:243]
    v_mfma_f32_4x4x4_16b_bf16 v[194:197], a[70:71], a[70:71], v[194:197]
    v_mfma_f32_4x4x4_16b_bf16 v[244:247], a[198:199], a[198:199], v[244:247]
    s_waitcnt lgkmcnt(3)
    v_mfma_f32_16x16x32_bf16 v[40:43], v[146:149], v[64:67], v[40:43]
    v_subrev_u32 v3, 2, v7
    v_ashrrev_i32 v3, 3, v3
    v_mfma_f32_32x32x16_bf16 v[100:115], v[60:63], a[32:35], v[100:115]
    ds_read_b64_tr_b16 v[48:49], v14 offset:18432
    ds_read_b64_tr_b16 v[50:51], v14 offset:18944
    buffer_load_dwordx4 v12, s[12:15], s67 offen offset:1024 lds
    v_cmp_eq_u32 s[92:93], -1, v3
    v_cmp_eq_u32 vcc, 0, v3
    v_mfma_f32_32x32x16_bf16 v[116:131], v[60:63], a[160:163], v[116:131]
    ds_read_b128 v[154:157], v133 offset:288
    v_cndmask_b32_e64 v216, v4, 0, s[92:93]
    v_cndmask_b32_e64 v223, 0, v5, s[92:93]
    v_cmp_eq_u32 s[92:93], 1, v3
    v_cndmask_b32_e64 v200, v4, 0, vcc
    s_waitcnt lgkmcnt(3)
    v_mfma_f32_16x16x32_bf16 v[40:43], v[150:153], v[44:47], v[40:43]
    v_cndmask_b32_e64 v225, 0, v5, vcc
    v_cmp_eq_u32 vcc, 2, v3
    v_mfma_f32_32x32x16_bf16 v[100:115], v[64:67], a[36:39], v[100:115]
    s_add_u32 m0, s90, 65536
    ds_read_b64_tr_b16 v[52:53], v13 offset:24576
    ds_read_b64_tr_b16 v[54:55], v13 offset:25088
    buffer_load_dwordx4 v17, s[20:23], s88 offen offset:2048 lds
    v_mfma_f32_32x32x16_bf16 v[116:131], v[64:67], a[164:167], v[116:131]
    ds_read_b128 v[142:145], v132 offset:384
    v_cndmask_b32_e64 v204, v4, 0, s[92:93]
    v_cndmask_b32_e64 v227, 0, v5, s[92:93]
    v_cmp_eq_u32 s[92:93], 3, v3
    v_cndmask_b32_e64 v208, v4, 0, vcc
    s_waitcnt lgkmcnt(3)
    v_mfma_f32_16x16x32_bf16 v[40:43], v[154:157], v[48:51], v[40:43]
    v_cndmask_b32_e64 v229, 0, v5, vcc
    v_cndmask_b32_e64 v212, v4, 0, s[92:93]
    v_mfma_f32_32x32x16_bf16 v[100:115], v[44:47], a[40:43], v[100:115]
    ds_read_b64_tr_b16 v[56:57], v13 offset:26624
    ds_read_b64_tr_b16 v[58:59], v13 offset:27136
    buffer_load_dwordx4 v18, s[20:23], s88 offen offset:3072 lds
    s_add_u32 s88, s88, 32768
    s_cmp_eq_u32 s88, s78
    s_cselect_b32 s88, 0, s88
    v_mfma_f32_32x32x16_bf16 v[116:131], v[44:47], a[168:171], v[116:131]
    ds_read_b128 v[146:149], v132 offset:416
    v_cndmask_b32_e64 v231, 0, v5, s[92:93]
    v_min_f32 v220, s99, v216
    v_subrev_u32 v3, 3, v7
    v_ashrrev_i32 v3, 3, v3
    v_cmp_eq_u32 s[92:93], -1, v3
    v_smfmac_f32_16x16x64_bf16 v[182:185], v[24:27], a[80:87], v23
    v_cmp_eq_u32 vcc, 0, v3
    v_smfmac_f32_16x16x64_bf16 v[186:189], v[24:27], a[208:215], v23
    v_cndmask_b32_e64 v217, v4, 0, s[92:93]
    v_mfma_f32_4x4x4_16b_bf16 v[190:193], a[80:81], a[80:81], v[190:193]
    v_mfma_f32_4x4x4_16b_bf16 v[240:243], a[208:209], a[208:209], v[240:243]
    v_mfma_f32_4x4x4_16b_bf16 v[194:197], a[82:83], a[82:83], v[194:197]
    v_mfma_f32_4x4x4_16b_bf16 v[244:247], a[210:211], a[210:211], v[244:247]
    v_mfma_f32_4x4x4_16b_bf16 v[190:193], a[84:85], a[84:85], v[190:193]
    v_mfma_f32_4x4x4_16b_bf16 v[240:243], a[212:213], a[212:213], v[240:243]
    v_mfma_f32_4x4x4_16b_bf16 v[194:197], a[86:87], a[86:87], v[194:197]
    v_mfma_f32_4x4x4_16b_bf16 v[244:247], a[214:215], a[214:215], v[244:247]
    s_waitcnt lgkmcnt(3)
    v_mfma_f32_16x16x32_bf16 v[40:43], v[142:145], v[52:55], v[40:43]
    v_add_u32 v11, 1024, v11
    v_add_u32 v12, 1024, v12
    v_mfma_f32_32x32x16_bf16 v[100:115], v[48:51], a[44:47], v[100:115]
    s_add_u32 m0, s73, 0
    ds_read_b64_tr_b16 v[60:61], v14 offset:24576
    ds_read_b64_tr_b16 v[62:63], v14 offset:25088
    buffer_load_dwordx4 v11, s[12:15], s60 offen offset:0 lds
    v_cndmask_b32_e64 v248, 0, v6, s[92:93]
    v_mfma_f32_32x32x16_bf16 v[116:131], v[48:51], a[172:175], v[116:131]
    ds_read_b128 v[150:153], v133 offset:384
    v_or_b32 v223, v223, v248
    v_cmp_eq_u32 s[92:93], 1, v3
    v_cndmask_b32_e64 v201, v4, 0, vcc
    v_cndmask_b32_e64 v248, 0, v6, vcc
    s_waitcnt lgkmcnt(3)
    v_mfma_f32_16x16x32_bf16 v[40:43], v[146:149], v[56:59], v[40:43]
    v_or_b32 v225, v225, v248
    v_mfma_f32_32x32x16_bf16 v[100:115], v[52:55], a[48:51], v[100:115]
    ds_read_b64_tr_b16 v[64:65], v14 offset:26624
    ds_read_b64_tr_b16 v[66:67], v14 offset:27136
    buffer_load_dwordx4 v12, s[12:15], s60 offen offset:1024 lds
    v_cmp_eq_u32 vcc, 2, v3
    v_cndmask_b32_e64 v205, v4, 0, s[92:93]
    v_mfma_f32_32x32x16_bf16 v[116:131], v[52:55], a[176:179], v[116:131]
    ds_read_b128 v[154:157], v133 offset:416
    v_cndmask_b32_e64 v248, 0, v6, s[92:93]
    v_or_b32 v227, v227, v248
    v_cmp_eq_u32 s[92:93], 3, v3
    v_cndmask_b32_e64 v209, v4, 0, vcc
    s_waitcnt lgkmcnt(3)
    v_mfma_f32_16x16x32_bf16 v[40:43], v[150:153], v[60:63], v[40:43]
    v_cndmask_b32_e64 v248, 0, v6, vcc
    v_or_b32 v229, v229, v248
    v_mfma_f32_32x32x16_bf16 v[100:115], v[56:59], a[52:55], v[100:115]
    s_waitcnt vmcnt(11)
    s_barrier
    v_mfma_f32_32x32x16_bf16 v[116:131], v[56:59], a[180:183], v[116:131]
    s_add_u32 m0, s90, 81920
    ds_read_b64_tr_b16 v[44:45], v13 offset:32768
    ds_read_b64_tr_b16 v[46:47], v13 offset:33280
    ds_read_b128 v[142:145], v132 offset:512
    buffer_load_dwordx4 v15, s[20:23], s88 offen offset:0 lds
    v_smfmac_f32_16x16x64_bf16 v[182:185], v[24:27], a[96:103], v23
    v_cndmask_b32_e64 v213, v4, 0, s[92:93]
    v_smfmac_f32_16x16x64_bf16 v[186:189], v[24:27], a[224:231], v23
    v_cndmask_b32_e64 v248, 0, v6, s[92:93]
    v_mfma_f32_4x4x4_16b_bf16 v[190:193], a[96:97], a[96:97], v[190:193]
    v_mfma_f32_4x4x4_16b_bf16 v[240:243], a[224:225], a[224:225], v[240:243]
    v_mfma_f32_4x4x4_16b_bf16 v[194:197], a[98:99], a[98:99], v[194:197]
    v_mfma_f32_4x4x4_16b_bf16 v[244:247], a[226:227], a[226:227], v[244:247]
    v_mfma_f32_4x4x4_16b_bf16 v[190:193], a[100:101], a[100:101], v[190:193]
    v_mfma_f32_4x4x4_16b_bf16 v[240:243], a[228:229], a[228:229], v[240:243]
    v_mfma_f32_4x4x4_16b_bf16 v[194:197], a[102:103], a[102:103], v[194:197]
    v_mfma_f32_4x4x4_16b_bf16 v[244:247], a[230:231], a[230:231], v[244:247]
    s_waitcnt lgkmcnt(3)
    v_mfma_f32_16x16x32_bf16 v[40:43], v[154:157], v[64:67], v[40:43]
    v_or_b32 v231, v231, v248
    v_min_f32 v221, s99, v217
    v_mfma_f32_32x32x16_bf16 v[100:115], v[60:63], a[56:59], v[100:115]
    ds_read_b64_tr_b16 v[48:49], v13 offset:34816
    ds_read_b64_tr_b16 v[50:51], v13 offset:35328
    buffer_load_dwordx4 v16, s[20:23], s88 offen offset:1024 lds
    v_subrev_u32 v232, 0, v7
    v_and_b32 v232, 7, v232
    v_mfma_f32_32x32x16_bf16 v[116:131], v[60:63], a[184:187], v[116:131]
    ds_read_b128 v[146:149], v132 offset:544
    v_lshlrev_b32 v232, 2, v232
    v_sub_u32 v232, v140, v232
    v_subrev_u32 v233, 1, v7
    v_and_b32 v233, 7, v233
    s_waitcnt lgkmcnt(3)
    v_mfma_f32_16x16x32_bf16 v[40:43], v[142:145], v[44:47], v[40:43]
    v_lshlrev_b32 v233, 2, v233
    v_sub_u32 v233, v140, v233
    v_mfma_f32_32x32x16_bf16 v[100:115], v[64:67], a[60:63], v[100:115]
    s_add_u32 m0, s73, 8192
    ds_read_b64_tr_b16 v[52:53], v14 offset:32768
    ds_read_b64_tr_b16 v[54:55], v14 offset:33280
    buffer_load_dwordx4 v11, s[12:15], s61 offen offset:0 lds
    v_subrev_u32 v234, 2, v7
    v_mfma_f32_32x32x16_bf16 v[116:131], v[64:67], a[188:191], v[116:131]
    ds_read_b128 v[150:153], v133 offset:512
    v_and_b32 v234, 7, v234
    v_lshlrev_b32 v234, 2, v234
    v_sub_u32 v234, v140, v234
    v_subrev_u32 v235, 3, v7
    v_and_b32 v235, 7, v235
    v_smfmac_f32_16x16x64_bf16 v[182:185], v[24:27], a[112:119], v23
    v_lshlrev_b32 v235, 2, v235
    v_smfmac_f32_16x16x64_bf16 v[186:189], v[24:27], a[240:247], v23
    v_sub_u32 v235, v140, v235
    v_mfma_f32_4x4x4_16b_bf16 v[190:193], a[112:113], a[112:113], v[190:193]
    v_mfma_f32_4x4x4_16b_bf16 v[240:243], a[240:241], a[240:241], v[240:243]
    v_mfma_f32_4x4x4_16b_bf16 v[194:197], a[114:115], a[114:115], v[194:197]
    v_mfma_f32_4x4x4_16b_bf16 v[244:247], a[242:243], a[242:243], v[244:247]
    v_mfma_f32_4x4x4_16b_bf16 v[190:193], a[116:117], a[116:117], v[190:193]
    v_mfma_f32_4x4x4_16b_bf16 v[240:243], a[244:245], a[244:245], v[240:243]
    v_mfma_f32_4x4x4_16b_bf16 v[194:197], a[118:119], a[118:119], v[194:197]
    v_mfma_f32_4x4x4_16b_bf16 v[244:247], a[246:247], a[246:247], v[244:247]
    s_waitcnt lgkmcnt(3)
    v_mfma_f32_16x16x32_bf16 v[40:43], v[146:149], v[48:51], v[40:43]
    v_and_b32 v3, 1, v0
    v_cmp_eq_u32 vcc, 1, v3
    v_mfma_f32_32x32x16_bf16 v[100:115], v[44:47], a[64:67], v[100:115]
    ds_read_b64_tr_b16 v[56:57], v14 offset:34816
    ds_read_b64_tr_b16 v[58:59], v14 offset:35328
    buffer_load_dwordx4 v12, s[12:15], s61 offen offset:1024 lds
    v_and_b32 v3, 2, v0
    v_cmp_eq_u32 s[92:93], 2, v3
    v_mfma_f32_32x32x16_bf16 v[116:131], v[44:47], a[192:195], v[116:131]
    ds_read_b128 v[154:157], v133 offset:544
    v_add_f32 v248, v182, v183
    v_add_f32 v190, v190, v194
    v_add_f32 v191, v191, v195
    v_add_f32 v192, v192, v196
    s_waitcnt lgkmcnt(3)
    v_mfma_f32_16x16x32_bf16 v[40:43], v[150:153], v[52:55], v[40:43]
    v_add_f32 v193, v193, v197
    v_cndmask_b32 v190, v190, v191, vcc
    v_mfma_f32_32x32x16_bf16 v[100:115], v[48:51], a[68:71], v[100:115]
    s_add_u32 m0, s73, 16384
    ds_read_b64_tr_b16 v[60:61], v13 offset:40960
    ds_read_b64_tr_b16 v[62:63], v13 offset:41472
    buffer_load_dwordx4 v11, s[12:15], s62 offen offset:0 lds
    v_cndmask_b32 v192, v192, v193, vcc
    v_mfma_f32_32x32x16_bf16 v[116:131], v[48:51], a[196:199], v[116:131]
    ds_read_b128 v[142:145], v132 offset:640
    v_cndmask_b32 v190, v190, v192, s[92:93]
    v_mov_b32 v191, v190
    v_add_f32 v250, v186, v187
    v_add_f32 v240, v240, v244
    s_waitcnt lgkmcnt(3)
    v_mfma_f32_16x16x32_bf16 v[40:43], v[154:157], v[56:59], v[40:43]
    v_add_f32 v241, v241, v245
    v_add_f32 v242, v242, v246
    v_mfma_f32_32x32x16_bf16 v[100:115], v[52:55], a[72:75], v[100:115]
    ds_read_b64_tr_b16 v[64:65], v13 offset:43008
    ds_read_b64_tr_b16 v[66:67], v13 offset:43520
    buffer_load_dwordx4 v12, s[12:15], s62 offen offset:1024 lds
    v_add_f32 v243, v243, v247
    v_cndmask_b32 v240, v240, v241, vcc
    v_mfma_f32_32x32x16_bf16 v[116:131], v[52:55], a[200:203], v[116:131]
    ds_read_b128 v[146:149], v132 offset:672
    v_cndmask_b32 v242, v242, v243, vcc
    v_cndmask_b32 v240, v240, v242, s[92:93]
    v_mov_b32 v241, v240
    v_permlane32_swap_b32 v190, v191
    s_waitcnt lgkmcnt(3)
    v_mfma_f32_16x16x32_bf16 v[40:43], v[142:145], v[60:63], v[40:43]
    v_permlane32_swap_b32 v240, v241
    v_add_f32 v249, v190, v191
    v_mfma_f32_32x32x16_bf16 v[100:115], v[56:59], a[76:79], v[100:115]
    s_add_u32 m0, s90, 81920
    ds_read_b64_tr_b16 v[44:45], v14 offset:40960
    ds_read_b64_tr_b16 v[46:47], v14 offset:41472
    buffer_load_dwordx4 v17, s[20:23], s88 offen offset:2048 lds
    v_add_f32 v251, v240, v241
    v_mfma_f32_32x32x16_bf16 v[116:131], v[56:59], a[204:207], v[116:131]
    ds_read_b128 v[150:153], v133 offset:640
    ds_write_b128 v134, v[248:251]
    s_waitcnt lgkmcnt(4)
    v_mfma_f32_16x16x32_bf16 v[40:43], v[146:149], v[64:67], v[40:43]
    v_xor_b32 v134, 2048, v134
    v_mfma_f32_32x32x16_bf16 v[100:115], v[60:63], a[80:83], v[100:115]
    ds_read_b64_tr_b16 v[48:49], v14 offset:43008
    ds_read_b64_tr_b16 v[50:51], v14 offset:43520
    buffer_load_dwordx4 v18, s[20:23], s88 offen offset:3072 lds
    s_add_u32 s88, s88, 32768
    s_cmp_eq_u32 s88, s78
    s_cselect_b32 s88, 0, s88
    v_mfma_f32_32x32x16_bf16 v[116:131], v[60:63], a[208:211], v[116:131]
    ds_read_b128 v[154:157], v133 offset:672
    s_waitcnt lgkmcnt(4)
    v_mfma_f32_16x16x32_bf16 v[40:43], v[150:153], v[44:47], v[40:43]
    v_mfma_f32_32x32x16_bf16 v[100:115], v[64:67], a[84:87], v[100:115]
    s_waitcnt vmcnt(12) lgkmcnt(3)
    s_barrier
    ds_read_b128 v[252:255], v134
    v_mfma_f32_32x32x16_bf16 v[116:131], v[64:67], a[212:215], v[116:131]
    ds_read_b64_tr_b16 v[52:53], v13 offset:49152
    ds_read_b64_tr_b16 v[54:55], v13 offset:49664
    ds_read_b128 v[142:145], v132 offset:768
    buffer_store_dword v23, off, s[44:47], 0 sc1
    v_cmp_gt_u32 vcc, 32, v0
    s_waitcnt lgkmcnt(4)
    v_mfma_f32_16x16x32_bf16 v[40:43], v[154:157], v[48:51], v[40:43]
    v_xor_b32 v19, 64, v21
    v_xor_b32 v20, 64, v22
    v_mfma_f32_32x32x16_bf16 v[100:115], v[44:47], a[88:91], v[100:115]
    ds_read_b64_tr_b16 v[56:57], v13 offset:51200
    ds_read_b64_tr_b16 v[58:59], v13 offset:51712
    s_waitcnt lgkmcnt(5)
    v_add_f32 v248, v248, v252
    v_add_f32 v249, v249, v253
    v_add_f32 v250, v250, v254
    v_add_f32 v251, v251, v255
    v_mul_f32 v248, 0x3b000000, v248
    v_mfma_f32_32x32x16_bf16 v[116:131], v[44:47], a[216:219], v[116:131]
    s_add_u32 m0, s73, 24576
    ds_read_b128 v[146:149], v132 offset:800
    buffer_load_dwordx4 v11, s[12:15], s63 offen offset:0 lds
    v_mul_f32 v250, 0x3b000000, v250
    v_mul_f32 v249, 0x3b000000, v249
    s_waitcnt lgkmcnt(3)
    v_mfma_f32_16x16x32_bf16 v[40:43], v[142:145], v[52:55], v[40:43]
    v_mul_f32 v251, 0x3b000000, v251
    v_fma_f32 v249, -v248, v248, v249
    v_fma_f32 v251, -v250, v250, v251
    v_mfma_f32_32x32x16_bf16 v[100:115], v[48:51], a[92:95], v[100:115]
    ds_read_b64_tr_b16 v[60:61], v14 offset:49152
    ds_read_b64_tr_b16 v[62:63], v14 offset:49664
    v_max_f32 v249, 0, v249
    v_max_f32 v251, 0, v251
    v_cvt_pk_bf16_f32 v28, -v248, -v248
    v_cvt_pk_bf16_f32 v32, -v250, -v250
    v_cvt_pk_bf16_f32 v252, v249, v249
    v_mfma_f32_32x32x16_bf16 v[116:131], v[48:51], a[220:223], v[116:131]
    ds_read_b128 v[150:153], v133 offset:768
    buffer_load_dwordx4 v12, s[12:15], s63 offen offset:1024 lds
    v_cvt_pk_bf16_f32 v253, v251, v251
    v_and_b32 v252, 0xffff0000, v252
    v_and_b32 v253, 0xffff0000, v253
    s_waitcnt lgkmcnt(3)
    v_mfma_f32_16x16x32_bf16 v[40:43], v[146:149], v[56:59], v[40:43]
    v_add_f32 v252, 0x3727c5ac, v252
    v_add_f32 v253, 0x3727c5ac, v253
    v_cvt_pk_bf16_f32 v252, v252, v252
    v_mfma_f32_32x32x16_bf16 v[100:115], v[52:55], a[96:99], v[100:115]
    ds_read_b64_tr_b16 v[64:65], v14 offset:51200
    ds_read_b64_tr_b16 v[66:67], v14 offset:51712
    v_cvt_pk_bf16_f32 v253, v253, v253
    v_and_b32 v252, 0xffff0000, v252
    v_and_b32 v253, 0xffff0000, v253
    v_sqrt_f32 v252, v252
    v_mfma_f32_32x32x16_bf16 v[116:131], v[52:55], a[224:227], v[116:131]
    s_add_u32 m0, s90, 98304
    ds_read_b128 v[154:157], v133 offset:800
    buffer_load_dwordx4 v15, s[20:23], s88 offen offset:0 lds
    v_sqrt_f32 v253, v253
    s_waitcnt lgkmcnt(3)
    v_mfma_f32_16x16x32_bf16 v[40:43], v[150:153], v[60:63], v[40:43]
    v_cvt_pk_bf16_f32 v29, v252, 0
    v_cvt_pk_bf16_f32 v33, v253, 0
    v_lshlrev_b32 v135, 16, v29
    v_mfma_f32_32x32x16_bf16 v[100:115], v[56:59], a[100:103], v[100:115]
    ds_read_b64_tr_b16 v[44:45], v13 offset:57344
    ds_read_b64_tr_b16 v[46:47], v13 offset:57856
    v_lshlrev_b32 v136, 16, v33
    v_rcp_f32 v137, v135
    v_rcp_f32 v138, v136
    v_mfma_f32_32x32x16_bf16 v[116:131], v[56:59], a[228:231], v[116:131]
    ds_read_b128 v[142:145], v132 offset:896
    buffer_load_dwordx4 v16, s[20:23], s88 offen offset:1024 lds
    v_cndmask_b32 v28, 0, v28, vcc
    v_cndmask_b32 v29, 0, v29, vcc
    v_cndmask_b32 v32, 0, v32, vcc
    v_cndmask_b32 v33, 0, v33, vcc
    v_mfma_f32_32x32x16_bf16 v[68:83], v[36:39], v[28:31], v[68:83]
    ds_write_b32 v140, v137
    ds_write_b32 v140, v138 offset:128
    v_mul_f32 v137, 0x3eb8aa3b, v137
    v_mul_f32 v138, 0x3eb8aa3b, v138
    v_mfma_f32_32x32x16_bf16 v[84:99], v[36:39], v[32:35], v[84:99]
    ds_read_b32 v236, v232 offset:128
    ds_read_b32 v237, v233 offset:128
    ds_read_b32 v238, v234 offset:128
    ds_read_b32 v239, v235 offset:128
    ds_read_b32 v232, v232 offset:0
    s_waitcnt lgkmcnt(10)
    v_mfma_f32_16x16x32_bf16 v[40:43], v[154:157], v[64:67], v[40:43]
    ds_read_b32 v233, v233 offset:0
    ds_read_b32 v234, v234 offset:0
    v_mfma_f32_32x32x16_bf16 v[100:115], v[60:63], a[104:107], v[100:115]
    ds_read_b64_tr_b16 v[48:49], v13 offset:59392
    ds_read_b64_tr_b16 v[50:51], v13 offset:59904
    ds_read_b32 v235, v235 offset:0
    v_cvt_pk_bf16_f32 v158, v68, v69
    v_cvt_pk_bf16_f32 v159, v70, v71
    v_mfma_f32_32x32x16_bf16 v[116:131], v[60:63], a[232:235], v[116:131]
    s_add_u32 m0, s73, 32768
    ds_read_b128 v[146:149], v132 offset:928
    buffer_load_dwordx4 v11, s[12:15], s64 offen offset:0 lds
    v_cvt_pk_bf16_f32 v160, v72, v73
    s_waitcnt lgkmcnt(13)
    v_mfma_f32_16x16x32_bf16 v[40:43], v[142:145], v[44:47], v[40:43]
    v_cvt_pk_bf16_f32 v161, v74, v75
    v_cvt_pk_bf16_f32 v162, v76, v77
    v_mfma_f32_32x32x16_bf16 v[100:115], v[64:67], a[108:111], v[100:115]
    ds_read_b64_tr_b16 v[52:53], v14 offset:57344
    ds_read_b64_tr_b16 v[54:55], v14 offset:57856
    v_cvt_pk_bf16_f32 v163, v78, v79
    v_cvt_pk_bf16_f32 v164, v80, v81
    v_cvt_pk_bf16_f32 v165, v82, v83
    v_mfma_f32_32x32x16_bf16 v[116:131], v[64:67], a[236:239], v[116:131]
    ds_read_b128 v[150:153], v133 offset:896
    buffer_load_dwordx4 v12, s[12:15], s64 offen offset:1024 lds
    v_cvt_pk_bf16_f32 v166, v84, v85
    v_cvt_pk_bf16_f32 v167, v86, v87
    s_waitcnt lgkmcnt(3)
    v_mfma_f32_16x16x32_bf16 v[40:43], v[146:149], v[48:51], v[40:43]
    v_cvt_pk_bf16_f32 v168, v88, v89
    v_mfma_f32_32x32x16_bf16 v[100:115], v[44:47], a[112:115], v[100:115]
    ds_read_b64_tr_b16 v[56:57], v14 offset:59392
    ds_read_b64_tr_b16 v[58:59], v14 offset:59904
    v_cvt_pk_bf16_f32 v169, v90, v91
    v_cvt_pk_bf16_f32 v170, v92, v93
    v_cvt_pk_bf16_f32 v171, v94, v95
    v_cvt_pk_bf16_f32 v172, v96, v97
    v_mfma_f32_32x32x16_bf16 v[116:131], v[44:47], a[240:243], v[116:131]
    s_add_u32 m0, s90, 98304
    ds_read_b128 v[154:157], v133 offset:928
    buffer_load_dwordx4 v17, s[20:23], s88 offen offset:2048 lds
    v_cvt_pk_bf16_f32 v173, v98, v99
    s_waitcnt lgkmcnt(3)
    v_mfma_f32_16x16x32_bf16 v[40:43], v[150:153], v[52:55], v[40:43]
    v_mul_f32 v232, v232, v137
    v_mfma_f32_32x32x16_bf16 v[100:115], v[48:51], a[116:119], v[100:115]
    s_waitcnt vmcnt(12)
    s_barrier
    v_mfma_f32_32x32x16_bf16 v[116:131], v[48:51], a[244:247], v[116:131]
    ds_read_b64_tr_b16 v[60:61], v13 offset:0
    ds_read_b64_tr_b16 v[62:63], v13 offset:512
    ds_read_b128 v[142:145], v132 offset:0
    buffer_load_dwordx4 v18, s[20:23], s88 offen offset:3072 lds
    s_add_u32 s88, s88, 32768
    s_cmp_eq_u32 s88, s78
    s_cselect_b32 s88, 0, s88
    s_waitcnt lgkmcnt(3)
    v_mfma_f32_16x16x32_bf16 v[40:43], v[154:157], v[56:59], v[40:43]
    v_mul_f32 v233, v233, v137
    v_mul_f32 v234, v234, v137
    v_mfma_f32_32x32x16_bf16 v[100:115], v[52:55], a[120:123], v[100:115]
    ds_read_b64_tr_b16 v[64:65], v13 offset:2048
    ds_read_b64_tr_b16 v[66:67], v13 offset:2560
    v_mul_f32 v235, v235, v137
    v_mul_f32 v236, v236, v138
    v_mul_f32 v237, v237, v138
    v_mfma_f32_32x32x16_bf16 v[116:131], v[52:55], a[248:251], v[116:131]
    s_add_u32 m0, s73, 40960
    ds_read_b128 v[146:149], v132 offset:32
    buffer_load_dwordx4 v11, s[12:15], s65 offen offset:0 lds
    v_mul_f32 v238, v238, v138
    v_mul_f32 v239, v239, v138
    v_mfma_f32_32x32x16_bf16 v[100:115], v[56:59], a[124:127], v[100:115]
    ds_read_b64_tr_b16 v[44:45], v14 offset:0
    ds_read_b64_tr_b16 v[46:47], v14 offset:512
    v_and_b32 v2, 0xffff0000, v40
    v_sub_f32 v1, v40, v2
    v_cvt_pk_bf16_f32 v36, v2, v1
    v_mfma_f32_32x32x16_bf16 v[116:131], v[56:59], a[252:255], v[116:131]
    ds_read_b128 v[150:153], v133 offset:0
    buffer_load_dwordx4 v12, s[12:15], s65 offen offset:1024 lds
    v_cvt_pk_bf16_f32 v248, v40, v41
    v_cvt_pk_bf16_f32 v249, v42, v43
    v_mfma_f32_32x32x16_bf16 v[100:115], v[36:39], v[28:31], v[100:115]
    ds_write_b16 v139, v248
    ds_write_b16_d16_hi v139, v248 offset:64
    ds_write_b16 v139, v249 offset:128
    ds_write_b16_d16_hi v139, v249 offset:192
    v_mfma_f32_32x32x16_bf16 v[116:131], v[36:39], v[32:35], v[116:131]
    v_and_b32 v3, 7, v0
    v_lshrrev_b32 v4, 5, v0
    v_lshlrev_b32 v4, 3, v4
    s_waitcnt lgkmcnt(10)
    v_mfma_f32_16x16x32_bf16 v[40:43], v[142:145], v[60:63], 0
    v_lshl_add_u32 v3, v3, 6, v4
    s_waitcnt lgkmcnt(7)
    v_mfma_f32_16x16x32_bf16 v[40:43], v[146:149], v[64:67], v[40:43]
    v_add_u32 v3, s91, v3
    v_mfma_f32_32x32x16_bf16 v[68:83], a[0:3], v[60:63], 0
    s_add_u32 m0, s90, 114688
    ds_read_b64_tr_b16 v[48:49], v14 offset:2048
    ds_read_b64_tr_b16 v[50:51], v14 offset:2560
    buffer_load_dwordx4 v15, s[20:23], s88 offen offset:0 lds
    ds_read2_b64 v[190:193], v3 offset0:0 offset1:2
    v_mfma_f32_32x32x16_bf16 v[84:99], a[128:131], v[60:63], 0
    ds_read_b128 v[154:157], v133 offset:32
    ds_read2_b64 v[194:197], v3 offset0:4 offset1:6
    v_cvt_pk_bf16_f32 v174, v100, v101
    v_cvt_pk_bf16_f32 v175, v102, v103
    s_waitcnt lgkmcnt(9)
    v_mfma_f32_16x16x32_bf16 v[40:43], v[150:153], v[44:47], v[40:43]
    v_cvt_pk_bf16_f32 v176, v104, v105
    v_mfma_f32_32x32x16_bf16 v[68:83], a[4:7], v[64:67], v[68:83]
    ds_read_b64_tr_b16 v[52:53], v13 offset:8192
    ds_read_b64_tr_b16 v[54:55], v13 offset:8704
    buffer_load_dwordx4 v16, s[20:23], s88 offen offset:1024 lds
    v_cvt_pk_bf16_f32 v177, v106, v107
    v_cvt_pk_bf16_f32 v178, v108, v109
    v_mfma_f32_32x32x16_bf16 v[84:99], a[132:135], v[64:67], v[84:99]
    ds_read_b128 v[142:145], v132 offset:128
    v_cvt_pk_bf16_f32 v179, v110, v111
    v_cvt_pk_bf16_f32 v180, v112, v113
    s_waitcnt lgkmcnt(4)
    v_mfma_f32_16x16x32_bf16 v[40:43], v[154:157], v[48:51], v[40:43]
    v_cvt_pk_bf16_f32 v181, v114, v115
    v_cvt_pk_bf16_f32 v182, v116, v117
    v_mfma_f32_32x32x16_bf16 v[68:83], a[8:11], v[44:47], v[68:83]
    s_add_u32 m0, s73, 49152
    ds_read_b64_tr_b16 v[56:57], v13 offset:10240
    ds_read_b64_tr_b16 v[58:59], v13 offset:10752
    buffer_load_dwordx4 v11, s[12:15], s66 offen offset:0 lds
    v_mfma_f32_32x32x16_bf16 v[84:99], a[136:139], v[44:47], v[84:99]
    ds_read_b128 v[146:149], v132 offset:160
    v_cvt_pk_bf16_f32 v183, v118, v119
    v_cvt_pk_bf16_f32 v184, v120, v121
    v_cvt_pk_bf16_f32 v185, v122, v123
    s_waitcnt lgkmcnt(3)
    v_mfma_f32_16x16x32_bf16 v[40:43], v[142:145], v[52:55], v[40:43]
    ds_read_b64_tr_b16 a[0:1], v21 offset:0
    v_cvt_pk_bf16_f32 v186, v124, v125
    v_mfma_f32_32x32x16_bf16 v[68:83], a[12:15], v[48:51], v[68:83]
    ds_read_b64_tr_b16 v[60:61], v14 offset:8192
    ds_read_b64_tr_b16 v[62:63], v14 offset:8704
    buffer_load_dwordx4 v12, s[12:15], s66 offen offset:1024 lds
    v_cvt_pk_bf16_f32 v187, v126, v127
    v_mfma_f32_32x32x16_bf16 v[84:99], a[140:143], v[48:51], v[84:99]
    ds_read_b128 v[150:153], v133 offset:128
    ds_read_b64_tr_b16 a[2:3], v21 offset:1024
    ds_read_b64_tr_b16 a[128:129], v22 offset:0
    v_cvt_pk_bf16_f32 v188, v128, v129
    v_cvt_pk_bf16_f32 v189, v130, v131
    v_mfma_f32_32x32x16_bf16 v[100:115], v[174:177], v[158:161], v[198:213]
    ds_read_b64_tr_b16 a[130:131], v22 offset:1024
    v_mfma_f32_32x32x16_bf16 v[116:131], v[190:193], v[158:161], v[206:221]
    ds_read_b64_tr_b16 a[4:5], v19 offset:0
    ds_read_b64_tr_b16 a[6:7], v19 offset:1024
    s_waitcnt lgkmcnt(9)
    v_mfma_f32_16x16x32_bf16 v[40:43], v[146:149], v[56:59], v[40:43]
    ds_read_b64_tr_b16 a[132:133], v20 offset:0
    v_mfma_f32_32x32x16_bf16 v[68:83], a[16:19], v[52:55], v[68:83]
    s_add_u32 m0, s90, 114688
    ds_read_b64_tr_b16 v[64:65], v14 offset:10240
    ds_read_b64_tr_b16 v[66:67], v14 offset:10752
    buffer_load_dwordx4 v17, s[20:23], s88 offen offset:2048 lds
    v_mfma_f32_32x32x16_bf16 v[84:99], a[144:147], v[52:55], v[84:99]
    ds_read_b128 v[154:157], v133 offset:160
    ds_read_b64_tr_b16 a[134:135], v20 offset:1024
    s_waitcnt lgkmcnt(10)
    v_mfma_f32_16x16x32_bf16 v[40:43], v[150:153], v[60:63], v[40:43]
    v_max3_f32 v248, v100, v104, v108
    v_max3_f32 v249, v101, v105, v109
    v_mfma_f32_32x32x16_bf16 v[68:83], a[20:23], v[56:59], v[68:83]
    s_waitcnt vmcnt(13)
    s_barrier
    v_mfma_f32_32x32x16_bf16 v[84:99], a[148:151], v[56:59], v[84:99]
    ds_read_b64_tr_b16 v[44:45], v13 offset:16384
    ds_read_b64_tr_b16 v[46:47], v13 offset:16896
    ds_read_b128 v[142:145], v132 offset:256
    buffer_load_dwordx4 v18, s[20:23], s88 offen offset:3072 lds
    s_add_u32 s88, s88, 32768
    s_cmp_eq_u32 s88, s78
    s_cselect_b32 s88, 0, s88
    s_waitcnt lgkmcnt(4)
    v_mfma_f32_16x16x32_bf16 v[40:43], v[154:157], v[64:67], v[40:43]
    ds_read_b64_tr_b16 a[8:9], v21 offset:16384
    v_max3_f32 v250, v102, v106, v110
    v_mfma_f32_32x32x16_bf16 v[68:83], a[24:27], v[60:63], v[68:83]
    ds_read_b64_tr_b16 v[48:49], v13 offset:18432
    ds_read_b64_tr_b16 v[50:51], v13 offset:18944
    ds_read_b64_tr_b16 a[10:11], v21 offset:17408
    ds_read_b64_tr_b16 a[136:137], v22 offset:16384
    v_max3_f32 v251, v103, v107, v111
    v_max3_f32 v248, v248, v112, v128
    v_max3_f32 v249, v249, v113, v129
    v_mfma_f32_32x32x16_bf16 v[84:99], a[152:155], v[60:63], v[84:99]
    s_add_u32 m0, s73, 57344
    ds_read_b128 v[146:149], v132 offset:288
    buffer_load_dwordx4 v11, s[12:15], s67 offen offset:0 lds
    ds_read_b64_tr_b16 a[138:139], v22 offset:17408
    v_max3_f32 v250, v250, v114, v130
    v_max3_f32 v251, v251, v115, v131
    v_mfma_f32_32x32x16_bf16 v[100:115], v[178:181], v[162:165], v[198:213]
    ds_read_b64_tr_b16 a[12:13], v19 offset:16384
    ds_read_b64_tr_b16 a[14:15], v19 offset:17408
    v_mfma_f32_32x32x16_bf16 v[116:131], v[194:197], v[162:165], v[206:221]
    ds_read_b64_tr_b16 a[140:141], v20 offset:16384
    ds_read_b64_tr_b16 a[142:143], v20 offset:17408
    s_waitcnt lgkmcnt(11)
    v_mfma_f32_16x16x32_bf16 v[40:43], v[142:145], v[44:47], v[40:43]
    s_waitcnt vmcnt(9)
    ds_read_b64_tr_b16 a[16:17], v21 offset:32768
    v_mfma_f32_32x32x16_bf16 v[68:83], a[28:31], v[64:67], v[68:83]
    ds_read_b64_tr_b16 v[52:53], v14 offset:16384
    ds_read_b64_tr_b16 v[54:55], v14 offset:16896
    ds_read_b64_tr_b16 a[18:19], v21 offset:33792
    ds_read_b64_tr_b16 a[144:145], v22 offset:32768
    v_mfma_f32_32x32x16_bf16 v[84:99], a[156:159], v[64:67], v[84:99]
    ds_read_b128 v[150:153], v133 offset:256
    buffer_load_dwordx4 v12, s[12:15], s67 offen offset:1024 lds
    ds_read_b64_tr_b16 a[146:147], v22 offset:33792
    s_waitcnt lgkmcnt(12)
    v_mfma_f32_16x16x32_bf16 v[40:43], v[146:149], v[48:51], v[40:43]
    ds_read_b64_tr_b16 a[20:21], v19 offset:32768
    v_max3_f32 v252, v100, v104, v108
    v_mfma_f32_32x32x16_bf16 v[68:83], a[32:35], v[44:47], v[68:83]
    ds_read_b64_tr_b16 v[56:57], v14 offset:18432
    ds_read_b64_tr_b16 v[58:59], v14 offset:18944
    ds_read_b64_tr_b16 a[22:23], v19 offset:33792
    ds_read_b64_tr_b16 a[148:149], v20 offset:32768
    v_max3_f32 v253, v101, v105, v109
    v_max3_f32 v254, v102, v106, v110
    v_mfma_f32_32x32x16_bf16 v[84:99], a[160:163], v[44:47], v[84:99]
    s_add_u32 m0, s90, 65536
    ds_read_b128 v[154:157], v133 offset:288
    buffer_load_dwordx4 v15, s[20:23], s88 offen offset:0 lds
    ds_read_b64_tr_b16 a[150:151], v20 offset:33792
    s_waitcnt lgkmcnt(8)
    v_mfma_f32_16x16x32_bf16 v[40:43], v[150:153], v[52:55], v[40:43]
    v_max3_f32 v255, v103, v107, v111
    v_max3_f32 v252, v252, v112, v128
    v_mfma_f32_32x32x16_bf16 v[68:83], a[36:39], v[48:51], v[68:83]
    ds_read_b64_tr_b16 v[60:61], v13 offset:24576
    ds_read_b64_tr_b16 v[62:63], v13 offset:25088
    v_max3_f32 v253, v253, v113, v129
    v_max3_f32 v254, v254, v114, v130
    v_max3_f32 v255, v255, v115, v131
    v_mul_f32 v248, v248, v232
    v_mfma_f32_32x32x16_bf16 v[84:99], a[164:167], v[48:51], v[84:99]
    ds_read_b128 v[142:145], v132 offset:384
    buffer_load_dwordx4 v16, s[20:23], s88 offen offset:1024 lds
    v_mul_f32 v249, v249, v233
    v_mul_f32 v250, v250, v234
    s_waitcnt lgkmcnt(4)
    v_mfma_f32_16x16x32_bf16 v[40:43], v[154:157], v[56:59], v[40:43]
    v_mul_f32 v251, v251, v235
    v_mul_f32 v252, v252, v232
    v_mfma_f32_32x32x16_bf16 v[68:83], a[40:43], v[52:55], v[68:83]
    ds_read_b64_tr_b16 v[64:65], v13 offset:26624
    ds_read_b64_tr_b16 v[66:67], v13 offset:27136
    v_mul_f32 v253, v253, v233
    v_mul_f32 v254, v254, v234
    v_mul_f32 v255, v255, v235
    v_max3_f32 v3, v248, v249, v250
    v_mfma_f32_32x32x16_bf16 v[84:99], a[168:171], v[52:55], v[84:99]
    ds_read_b128 v[146:149], v132 offset:416
    buffer_load_dwordx4 v17, s[20:23], s88 offen offset:2048 lds
    v_max3_f32 v4, v252, v253, v254
    v_max_f32 v3, v3, v251
    s_waitcnt lgkmcnt(3)
    v_mfma_f32_16x16x32_bf16 v[40:43], v[142:145], v[60:63], v[40:43]
    v_max_f32 v4, v4, v255
    s_nop 1
    v_permlane32_swap_b32 v3, v4
    v_mfma_f32_32x32x16_bf16 v[68:83], a[44:47], v[56:59], v[68:83]
    ds_read_b64_tr_b16 v[44:45], v14 offset:24576
    ds_read_b64_tr_b16 v[46:47], v14 offset:25088
    v_max_f32 v4, v3, v4
    v_mov_b32 v3, v4
    s_nop 1
    v_permlane32_swap_b32 v3, v4
    v_sub_f32 v248, v248, v3
    v_mfma_f32_32x32x16_bf16 v[84:99], a[172:175], v[56:59], v[84:99]
    ds_read_b128 v[150:153], v133 offset:384
    buffer_load_dwordx4 v18, s[20:23], s88 offen offset:3072 lds
    s_add_u32 s88, s88, 32768
    s_cmp_eq_u32 s88, s78
    s_cselect_b32 s88, 0, s88
    s_waitcnt lgkmcnt(3)
    v_mfma_f32_16x16x32_bf16 v[40:43], v[146:149], v[64:67], v[40:43]
    v_sub_f32 v249, v249, v3
    v_sub_f32 v250, v250, v3
    v_mfma_f32_32x32x16_bf16 v[68:83], a[48:51], v[60:63], v[68:83]
    ds_read_b64_tr_b16 v[48:49], v14 offset:26624
    ds_read_b64_tr_b16 v[50:51], v14 offset:27136
    v_sub_f32 v251, v251, v3
    v_sub_f32 v252, v252, v4
    v_sub_f32 v253, v253, v4
    v_sub_f32 v254, v254, v4
    v_mfma_f32_32x32x16_bf16 v[84:99], a[176:179], v[60:63], v[84:99]
    ds_read_b128 v[154:157], v133 offset:416
    v_sub_f32 v255, v255, v4
    v_exp_f32 v248, v248
    v_exp_f32 v249, v249
    s_waitcnt lgkmcnt(3)
    v_mfma_f32_16x16x32_bf16 v[40:43], v[150:153], v[44:47], v[40:43]
    v_exp_f32 v250, v250
    v_mfma_f32_32x32x16_bf16 v[68:83], a[52:55], v[64:67], v[68:83]
    s_waitcnt vmcnt(12)
    s_barrier
    v_mfma_f32_32x32x16_bf16 v[84:99], a[180:183], v[64:67], v[84:99]
    s_add_u32 m0, s90, 81920
    ds_read_b64_tr_b16 v[52:53], v13 offset:32768
    ds_read_b64_tr_b16 v[54:55], v13 offset:33280
    ds_read_b128 v[142:145], v132 offset:512
    buffer_load_dwordx4 v15, s[20:23], s88 offen offset:0 lds
    s_waitcnt lgkmcnt(3)
    v_mfma_f32_16x16x32_bf16 v[40:43], v[154:157], v[48:51], v[40:43]
    v_exp_f32 v251, v251
    v_mfma_f32_32x32x16_bf16 v[68:83], a[56:59], v[44:47], v[68:83]
    ds_read_b64_tr_b16 v[56:57], v13 offset:34816
    ds_read_b64_tr_b16 v[58:59], v13 offset:35328
    v_exp_f32 v252, v252
    v_exp_f32 v253, v253
    v_mfma_f32_32x32x16_bf16 v[84:99], a[184:187], v[44:47], v[84:99]
    ds_read_b128 v[146:149], v132 offset:544
    buffer_load_dwordx4 v16, s[20:23], s88 offen offset:1024 lds
    v_exp_f32 v254, v254
    s_waitcnt lgkmcnt(3)
    v_mfma_f32_16x16x32_bf16 v[40:43], v[142:145], v[52:55], v[40:43]
    v_exp_f32 v255, v255
    v_mfma_f32_32x32x16_bf16 v[68:83], a[60:63], v[48:51], v[68:83]
    ds_read_b64_tr_b16 v[60:61], v14 offset:32768
    ds_read_b64_tr_b16 v[62:63], v14 offset:33280
    v_add_f32 v3, v248, v249
    v_add_f32 v4, v252, v253
    v_add_f32 v3, v3, v250
    v_add_f32 v4, v4, v254
    v_mfma_f32_32x32x16_bf16 v[84:99], a[188:191], v[48:51], v[84:99]
    ds_read_b128 v[150:153], v133 offset:512
    buffer_load_dwordx4 v17, s[20:23], s88 offen offset:2048 lds
    v_add_f32 v3, v3, v251
    v_add_f32 v4, v4, v255
    s_waitcnt lgkmcnt(3)
    v_mfma_f32_16x16x32_bf16 v[40:43], v[146:149], v[56:59], v[40:43]
    v_mul_f32 v248, v248, v232
    v_mul_f32 v249, v249, v233
    v_mfma_f32_32x32x16_bf16 v[68:83], a[64:67], v[52:55], v[68:83]
    ds_read_b64_tr_b16 v[64:65], v14 offset:34816
    ds_read_b64_tr_b16 v[66:67], v14 offset:35328
    v_mul_f32 v250, v250, v234
    v_mul_f32 v251, v251, v235
    v_permlane32_swap_b32 v3, v4
    v_add_f32 v4, v3, v4
    v_mfma_f32_32x32x16_bf16 v[84:99], a[192:195], v[52:55], v[84:99]
    ds_read_b128 v[154:157], v133 offset:544
    buffer_load_dwordx4 v18, s[20:23], s88 offen offset:3072 lds
    s_add_u32 s88, s88, 32768
    s_cmp_eq_u32 s88, s78
    s_cselect_b32 s88, 0, s88
    v_mfma_f32_32x32x16_bf16 v[100:115], v[182:185], v[166:169], v[198:213]
    v_mul_f32 v4, v4, v137
    v_rcp_f32 v4, v4
    v_mul_f32 v252, v252, v232
    v_mul_f32 v253, v253, v233
    v_mul_f32 v254, v254, v234
    v_mfma_f32_32x32x16_bf16 v[116:131], v[174:177], v[166:169], v[202:217]
    v_mul_f32 v255, v255, v235
    v_mov_b32 v3, v4
    s_nop 1
    v_permlane32_swap_b32 v3, v4
    v_mul_f32 v248, v248, v3
    v_mul_f32 v249, v249, v3
    s_waitcnt lgkmcnt(3)
    v_mfma_f32_16x16x32_bf16 v[40:43], v[150:153], v[60:63], v[40:43]
    v_mul_f32 v250, v250, v3
    v_mul_f32 v251, v251, v3
    v_mfma_f32_32x32x16_bf16 v[68:83], a[68:71], v[56:59], v[68:83]
    ds_read_b64_tr_b16 v[44:45], v13 offset:40960
    ds_read_b64_tr_b16 v[46:47], v13 offset:41472
    v_mul_f32 v252, v252, v4
    v_mul_f32 v253, v253, v4
    v_mul_f32 v254, v254, v4
    v_mul_f32 v255, v255, v4
    v_mfma_f32_32x32x16_bf16 v[84:99], a[196:199], v[56:59], v[84:99]
    ds_read_b128 v[142:145], v132 offset:640
    v_cvt_pk_bf16_f32 v240, v248, v249
    v_cvt_pk_bf16_f32 v241, v250, v251
    v_cvt_pk_bf16_f32 v242, v252, v253
    v_cvt_pk_bf16_f32 v243, v254, v255
    s_waitcnt lgkmcnt(3)
    v_mfma_f32_16x16x32_bf16 v[40:43], v[154:157], v[64:67], v[40:43]
    v_max3_f32 v248, v100, v104, v108
    v_mfma_f32_32x32x16_bf16 v[68:83], a[72:75], v[60:63], v[68:83]
    s_add_u32 m0, s90, 98304
    ds_read_b64_tr_b16 v[48:49], v13 offset:43008
    ds_read_b64_tr_b16 v[50:51], v13 offset:43520
    buffer_load_dwordx4 v15, s[20:23], s88 offen offset:0 lds
    v_max3_f32 v249, v101, v105, v109
    v_mfma_f32_32x32x16_bf16 v[84:99], a[200:203], v[60:63], v[84:99]
    ds_read_b128 v[146:149], v132 offset:672
    v_max3_f32 v250, v102, v106, v110
    v_max3_f32 v251, v103, v107, v111
    s_waitcnt lgkmcnt(3)
    v_mfma_f32_16x16x32_bf16 v[40:43], v[142:145], v[44:47], v[40:43]
    v_max3_f32 v248, v248, v112, v128
    v_mfma_f32_32x32x16_bf16 v[68:83], a[76:79], v[64:67], v[68:83]
    ds_read_b64_tr_b16 v[52:53], v14 offset:40960
    ds_read_b64_tr_b16 v[54:55], v14 offset:41472
    buffer_load_dwordx4 v16, s[20:23], s88 offen offset:1024 lds
    v_max3_f32 v249, v249, v113, v129
    v_mfma_f32_32x32x16_bf16 v[84:99], a[204:207], v[64:67], v[84:99]
    ds_read_b128 v[150:153], v133 offset:640
    v_max3_f32 v250, v250, v114, v130
    v_max3_f32 v251, v251, v115, v131
    v_mfma_f32_32x32x16_bf16 v[100:115], v[186:189], v[170:173], v[198:213]
    v_mfma_f32_32x32x16_bf16 v[116:131], v[178:181], v[170:173], v[202:217]
    s_waitcnt lgkmcnt(3)
    v_mfma_f32_16x16x32_bf16 v[40:43], v[146:149], v[48:51], v[40:43]
    v_mfma_f32_32x32x16_bf16 v[68:83], a[80:83], v[44:47], v[68:83]
    ds_read_b64_tr_b16 v[56:57], v14 offset:43008
    ds_read_b64_tr_b16 v[58:59], v14 offset:43520
    buffer_load_dwordx4 v17, s[20:23], s88 offen offset:2048 lds
    v_mfma_f32_32x32x16_bf16 v[84:99], a[208:211], v[44:47], v[84:99]
    ds_read_b128 v[154:157], v133 offset:672
    s_waitcnt lgkmcnt(3)
    v_mfma_f32_16x16x32_bf16 v[40:43], v[150:153], v[52:55], v[40:43]
    s_nop 0
    v_max3_f32 v252, v100, v104, v108
    v_max3_f32 v253, v101, v105, v109
    v_mfma_f32_32x32x16_bf16 v[68:83], a[84:87], v[48:51], v[68:83]
    s_waitcnt vmcnt(11)
    s_barrier
    v_mfma_f32_32x32x16_bf16 v[84:99], a[212:215], v[48:51], v[84:99]
    ds_read_b64_tr_b16 v[60:61], v13 offset:49152
    ds_read_b64_tr_b16 v[62:63], v13 offset:49664
    ds_read_b128 v[142:145], v132 offset:768
    buffer_load_dwordx4 v18, s[20:23], s88 offen offset:3072 lds
    s_add_u32 s88, s88, 32768
    s_cmp_eq_u32 s88, s78
    s_cselect_b32 s88, 0, s88
    s_waitcnt lgkmcnt(3)
    v_mfma_f32_16x16x32_bf16 v[40:43], v[154:157], v[56:59], v[40:43]
    v_max3_f32 v254, v102, v106, v110
    v_max3_f32 v255, v103, v107, v111
    v_mfma_f32_32x32x16_bf16 v[68:83], a[88:91], v[52:55], v[68:83]
    ds_read_b64_tr_b16 v[64:65], v13 offset:51200
    ds_read_b64_tr_b16 v[66:67], v13 offset:51712
    v_max3_f32 v252, v252, v112, v128
    v_max3_f32 v253, v253, v113, v129
    v_max3_f32 v254, v254, v114, v130
    v_max3_f32 v255, v255, v115, v131
    v_mul_f32 v248, v248, v236
    v_mfma_f32_32x32x16_bf16 v[84:99], a[216:219], v[52:55], v[84:99]
    s_add_u32 m0, s90, 0
    ds_read_b128 v[146:149], v132 offset:800
    buffer_load_dwordx4 v15, s[20:23], s88 offen offset:0 lds
    v_mul_f32 v249, v249, v237
    s_waitcnt lgkmcnt(3)
    v_mfma_f32_16x16x32_bf16 v[40:43], v[142:145], v[60:63], v[40:43]
    buffer_load_dword v9, off, s[28:31], 0 sc1
    v_mov_b32 v174, 0
    v_mfma_f32_32x32x16_bf16 v[68:83], a[92:95], v[56:59], v[68:83]
    ds_read_b64_tr_b16 v[44:45], v14 offset:49152
    ds_read_b64_tr_b16 v[46:47], v14 offset:49664
    v_mul_f32 v250, v250, v238
    v_mul_f32 v251, v251, v239
    v_mul_f32 v252, v252, v236
    v_mul_f32 v253, v253, v237
    v_mfma_f32_32x32x16_bf16 v[84:99], a[220:223], v[56:59], v[84:99]
    ds_read_b128 v[150:153], v133 offset:768
    buffer_load_dwordx4 v16, s[20:23], s88 offen offset:1024 lds
    v_mul_f32 v254, v254, v238
    v_mul_f32 v255, v255, v239
    s_waitcnt lgkmcnt(3)
    v_mfma_f32_16x16x32_bf16 v[40:43], v[146:149], v[64:67], v[40:43]
    v_max3_f32 v3, v248, v249, v250
    v_max3_f32 v4, v252, v253, v254
    v_mfma_f32_32x32x16_bf16 v[68:83], a[96:99], v[60:63], v[68:83]
    ds_read_b64_tr_b16 v[48:49], v14 offset:51200
    ds_read_b64_tr_b16 v[50:51], v14 offset:51712
    v_max_f32 v3, v3, v251
    v_max_f32 v4, v4, v255
    s_nop 1
    v_permlane32_swap_b32 v3, v4
    v_max_f32 v4, v3, v4
    v_mov_b32 v3, v4
    v_mfma_f32_32x32x16_bf16 v[84:99], a[224:227], v[60:63], v[84:99]
    ds_read_b128 v[154:157], v133 offset:800
    v_permlane32_swap_b32 v3, v4
    v_sub_f32 v248, v248, v3
    v_sub_f32 v249, v249, v3
    v_sub_f32 v250, v250, v3
    s_waitcnt lgkmcnt(3)
    v_mfma_f32_16x16x32_bf16 v[40:43], v[150:153], v[44:47], v[40:43]
    v_sub_f32 v251, v251, v3
    v_sub_f32 v252, v252, v4
    v_mfma_f32_32x32x16_bf16 v[68:83], a[100:103], v[64:67], v[68:83]
    ds_read_b64_tr_b16 v[52:53], v13 offset:57344
    ds_read_b64_tr_b16 v[54:55], v13 offset:57856
    buffer_load_dwordx4 v17, s[20:23], s88 offen offset:2048 lds
    v_sub_f32 v253, v253, v4
    v_sub_f32 v254, v254, v4
    v_mfma_f32_32x32x16_bf16 v[84:99], a[228:231], v[64:67], v[84:99]
    ds_read_b128 v[142:145], v132 offset:896
    v_sub_f32 v255, v255, v4
    v_exp_f32 v248, v248
    v_exp_f32 v249, v249
    s_waitcnt lgkmcnt(3)
    v_mfma_f32_16x16x32_bf16 v[40:43], v[154:157], v[48:51], v[40:43]
    v_exp_f32 v250, v250
    v_mfma_f32_32x32x16_bf16 v[68:83], a[104:107], v[44:47], v[68:83]
    ds_read_b64_tr_b16 v[56:57], v13 offset:59392
    ds_read_b64_tr_b16 v[58:59], v13 offset:59904
    buffer_load_dwordx4 v18, s[20:23], s88 offen offset:3072 lds
    s_add_u32 s88, s88, 32768
    s_cmp_eq_u32 s88, s78
    s_cselect_b32 s88, 0, s88
    v_mfma_f32_32x32x16_bf16 v[84:99], a[232:235], v[44:47], v[84:99]
    ds_read_b128 v[146:149], v132 offset:928
    v_exp_f32 v251, v251
    v_exp_f32 v252, v252
    s_waitcnt lgkmcnt(3)
    v_mfma_f32_16x16x32_bf16 v[40:43], v[142:145], v[52:55], v[40:43]
    v_exp_f32 v253, v253
    v_mfma_f32_32x32x16_bf16 v[68:83], a[108:111], v[48:51], v[68:83]
    ds_read_b64_tr_b16 v[60:61], v14 offset:57344
    ds_read_b64_tr_b16 v[62:63], v14 offset:57856
    v_exp_f32 v254, v254
    v_exp_f32 v255, v255
    v_mov_b32 v175, 0
    v_mfma_f32_32x32x16_bf16 v[84:99], a[236:239], v[48:51], v[84:99]
    s_add_u32 m0, s90, 16384
    ds_read_b128 v[150:153], v133 offset:896
    buffer_load_dwordx4 v15, s[20:23], s88 offen offset:0 lds
    v_add_f32 v3, v248, v249
    s_waitcnt lgkmcnt(3)
    v_mfma_f32_16x16x32_bf16 v[40:43], v[146:149], v[56:59], v[40:43]
    v_add_f32 v4, v252, v253
    v_add_f32 v3, v3, v250
    v_mfma_f32_32x32x16_bf16 v[68:83], a[112:115], v[52:55], v[68:83]
    ds_read_b64_tr_b16 v[64:65], v14 offset:59392
    ds_read_b64_tr_b16 v[66:67], v14 offset:59904
    v_add_f32 v4, v4, v254
    v_add_f32 v3, v3, v251
    v_add_f32 v4, v4, v255
    v_mul_f32 v248, v248, v236
    v_mul_f32 v249, v249, v237
    v_mfma_f32_32x32x16_bf16 v[84:99], a[240:243], v[52:55], v[84:99]
    ds_read_b128 v[154:157], v133 offset:928
    buffer_load_dwordx4 v16, s[20:23], s88 offen offset:1024 lds
    v_mul_f32 v250, v250, v238
    v_mul_f32 v251, v251, v239
    s_waitcnt lgkmcnt(3)
    v_mfma_f32_16x16x32_bf16 v[40:43], v[150:153], v[60:63], v[40:43]
    v_permlane32_swap_b32 v3, v4
    v_add_f32 v4, v3, v4
    v_mfma_f32_32x32x16_bf16 v[68:83], a[116:119], v[56:59], v[68:83]
    v_mul_f32 v4, v4, v138
    v_rcp_f32 v4, v4
    v_mul_f32 v252, v252, v236
    v_mul_f32 v253, v253, v237
    v_mul_f32 v254, v254, v238
    v_mfma_f32_32x32x16_bf16 v[84:99], a[244:247], v[56:59], v[84:99]
    v_mul_f32 v255, v255, v239
    v_mov_b32 v3, v4
    s_nop 1
    v_permlane32_swap_b32 v3, v4
    v_mul_f32 v248, v248, v3
    v_mul_f32 v249, v249, v3
    v_and_b32 v176, v240, v222
    s_waitcnt lgkmcnt(0)
    v_mfma_f32_16x16x32_bf16 v[40:43], v[154:157], v[64:67], v[40:43]
    v_mul_f32 v250, v250, v3
    v_mul_f32 v251, v251, v3
    v_mul_f32 v252, v252, v4
    v_and_b32 v177, v241, v223
    v_mfma_f32_32x32x16_bf16 v[68:83], a[120:123], v[60:63], v[68:83]
    buffer_load_dwordx4 v17, s[20:23], s88 offen offset:2048 lds
    v_mul_f32 v253, v253, v4
    v_mul_f32 v254, v254, v4
    v_mul_f32 v255, v255, v4
    v_cvt_pk_bf16_f32 v244, v248, v249
    v_and_b32 v178, v240, v224
    v_mfma_f32_32x32x16_bf16 v[84:99], a[248:251], v[60:63], v[84:99]
    v_and_b32 v2, 0xffff0000, v40
    v_sub_f32 v1, v40, v2
    v_cvt_pk_bf16_f32 v36, v2, v1
    v_cvt_pk_bf16_f32 v245, v250, v251
    v_cvt_pk_bf16_f32 v246, v252, v253
    v_cvt_pk_bf16_f32 v247, v254, v255
    v_and_b32 v179, v241, v225
    v_mfma_f32_32x32x16_bf16 v[68:83], a[124:127], v[64:67], v[68:83]
    buffer_load_dwordx4 v18, s[20:23], s88 offen offset:3072 lds
    s_add_u32 s88, s88, 32768
    s_cmp_eq_u32 s88, s78
    s_cselect_b32 s88, 0, s88
    v_cvt_pk_bf16_f32 v234, v40, v41
    v_and_b32 v180, v240, v226
    v_mfma_f32_32x32x16_bf16 v[84:99], a[252:255], v[64:67], v[84:99]
    v_cvt_pk_bf16_f32 v235, v42, v43
    v_mov_b32 v232, 0
    v_mov_b32 v233, 0
    v_and_b32 v181, v241, v227
    v_and_b32 v182, v240, v228
    v_and_b32 v183, v241, v229
    v_and_b32 v184, v240, v230
    v_mfma_f32_32x32x16_bf16 v[68:83], v[28:31], v[36:39], v[68:83]
    v_and_b32 v185, v241, v231
    v_mov_b32 v186, 0
    v_mov_b32 v187, 0
    v_and_b32 v188, v242, v222
    v_and_b32 v189, v243, v223
    v_and_b32 v190, v242, v224
    v_and_b32 v191, v243, v225
    v_mfma_f32_32x32x16_bf16 v[84:99], v[32:35], v[36:39], v[84:99]
    v_and_b32 v192, v242, v226
    v_and_b32 v193, v243, v227
    v_and_b32 v194, v242, v228
    v_and_b32 v195, v243, v229
    v_and_b32 v196, v242, v230
    v_and_b32 v197, v243, v231
    v_mfma_f32_32x32x16_bf16 v[100:115], v[232:235], v[174:177], 0
    s_barrier
    v_cvt_pk_bf16_f32 v158, v68, v69
    v_mfma_f32_32x32x16_bf16 v[116:131], v[232:235], v[186:189], 0
    v_cvt_pk_bf16_f32 v159, v70, v71
    v_cvt_pk_bf16_f32 v160, v72, v73
    v_cvt_pk_bf16_f32 v161, v74, v75
    v_cvt_pk_bf16_f32 v162, v76, v77
    v_cvt_pk_bf16_f32 v163, v78, v79
    v_cvt_pk_bf16_f32 v164, v80, v81
    v_cvt_pk_bf16_f32 v165, v82, v83
    v_mfma_f32_32x32x16_bf16 v[100:115], v[158:161], v[178:181], v[100:115]
    v_mov_b32 v198, 0
    v_mov_b32 v199, 0
    v_and_b32 v200, v244, v222
    v_and_b32 v201, v245, v223
    v_and_b32 v202, v244, v224
    v_mfma_f32_32x32x16_bf16 v[100:115], v[162:165], v[182:185], v[100:115]
    v_and_b32 v203, v245, v225
    v_and_b32 v204, v244, v226
    v_and_b32 v205, v245, v227
    v_and_b32 v206, v244, v228
    v_and_b32 v207, v245, v229
    v_mfma_f32_32x32x16_bf16 v[116:131], v[158:161], v[190:193], v[116:131]
    v_and_b32 v208, v244, v230
    v_and_b32 v209, v245, v231
    v_cvt_pk_bf16_f32 v166, v84, v85
    v_cvt_pk_bf16_f32 v167, v86, v87
    v_cvt_pk_bf16_f32 v168, v88, v89
    v_mfma_f32_32x32x16_bf16 v[116:131], v[162:165], v[194:197], v[116:131]
    v_cvt_pk_bf16_f32 v169, v90, v91
    v_cvt_pk_bf16_f32 v170, v92, v93
    v_cvt_pk_bf16_f32 v171, v94, v95
    v_cvt_pk_bf16_f32 v172, v96, v97
    v_cvt_pk_bf16_f32 v173, v98, v99
    v_mfma_f32_32x32x16_bf16 v[68:83], v[162:165], v[198:201], 0
    v_mov_b32 v210, 0
    v_mov_b32 v211, 0
    v_and_b32 v212, v246, v222
    v_and_b32 v213, v247, v223
    v_cvt_pk_bf16_f32 v44, v100, v101
    v_mfma_f32_32x32x16_bf16 v[68:83], v[166:169], v[202:205], v[68:83]
    v_and_b32 v214, v246, v224
    v_and_b32 v215, v247, v225
    v_and_b32 v216, v246, v226
    v_and_b32 v217, v247, v227
    v_cvt_pk_bf16_f32 v45, v102, v103
    v_cvt_pk_bf16_f32 v46, v104, v105
    v_mfma_f32_32x32x16_bf16 v[68:83], v[170:173], v[206:209], v[68:83]
    v_and_b32 v218, v246, v228
    v_and_b32 v219, v247, v229
    v_and_b32 v220, v246, v230
    v_and_b32 v221, v247, v231
    v_cvt_pk_bf16_f32 v47, v106, v107
    v_mfma_f32_32x32x16_bf16 v[84:99], v[162:165], v[210:213], 0
    buffer_store_dwordx4 v[44:47], v8, s[16:19], s75 offen offset:0 sc1
    v_cvt_pk_bf16_f32 v48, v124, v125
    v_cvt_pk_bf16_f32 v49, v126, v127
    v_mfma_f32_32x32x16_bf16 v[84:99], v[166:169], v[214:217], v[84:99]
    v_cvt_pk_bf16_f32 v50, v128, v129
    v_cvt_pk_bf16_f32 v51, v130, v131
    buffer_store_dwordx4 v[48:51], v8, s[16:19], s75 offen offset:2048 sc1
    v_mfma_f32_32x32x16_bf16 v[84:99], v[170:173], v[218:221], v[84:99]
    v_cvt_pk_bf16_f32 v52, v68, v69
    v_cvt_pk_bf16_f32 v53, v70, v71
    v_cvt_pk_bf16_f32 v54, v72, v73
    v_cvt_pk_bf16_f32 v55, v74, v75
    buffer_store_dwordx4 v[52:55], v8, s[16:19], s76 offen offset:0 sc1
    s_nop 6
    v_cvt_pk_bf16_f32 v56, v92, v93
    v_cvt_pk_bf16_f32 v57, v94, v95
    v_cvt_pk_bf16_f32 v58, v96, v97
    v_cvt_pk_bf16_f32 v59, v98, v99
    buffer_store_dwordx4 v[56:59], v8, s[16:19], s76 offen offset:2048 sc1
    s_add_u32 m0, s90, 32768
    s_nop 0
    buffer_load_dwordx4 v15, s[20:23], s88 offen offset:0 lds
    v_mov_b32 v4, 1
    s_lshl_b32 s83, s83, 8
    s_add_u32 s83, s83, 10485760
    s_cmp_eq_u32 s4, 0
    s_cselect_b32 s42, 12582912, 0
    buffer_load_dwordx4 v16, s[20:23], s88 offen offset:1024 lds
    buffer_load_dwordx4 v17, s[20:23], s88 offen offset:2048 lds
    buffer_load_dwordx4 v18, s[20:23], s88 offen offset:3072 lds
    s_add_u32 s88, s88, 32768
    s_cmp_eq_u32 s88, s78
    s_cselect_b32 s88, 0, s88
    s_add_u32 m0, s90, 49152
    s_nop 0
    buffer_load_dwordx4 v15, s[20:23], s88 offen offset:0 lds
    buffer_load_dwordx4 v16, s[20:23], s88 offen offset:1024 lds
    buffer_load_dwordx4 v17, s[20:23], s88 offen offset:2048 lds
    buffer_load_dwordx4 v18, s[20:23], s88 offen offset:3072 lds
    s_add_u32 s88, s88, 32768
    s_cmp_eq_u32 s88, s78
    s_cselect_b32 s88, 0, s88
    s_waitcnt vmcnt(19)
    v_readfirstlane_b32 s3, v9
    s_nop 3
    s_cmp_eq_u32 s3, 0
    s_cbranch_scc1 L_a_rdy_retry
L_a_rdy_ok:
    s_waitcnt vmcnt(8)
    s_barrier
    buffer_store_dword v4, off, s[40:43], s83 sc1
    s_cmp_eq_u32 s4, 0
    s_cbranch_scc1 L_a_w0
    v_and_b32 v1, 15, v0
    s_lshl_b32 s77, s71, 7
    v_lshl_add_u32 v1, v1, 3, s77
    s_lshl_b32 s77, s70, 5
    s_add_u32 s77, s77, s4
    s_lshl_b32 s77, s77, 11
    v_and_b32 v2, 48, v0
    v_lshlrev_b32 v2, 9, v2
    v_add3_u32 v25, v1, v2, s77
    s_mov_b32 s76, 0x8000
    buffer_load_dwordx2 v[112:113], v1, s[36:39], 0 offen
    ds_read_b64_tr_b16 a[24:25], v21 offset:49152
    ds_read_b64_tr_b16 a[26:27], v21 offset:50176
    ds_read_b64_tr_b16 a[152:153], v22 offset:49152
    ds_read_b64_tr_b16 a[154:155], v22 offset:50176
    ds_read_b64_tr_b16 a[28:29], v19 offset:49152
    ds_read_b64_tr_b16 a[30:31], v19 offset:50176
    buffer_load_dwordx2 v[104:105], v25, s[8:11], 0 offen offset:0
    ds_read_b64_tr_b16 a[156:157], v20 offset:49152
    ds_read_b64_tr_b16 a[158:159], v20 offset:50176
    ds_read_b64_tr_b16 a[32:33], v21 offset:0
    ds_read_b64_tr_b16 a[34:35], v21 offset:1024
    ds_read_b64_tr_b16 a[160:161], v22 offset:0
    ds_read_b64_tr_b16 a[162:163], v22 offset:1024
    buffer_load_dwordx2 v[106:107], v25, s[8:11], s76 offen offset:0
    ds_read_b64_tr_b16 a[36:37], v19 offset:0
    ds_read_b64_tr_b16 a[38:39], v19 offset:1024
    ds_read_b64_tr_b16 a[164:165], v20 offset:0
    ds_read_b64_tr_b16 a[166:167], v20 offset:1024
    ds_read_b64_tr_b16 a[40:41], v21 offset:16384
    ds_read_b64_tr_b16 a[42:43], v21 offset:17408
    buffer_load_dwordx2 v[108:109], v25, s[8:11], 0 offen offset:1024
    ds_read_b64_tr_b16 a[168:169], v22 offset:16384
    ds_read_b64_tr_b16 a[170:171], v22 offset:17408
    ds_read_b64_tr_b16 a[44:45], v19 offset:16384
    ds_read_b64_tr_b16 a[46:47], v19 offset:17408
    ds_read_b64_tr_b16 a[172:173], v20 offset:16384
    ds_read_b64_tr_b16 a[174:175], v20 offset:17408
    buffer_load_dwordx2 v[110:111], v25, s[8:11], s76 offen offset:1024
    ds_read_b64_tr_b16 a[48:49], v21 offset:32768
    ds_read_b64_tr_b16 a[50:51], v21 offset:33792
    ds_read_b64_tr_b16 a[176:177], v22 offset:32768
    ds_read_b64_tr_b16 a[178:179], v22 offset:33792
    ds_read_b64_tr_b16 a[52:53], v19 offset:32768
    ds_read_b64_tr_b16 a[54:55], v19 offset:33792
    ds_read_b64_tr_b16 a[180:181], v20 offset:32768
    s_add_u32 m0, s90, 131072
    s_nop 0
    buffer_load_dwordx4 v15, s[20:23], s88 offen offset:0 lds
    ds_read_b64_tr_b16 a[182:183], v20 offset:33792
    v_add_u32 v26, -65536, v21
    v_add_u32 v27, -65536, v22
    v_add_u32 v28, -65536, v19
    v_add_u32 v29, -65536, v20
    ds_read_b64_tr_b16 a[56:57], v26 offset:0
    buffer_load_dwordx4 v16, s[20:23], s88 offen offset:1024 lds
    ds_read_b64_tr_b16 a[58:59], v26 offset:1024
    ds_read_b64_tr_b16 a[184:185], v27 offset:0
    ds_read_b64_tr_b16 a[186:187], v27 offset:1024
    ds_read_b64_tr_b16 a[60:61], v28 offset:0
    ds_read_b64_tr_b16 a[62:63], v28 offset:1024
    ds_read_b64_tr_b16 a[188:189], v29 offset:0
    ds_read_b64_tr_b16 a[190:191], v29 offset:1024
    buffer_load_dwordx4 v17, s[20:23], s88 offen offset:2048 lds
    s_lshr_b32 s91, s70, 1
    s_lshl_b32 s91, s91, 12
    s_add_u32 s91, s91, 10485760
    v_lshlrev_b32 v3, 8, v0
    s_mov_b32 s93, 0
    s_cmp_eq_u32 s4, 2
    s_cselect_b32 s92, 0x3c, 7
    buffer_load_dwordx4 v18, s[20:23], s88 offen offset:3072 lds
    s_add_u32 s88, s88, 32768
    s_cmp_eq_u32 s88, s78
    s_cselect_b32 s88, 0, s88
    s_cmp_eq_u32 s4, 3
    s_cselect_b32 s92, 0xe0, s92
    ds_read_b64_tr_b16 a[64:65], v26 offset:16384
    ds_read_b64_tr_b16 a[66:67], v26 offset:17408
    ds_read_b64_tr_b16 a[68:69], v27 offset:16384
    ds_read_b64_tr_b16 a[70:71], v27 offset:17408
    s_add_u32 m0, s90, 147456
    s_nop 0
    buffer_load_dwordx4 v15, s[20:23], s88 offen offset:0 lds
    ds_read_b64_tr_b16 a[72:73], v28 offset:16384
    ds_read_b64_tr_b16 a[74:75], v28 offset:17408
    ds_read_b64_tr_b16 a[76:77], v29 offset:16384
    ds_read_b64_tr_b16 a[78:79], v29 offset:17408
    s_waitcnt vmcnt(15)
    ds_read_b64_tr_b16 a[80:81], v26 offset:32768
    ds_read_b64_tr_b16 a[82:83], v26 offset:33792
    buffer_load_dwordx4 v16, s[20:23], s88 offen offset:1024 lds
    ds_read_b64_tr_b16 a[84:85], v27 offset:32768
    ds_read_b64_tr_b16 a[86:87], v27 offset:33792
    ds_read_b64_tr_b16 a[88:89], v28 offset:32768
    ds_read_b64_tr_b16 a[90:91], v28 offset:33792
    ds_read_b64_tr_b16 a[92:93], v29 offset:32768
    ds_read_b64_tr_b16 a[94:95], v29 offset:33792
    s_waitcnt vmcnt(12)
    buffer_load_dwordx4 v17, s[20:23], s88 offen offset:2048 lds
    ds_read_b64_tr_b16 a[96:97], v26 offset:49152
    ds_read_b64_tr_b16 a[98:99], v26 offset:50176
    ds_read_b64_tr_b16 a[100:101], v27 offset:49152
    ds_read_b64_tr_b16 a[102:103], v27 offset:50176
    ds_read_b64_tr_b16 a[104:105], v28 offset:49152
    ds_read_b64_tr_b16 a[106:107], v28 offset:50176
    ds_read_b64_tr_b16 a[108:109], v29 offset:49152
    buffer_load_dwordx4 v18, s[20:23], s88 offen offset:3072 lds
    s_add_u32 s88, s88, 32768
    s_cmp_eq_u32 s88, s78
    s_cselect_b32 s88, 0, s88
    ds_read_b64_tr_b16 a[110:111], v29 offset:50176
    v_and_b32 v23, 15, v0
    v_lshlrev_b32 v23, 4, v23
    v_and_b32 v24, 16, v0
    v_lshl_add_u32 v23, v24, 5, v23
    v_and_b32 v24, 32, v0
    v_lshl_add_u32 v34, v24, 6, v23
    s_waitcnt lgkmcnt(15)
    s_add_u32 m0, s90, 114688
    s_nop 0
    buffer_load_dwordx4 v15, s[20:23], s88 offen offset:0 lds
    v_bfe_u32 v24, v0, 2, 1
    v_xor_b32 v24, v24, v0
    v_and_b32 v24, 3, v24
    v_and_b32 v23, 12, v0
    v_lshlrev_b32 v23, 8, v23
    v_lshl_add_u32 v23, v24, 4, v23
    v_and_b32 v24, 48, v0
    buffer_load_dwordx4 v16, s[20:23], s88 offen offset:1024 lds
    v_lshl_add_u32 v23, v24, 2, v23
    v_lshl_add_u32 v23, s4, 8, v23
    v_mov_b32 v36, 0xbfb8aa3b
    v_mov_b32 v38, 1.0
    s_add_u32 s52, s89, 4096
    s_cmp_eq_u32 s52, s79
    s_cselect_b32 s52, 0, s52
    buffer_load_dwordx4 v17, s[20:23], s88 offen offset:2048 lds
    s_add_u32 s53, s52, 4096
    s_cmp_eq_u32 s53, s79
    s_cselect_b32 s53, 0, s53
    s_add_u32 s54, s53, 4096
    s_cmp_eq_u32 s54, s79
    s_cselect_b32 s54, 0, s54
    s_add_u32 s55, s54, 4096
    s_cmp_eq_u32 s55, s79
    s_cselect_b32 s55, 0, s55
    buffer_load_dwordx4 v18, s[20:23], s88 offen offset:3072 lds
    s_add_u32 s88, s88, 32768
    s_cmp_eq_u32 s88, s78
    s_cselect_b32 s88, 0, s88
    s_add_u32 s56, s55, 4096
    s_cmp_eq_u32 s56, s79
    s_cselect_b32 s56, 0, s56
    s_add_u32 s57, s56, 4096
    s_cmp_eq_u32 s57, s79
    s_cselect_b32 s57, 0, s57
    s_add_u32 s58, s57, 4096
    s_cmp_eq_u32 s58, s79
    s_cselect_b32 s58, 0, s58
    s_add_u32 m0, s90, 65536
    s_nop 0
    buffer_load_dwordx4 v15, s[20:23], s88 offen offset:0 lds
    s_add_u32 s59, s58, 4096
    s_cmp_eq_u32 s59, s79
    s_cselect_b32 s59, 0, s59
    s_add_u32 s60, s59, 4096
    s_cmp_eq_u32 s60, s79
    s_cselect_b32 s60, 0, s60
    s_add_u32 s61, s60, 4096
    s_cmp_eq_u32 s61, s79
    s_cselect_b32 s61, 0, s61
    buffer_load_dwordx4 v16, s[20:23], s88 offen offset:1024 lds
    v_add_u32 v30, 65536, v21
    v_add_u32 v31, 65536, v22
    v_add_u32 v32, 65536, v19
    v_add_u32 v33, 65536, v20
    s_waitcnt vmcnt(10)
    ds_read_b64_tr_b16 a[112:113], v30 offset:0
    ds_read_b64_tr_b16 a[114:115], v30 offset:1024
    buffer_load_dwordx4 v17, s[20:23], s88 offen offset:2048 lds
    ds_read_b64_tr_b16 a[116:117], v31 offset:0
    ds_read_b64_tr_b16 a[118:119], v31 offset:1024
    ds_read_b64_tr_b16 a[120:121], v32 offset:0
    ds_read_b64_tr_b16 a[122:123], v32 offset:1024
    ds_read_b64_tr_b16 a[124:125], v33 offset:0
    ds_read_b64_tr_b16 a[126:127], v33 offset:1024
    s_add_u32 s62, s61, 4096
    s_cmp_eq_u32 s62, s79
    s_cselect_b32 s62, 0, s62
    buffer_load_dwordx4 v18, s[20:23], s88 offen offset:3072 lds
    s_add_u32 s88, s88, 32768
    s_cmp_eq_u32 s88, s78
    s_cselect_b32 s88, 0, s88
    s_add_u32 s63, s62, 4096
    s_cmp_eq_u32 s63, s79
    s_cselect_b32 s63, 0, s63
    s_add_u32 s64, s63, 4096
    s_cmp_eq_u32 s64, s79
    s_cselect_b32 s64, 0, s64
    s_add_u32 s65, s64, 4096
    s_cmp_eq_u32 s65, s79
    s_cselect_b32 s65, 0, s65
    s_add_u32 m0, s90, 81920
    s_nop 0
    buffer_load_dwordx4 v15, s[20:23], s88 offen offset:0 lds
    s_add_u32 s66, s65, 4096
    s_cmp_eq_u32 s66, s79
    s_cselect_b32 s66, 0, s66
    s_add_u32 s67, s66, 4096
    s_cmp_eq_u32 s67, s79
    s_cselect_b32 s67, 0, s67
    s_add_u32 s73, s67, 4096
    s_cmp_eq_u32 s73, s79
    s_cselect_b32 s73, 0, s73
    buffer_load_dwordx4 v16, s[20:23], s88 offen offset:1024 lds
    s_waitcnt vmcnt(10)
    ds_read_b64_tr_b16 a[192:193], v30 offset:16384
    ds_read_b64_tr_b16 a[194:195], v30 offset:17408
    ds_read_b64_tr_b16 a[196:197], v31 offset:16384
    ds_read_b64_tr_b16 a[198:199], v31 offset:17408
    ds_read_b64_tr_b16 a[200:201], v32 offset:16384
    ds_read_b64_tr_b16 a[202:203], v32 offset:17408
    buffer_load_dwordx4 v17, s[20:23], s88 offen offset:2048 lds
    ds_read_b64_tr_b16 a[204:205], v33 offset:16384
    ds_read_b64_tr_b16 a[206:207], v33 offset:17408
    s_add_u32 s75, s73, 4096
    s_cmp_eq_u32 s75, s79
    s_cselect_b32 s75, 0, s75
    buffer_load_dwordx4 v18, s[20:23], s88 offen offset:3072 lds
    s_add_u32 s88, s88, 32768
    s_cmp_eq_u32 s88, s78
    s_cselect_b32 s88, 0, s88
    s_add_u32 m0, s90, 98304
    s_nop 0
    buffer_load_dwordx4 v15, s[20:23], s88 offen offset:0 lds
    buffer_load_dwordx4 v16, s[20:23], s88 offen offset:1024 lds
    s_waitcnt vmcnt(10)
    ds_read_b64_tr_b16 a[208:209], v21 offset:49152
    ds_read_b64_tr_b16 a[210:211], v21 offset:50176
    ds_read_b64_tr_b16 a[212:213], v22 offset:49152
    ds_read_b64_tr_b16 a[214:215], v22 offset:50176
    ds_read_b64_tr_b16 a[216:217], v19 offset:49152
    ds_read_b64_tr_b16 a[218:219], v19 offset:50176
    buffer_load_dwordx4 v17, s[20:23], s88 offen offset:2048 lds
    ds_read_b64_tr_b16 a[220:221], v20 offset:49152
    ds_read_b64_tr_b16 a[222:223], v20 offset:50176
    buffer_load_dwordx4 v18, s[20:23], s88 offen offset:3072 lds
    s_add_u32 s88, s88, 32768
    s_cmp_eq_u32 s88, s78
    s_cselect_b32 s88, 0, s88
    s_add_u32 m0, s90, 0
    s_nop 0
    buffer_load_dwordx4 v15, s[20:23], s88 offen offset:0 lds
    buffer_load_dwordx4 v16, s[20:23], s88 offen offset:1024 lds
    s_waitcnt vmcnt(10)
    ds_read_b64_tr_b16 a[224:225], v21 offset:0
    ds_read_b64_tr_b16 a[226:227], v21 offset:1024
    ds_read_b64_tr_b16 a[228:229], v22 offset:0
    ds_read_b64_tr_b16 a[230:231], v22 offset:1024
    ds_read_b64_tr_b16 a[232:233], v19 offset:0
    ds_read_b64_tr_b16 a[234:235], v19 offset:1024
    s_mov_b64 exec, s[92:93]
    buffer_load_dword v4, v3, s[16:19], s91 offen sc1
    s_mov_b64 exec, -1
    ds_read_b64_tr_b16 a[236:237], v20 offset:0
    ds_read_b64_tr_b16 a[238:239], v20 offset:1024
    buffer_load_dwordx4 v17, s[20:23], s88 offen offset:2048 lds
    buffer_load_dwordx4 v18, s[20:23], s88 offen offset:3072 lds
    s_add_u32 s88, s88, 32768
    s_cmp_eq_u32 s88, s78
    s_cselect_b32 s88, 0, s88
    s_add_u32 m0, s90, 16384
    s_nop 0
    buffer_load_dwordx4 v15, s[20:23], s88 offen offset:0 lds
    s_waitcnt vmcnt(10)
    ds_read_b64_tr_b16 a[240:241], v21 offset:16384
    ds_read_b64_tr_b16 a[242:243], v21 offset:17408
    ds_read_b64_tr_b16 a[244:245], v22 offset:16384
    ds_read_b64_tr_b16 a[246:247], v22 offset:17408
    ds_read_b64_tr_b16 a[248:249], v19 offset:16384
    ds_read_b64_tr_b16 a[250:251], v19 offset:17408
    buffer_load_dwordx4 v16, s[20:23], s88 offen offset:1024 lds
    ds_read_b64_tr_b16 a[252:253], v20 offset:16384
    ds_read_b64_tr_b16 a[254:255], v20 offset:17408
    buffer_load_dwordx4 v17, s[20:23], s88 offen offset:2048 lds
    buffer_load_dwordx4 v18, s[20:23], s88 offen offset:3072 lds
    s_add_u32 s88, s88, 32768
    s_cmp_eq_u32 s88, s78
    s_cselect_b32 s88, 0, s88
    s_waitcnt vmcnt(9)
    ds_read_b64_tr_b16 v[208:209], v21 offset:32768
    ds_read_b64_tr_b16 v[210:211], v21 offset:33792
    ds_read_b64_tr_b16 v[212:213], v22 offset:32768
    ds_read_b64_tr_b16 v[214:215], v22 offset:33792
    ds_read_b64_tr_b16 v[216:217], v19 offset:32768
    ds_read_b64_tr_b16 v[218:219], v19 offset:33792
    ds_read_b64_tr_b16 v[220:221], v20 offset:32768
    ds_read_b64_tr_b16 v[222:223], v20 offset:33792
    s_waitcnt vmcnt(6)
    v_cmp_ne_u32 vcc, 1, v4
    s_nop 4
    s_cbranch_vccnz L_a0_go_retry
L_a0_go_ok:
    buffer_load_dwordx4 v[140:143], v34, s[84:87], s89 offen offset:0 sc1
    buffer_load_dwordx4 v[144:147], v34, s[84:87], s52 offen offset:0 sc1
    buffer_load_dwordx4 v[148:151], v34, s[84:87], s53 offen offset:0 sc1
    buffer_load_dwordx4 v[152:155], v34, s[84:87], s54 offen offset:0 sc1
    buffer_load_dwordx4 v[156:159], v34, s[84:87], s55 offen offset:0 sc1
    buffer_load_dwordx4 v[160:163], v34, s[84:87], s56 offen offset:0 sc1
    buffer_load_dwordx4 v[164:167], v34, s[84:87], s57 offen offset:0 sc1
    buffer_load_dwordx4 v[168:171], v34, s[84:87], s58 offen offset:0 sc1
    buffer_load_dwordx4 v[172:175], v34, s[84:87], s59 offen offset:0 sc1
    buffer_load_dwordx4 v[176:179], v34, s[84:87], s60 offen offset:0 sc1
    buffer_load_dwordx4 v[180:183], v34, s[84:87], s61 offen offset:0 sc1
    buffer_load_dwordx4 v[184:187], v34, s[84:87], s62 offen offset:0 sc1
    s_mov_b32 m0, s90
    v_lshlrev_b32 v124, 16, v104
    v_and_b32 v125, 0xffff0000, v104
    v_lshlrev_b32 v126, 16, v105
    v_and_b32 v127, 0xffff0000, v105
    v_lshlrev_b32 v128, 16, v106
    v_and_b32 v129, 0xffff0000, v106
    v_lshlrev_b32 v130, 16, v107
    v_and_b32 v131, 0xffff0000, v107
    v_lshlrev_b32 v132, 16, v108
    v_and_b32 v133, 0xffff0000, v108
    v_lshlrev_b32 v134, 16, v109
    v_and_b32 v135, 0xffff0000, v109
    v_lshlrev_b32 v136, 16, v110
    v_and_b32 v137, 0xffff0000, v110
    v_lshlrev_b32 v138, 16, v111
    v_and_b32 v139, 0xffff0000, v111
    v_lshlrev_b32 v116, 16, v112
    v_and_b32 v117, 0xffff0000, v112
    v_lshlrev_b32 v118, 16, v113
    v_and_b32 v119, 0xffff0000, v113
    s_waitcnt vmcnt(11)
    v_mfma_f32_16x16x32_bf16 v[40:43], v[140:143], a[0:3], 0
    buffer_load_dwordx4 v[188:191], v34, s[84:87], s63 offen offset:0 sc1
    v_mfma_f32_16x16x32_bf16 v[44:47], v[140:143], a[128:131], 0
    ds_read_b64_tr_b16 v[224:225], v26 offset:0
    ds_read_b64_tr_b16 v[226:227], v26 offset:1024
    v_mfma_f32_16x16x32_bf16 v[48:51], v[140:143], a[4:7], 0
    ds_read_b64_tr_b16 v[228:229], v27 offset:0
    v_mfma_f32_16x16x32_bf16 v[52:55], v[140:143], a[132:135], 0
    ds_read_b64_tr_b16 v[230:231], v27 offset:1024
    s_waitcnt vmcnt(11)
    v_mfma_f32_16x16x32_bf16 v[40:43], v[144:147], a[8:11], v[40:43]
    buffer_load_dwordx4 v[192:195], v34, s[84:87], s64 offen offset:0 sc1
    v_mfma_f32_16x16x32_bf16 v[44:47], v[144:147], a[136:139], v[44:47]
    ds_read_b64_tr_b16 v[232:233], v28 offset:0
    ds_read_b64_tr_b16 v[234:235], v28 offset:1024
    v_mfma_f32_16x16x32_bf16 v[48:51], v[144:147], a[12:15], v[48:51]
    ds_read_b64_tr_b16 v[236:237], v29 offset:0
    v_mfma_f32_16x16x32_bf16 v[52:55], v[144:147], a[140:143], v[52:55]
    ds_read_b64_tr_b16 v[238:239], v29 offset:1024
    s_waitcnt vmcnt(11)
    v_mfma_f32_16x16x32_bf16 v[40:43], v[148:151], a[16:19], v[40:43]
    buffer_load_dwordx4 v[140:143], v34, s[84:87], s65 offen offset:0 sc1
    v_mfma_f32_16x16x32_bf16 v[44:47], v[148:151], a[144:147], v[44:47]
    ds_read_b64_tr_b16 v[240:241], v26 offset:16384
    ds_read_b64_tr_b16 v[242:243], v26 offset:17408
    v_mfma_f32_16x16x32_bf16 v[48:51], v[148:151], a[20:23], v[48:51]
    ds_read_b64_tr_b16 v[244:245], v27 offset:16384
    v_mfma_f32_16x16x32_bf16 v[52:55], v[148:151], a[148:151], v[52:55]
    ds_read_b64_tr_b16 v[246:247], v27 offset:17408
    s_waitcnt vmcnt(11)
    v_mfma_f32_16x16x32_bf16 v[40:43], v[152:155], a[24:27], v[40:43]
    buffer_load_dwordx4 v[144:147], v34, s[84:87], s66 offen offset:0 sc1
    v_mfma_f32_16x16x32_bf16 v[44:47], v[152:155], a[152:155], v[44:47]
    ds_read_b64_tr_b16 v[248:249], v28 offset:16384
    ds_read_b64_tr_b16 v[250:251], v28 offset:17408
    v_mfma_f32_16x16x32_bf16 v[48:51], v[152:155], a[28:31], v[48:51]
    ds_read_b64_tr_b16 v[252:253], v29 offset:16384
    v_mfma_f32_16x16x32_bf16 v[52:55], v[152:155], a[156:159], v[52:55]
    ds_read_b64_tr_b16 v[254:255], v29 offset:17408
    s_waitcnt vmcnt(11)
    v_mfma_f32_16x16x32_bf16 v[40:43], v[156:159], a[32:35], v[40:43]
    buffer_load_dwordx4 v[148:151], v34, s[84:87], s67 offen offset:0 sc1
    v_mfma_f32_16x16x32_bf16 v[44:47], v[156:159], a[160:163], v[44:47]
    v_mfma_f32_16x16x32_bf16 v[48:51], v[156:159], a[36:39], v[48:51]
    v_mfma_f32_16x16x32_bf16 v[52:55], v[156:159], a[164:167], v[52:55]
    s_waitcnt vmcnt(11)
    v_mfma_f32_16x16x32_bf16 v[40:43], v[160:163], a[40:43], v[40:43]
    buffer_load_dwordx4 v[152:155], v34, s[84:87], s73 offen offset:0 sc1
    v_mfma_f32_16x16x32_bf16 v[44:47], v[160:163], a[168:171], v[44:47]
    v_mfma_f32_16x16x32_bf16 v[48:51], v[160:163], a[44:47], v[48:51]
    v_mfma_f32_16x16x32_bf16 v[52:55], v[160:163], a[172:175], v[52:55]
    s_waitcnt vmcnt(11)
    v_mfma_f32_16x16x32_bf16 v[40:43], v[164:167], a[48:51], v[40:43]
    buffer_load_dwordx4 v[156:159], v34, s[84:87], s75 offen offset:0 sc1
    v_mfma_f32_16x16x32_bf16 v[44:47], v[164:167], a[176:179], v[44:47]
    v_mfma_f32_16x16x32_bf16 v[48:51], v[164:167], a[52:55], v[48:51]
    v_mfma_f32_16x16x32_bf16 v[52:55], v[164:167], a[180:183], v[52:55]
    s_waitcnt vmcnt(11)
    v_mfma_f32_16x16x32_bf16 v[40:43], v[168:171], a[56:59], v[40:43]
    buffer_load_dwordx4 v[160:163], v34, s[84:87], s89 offen offset:256 sc1
    v_mfma_f32_16x16x32_bf16 v[44:47], v[168:171], a[184:187], v[44:47]
    v_mfma_f32_16x16x32_bf16 v[48:51], v[168:171], a[60:63], v[48:51]
    v_mfma_f32_16x16x32_bf16 v[52:55], v[168:171], a[188:191], v[52:55]
    s_waitcnt vmcnt(11)
    v_mfma_f32_16x16x32_bf16 v[40:43], v[172:175], a[64:67], v[40:43]
    buffer_load_dwordx4 v[164:167], v34, s[84:87], s52 offen offset:256 sc1
    v_mfma_f32_16x16x32_bf16 v[44:47], v[172:175], a[68:71], v[44:47]
    v_mfma_f32_16x16x32_bf16 v[48:51], v[172:175], a[72:75], v[48:51]
    v_mfma_f32_16x16x32_bf16 v[52:55], v[172:175], a[76:79], v[52:55]
    s_waitcnt vmcnt(11) lgkmcnt(15)
    v_mfma_f32_16x16x32_bf16 v[40:43], v[176:179], a[80:83], v[40:43]
    buffer_load_dwordx4 v[168:171], v34, s[84:87], s53 offen offset:256 sc1
    v_mfma_f32_16x16x32_bf16 v[44:47], v[176:179], a[84:87], v[44:47]
    v_mfma_f32_16x16x32_bf16 v[48:51], v[176:179], a[88:91], v[48:51]
    v_mfma_f32_16x16x32_bf16 v[52:55], v[176:179], a[92:95], v[52:55]
    s_waitcnt vmcnt(11)
    v_mfma_f32_16x16x32_bf16 v[40:43], v[180:183], a[96:99], v[40:43]
    buffer_load_dwordx4 v[172:175], v34, s[84:87], s54 offen offset:256 sc1
    v_mfma_f32_16x16x32_bf16 v[44:47], v[180:183], a[100:103], v[44:47]
    v_mfma_f32_16x16x32_bf16 v[48:51], v[180:183], a[104:107], v[48:51]
    v_mfma_f32_16x16x32_bf16 v[52:55], v[180:183], a[108:111], v[52:55]
    s_waitcnt vmcnt(11)
    v_mfma_f32_16x16x32_bf16 v[40:43], v[184:187], a[112:115], v[40:43]
    buffer_load_dwordx4 v[176:179], v34, s[84:87], s55 offen offset:256 sc1
    v_mfma_f32_16x16x32_bf16 v[44:47], v[184:187], a[116:119], v[44:47]
    v_mfma_f32_16x16x32_bf16 v[48:51], v[184:187], a[120:123], v[48:51]
    v_mfma_f32_16x16x32_bf16 v[52:55], v[184:187], a[124:127], v[52:55]
    s_waitcnt vmcnt(11)
    v_mfma_f32_16x16x32_bf16 v[40:43], v[188:191], a[192:195], v[40:43]
    buffer_load_dwordx4 v[180:183], v34, s[84:87], s56 offen offset:256 sc1
    v_mfma_f32_16x16x32_bf16 v[44:47], v[188:191], a[196:199], v[44:47]
    v_mfma_f32_16x16x32_bf16 v[48:51], v[188:191], a[200:203], v[48:51]
    v_mfma_f32_16x16x32_bf16 v[52:55], v[188:191], a[204:207], v[52:55]
    s_waitcnt vmcnt(11)
    v_mfma_f32_16x16x32_bf16 v[40:43], v[192:195], a[208:211], v[40:43]
    buffer_load_dwordx4 v[184:187], v34, s[84:87], s57 offen offset:256 sc1
    v_mfma_f32_16x16x32_bf16 v[44:47], v[192:195], a[212:215], v[44:47]
    v_mfma_f32_16x16x32_bf16 v[48:51], v[192:195], a[216:219], v[48:51]
    v_mfma_f32_16x16x32_bf16 v[52:55], v[192:195], a[220:223], v[52:55]
    s_waitcnt vmcnt(11)
    v_mfma_f32_16x16x32_bf16 v[40:43], v[140:143], a[224:227], v[40:43]
    buffer_load_dwordx4 v[188:191], v34, s[84:87], s58 offen offset:256 sc1
    v_mfma_f32_16x16x32_bf16 v[44:47], v[140:143], a[228:231], v[44:47]
    v_mfma_f32_16x16x32_bf16 v[48:51], v[140:143], a[232:235], v[48:51]
    v_mfma_f32_16x16x32_bf16 v[52:55], v[140:143], a[236:239], v[52:55]
    s_waitcnt vmcnt(11)
    v_mfma_f32_16x16x32_bf16 v[40:43], v[144:147], a[240:243], v[40:43]
    buffer_load_dwordx4 v[192:195], v34, s[84:87], s59 offen offset:256 sc1
    v_mfma_f32_16x16x32_bf16 v[44:47], v[144:147], a[244:247], v[44:47]
    v_mfma_f32_16x16x32_bf16 v[48:51], v[144:147], a[248:251], v[48:51]
    v_mfma_f32_16x16x32_bf16 v[52:55], v[144:147], a[252:255], v[52:55]
    s_waitcnt vmcnt(11)
    v_mfma_f32_16x16x32_bf16 v[40:43], v[148:151], v[208:211], v[40:43]
    buffer_load_dwordx4 v[140:143], v34, s[84:87], s60 offen offset:256 sc1
    v_mfma_f32_16x16x32_bf16 v[44:47], v[148:151], v[212:215], v[44:47]
    v_mfma_f32_16x16x32_bf16 v[48:51], v[148:151], v[216:219], v[48:51]
    v_mfma_f32_16x16x32_bf16 v[52:55], v[148:151], v[220:223], v[52:55]
    s_waitcnt vmcnt(11) lgkmcnt(14)
    v_mfma_f32_16x16x32_bf16 v[40:43], v[152:155], v[224:227], v[40:43]
    buffer_load_dwordx4 v[144:147], v34, s[84:87], s61 offen offset:256 sc1
    s_waitcnt lgkmcnt(12)
    v_mfma_f32_16x16x32_bf16 v[44:47], v[152:155], v[228:231], v[44:47]
    s_waitcnt lgkmcnt(10)
    v_mfma_f32_16x16x32_bf16 v[48:51], v[152:155], v[232:235], v[48:51]
    s_waitcnt lgkmcnt(8)
    v_mfma_f32_16x16x32_bf16 v[52:55], v[152:155], v[236:239], v[52:55]
    s_waitcnt vmcnt(11) lgkmcnt(6)
    v_mfma_f32_16x16x32_bf16 v[40:43], v[156:159], v[240:243], v[40:43]
    buffer_load_dwordx4 v[148:151], v34, s[84:87], s62 offen offset:256 sc1
    s_waitcnt lgkmcnt(4)
    v_mfma_f32_16x16x32_bf16 v[44:47], v[156:159], v[244:247], v[44:47]
    s_waitcnt lgkmcnt(2)
    v_mfma_f32_16x16x32_bf16 v[48:51], v[156:159], v[248:251], v[48:51]
    s_waitcnt lgkmcnt(0)
    v_mfma_f32_16x16x32_bf16 v[52:55], v[156:159], v[252:255], v[52:55]
    s_waitcnt vmcnt(11)
    v_mfma_f32_16x16x32_bf16 v[56:59], v[160:163], a[0:3], 0
    buffer_load_dwordx4 v[152:155], v34, s[84:87], s63 offen offset:256 sc1
    v_mfma_f32_16x16x32_bf16 v[60:63], v[160:163], a[128:131], 0
    v_mfma_f32_16x16x32_bf16 v[64:67], v[160:163], a[4:7], 0
    ds_write_addtid_b32 v40 offset:0
    v_mfma_f32_16x16x32_bf16 v[68:71], v[160:163], a[132:135], 0
    ds_write_addtid_b32 v41 offset:256
    s_waitcnt vmcnt(11)
    v_mfma_f32_16x16x32_bf16 v[56:59], v[164:167], a[8:11], v[56:59]
    buffer_load_dwordx4 v[156:159], v34, s[84:87], s64 offen offset:256 sc1
    v_mfma_f32_16x16x32_bf16 v[60:63], v[164:167], a[136:139], v[60:63]
    ds_write_addtid_b32 v42 offset:512
    v_mfma_f32_16x16x32_bf16 v[64:67], v[164:167], a[12:15], v[64:67]
    ds_write_addtid_b32 v43 offset:768
    v_mfma_f32_16x16x32_bf16 v[68:71], v[164:167], a[140:143], v[68:71]
    s_waitcnt vmcnt(11)
    v_mfma_f32_16x16x32_bf16 v[56:59], v[168:171], a[16:19], v[56:59]
    buffer_load_dwordx4 v[160:163], v34, s[84:87], s65 offen offset:256 sc1
    v_mfma_f32_16x16x32_bf16 v[60:63], v[168:171], a[144:147], v[60:63]
    ds_write_addtid_b32 v44 offset:1024
    v_mfma_f32_16x16x32_bf16 v[64:67], v[168:171], a[20:23], v[64:67]
    ds_write_addtid_b32 v45 offset:1280
    v_mfma_f32_16x16x32_bf16 v[68:71], v[168:171], a[148:151], v[68:71]
    ds_write_addtid_b32 v46 offset:1536
    s_waitcnt vmcnt(11)
    v_mfma_f32_16x16x32_bf16 v[56:59], v[172:175], a[24:27], v[56:59]
    buffer_load_dwordx4 v[164:167], v34, s[84:87], s66 offen offset:256 sc1
    v_mfma_f32_16x16x32_bf16 v[60:63], v[172:175], a[152:155], v[60:63]
    ds_write_addtid_b32 v47 offset:1792
    v_mfma_f32_16x16x32_bf16 v[64:67], v[172:175], a[28:31], v[64:67]
    ds_write_addtid_b32 v48 offset:2048
    v_mfma_f32_16x16x32_bf16 v[68:71], v[172:175], a[156:159], v[68:71]
    ds_write_addtid_b32 v49 offset:2304
    s_waitcnt vmcnt(11)
    v_mfma_f32_16x16x32_bf16 v[56:59], v[176:179], a[32:35], v[56:59]
    buffer_load_dwordx4 v[168:171], v34, s[84:87], s67 offen offset:256 sc1
    v_mfma_f32_16x16x32_bf16 v[60:63], v[176:179], a[160:163], v[60:63]
    ds_write_addtid_b32 v50 offset:2560
    v_mfma_f32_16x16x32_bf16 v[64:67], v[176:179], a[36:39], v[64:67]
    ds_write_addtid_b32 v51 offset:2816
    v_mfma_f32_16x16x32_bf16 v[68:71], v[176:179], a[164:167], v[68:71]
    s_waitcnt vmcnt(11)
    v_mfma_f32_16x16x32_bf16 v[56:59], v[180:183], a[40:43], v[56:59]
    buffer_load_dwordx4 v[172:175], v34, s[84:87], s73 offen offset:256 sc1
    v_mfma_f32_16x16x32_bf16 v[60:63], v[180:183], a[168:171], v[60:63]
    ds_write_addtid_b32 v52 offset:3072
    v_mfma_f32_16x16x32_bf16 v[64:67], v[180:183], a[44:47], v[64:67]
    ds_write_addtid_b32 v53 offset:3328
    v_mfma_f32_16x16x32_bf16 v[68:71], v[180:183], a[172:175], v[68:71]
    ds_write_addtid_b32 v54 offset:3584
    s_waitcnt vmcnt(11)
    v_mfma_f32_16x16x32_bf16 v[56:59], v[184:187], a[48:51], v[56:59]
    buffer_load_dwordx4 v[176:179], v34, s[84:87], s75 offen offset:256 sc1
    v_mfma_f32_16x16x32_bf16 v[60:63], v[184:187], a[176:179], v[60:63]
    ds_write_addtid_b32 v55 offset:3840
    v_mfma_f32_16x16x32_bf16 v[64:67], v[184:187], a[52:55], v[64:67]
    v_mfma_f32_16x16x32_bf16 v[68:71], v[184:187], a[180:183], v[68:71]
    s_waitcnt vmcnt(11)
    v_mfma_f32_16x16x32_bf16 v[56:59], v[188:191], a[56:59], v[56:59]
    buffer_load_dwordx4 v[180:183], v34, s[84:87], s89 offen offset:1024 sc1
    v_mfma_f32_16x16x32_bf16 v[60:63], v[188:191], a[184:187], v[60:63]
    v_mfma_f32_16x16x32_bf16 v[64:67], v[188:191], a[60:63], v[64:67]
    v_mfma_f32_16x16x32_bf16 v[68:71], v[188:191], a[188:191], v[68:71]
    s_waitcnt lgkmcnt(0)
    s_barrier
    s_waitcnt vmcnt(11)
    v_mfma_f32_16x16x32_bf16 v[56:59], v[192:195], a[64:67], v[56:59]
    buffer_load_dwordx4 v[184:187], v34, s[84:87], s52 offen offset:1024 sc1
    v_mfma_f32_16x16x32_bf16 v[60:63], v[192:195], a[68:71], v[60:63]
    ds_read_b128 v[44:47], v23 offset:4096
    ds_read_b128 v[48:51], v23 offset:8192
    v_mfma_f32_16x16x32_bf16 v[64:67], v[192:195], a[72:75], v[64:67]
    ds_read_b128 v[52:55], v23 offset:12288
    v_mfma_f32_16x16x32_bf16 v[68:71], v[192:195], a[76:79], v[68:71]
    ds_read_b128 v[40:43], v23 offset:0
    s_waitcnt vmcnt(11)
    v_mfma_f32_16x16x32_bf16 v[56:59], v[140:143], a[80:83], v[56:59]
    buffer_load_dwordx4 v[188:191], v34, s[84:87], s53 offen offset:1024 sc1
    v_mfma_f32_16x16x32_bf16 v[60:63], v[140:143], a[84:87], v[60:63]
    v_mfma_f32_16x16x32_bf16 v[64:67], v[140:143], a[88:91], v[64:67]
    v_mfma_f32_16x16x32_bf16 v[68:71], v[140:143], a[92:95], v[68:71]
    s_waitcnt vmcnt(11)
    v_mfma_f32_16x16x32_bf16 v[56:59], v[144:147], a[96:99], v[56:59]
    buffer_load_dwordx4 v[192:195], v34, s[84:87], s54 offen offset:1024 sc1
    v_mfma_f32_16x16x32_bf16 v[60:63], v[144:147], a[100:103], v[60:63]
    s_waitcnt lgkmcnt(3)
    v_add_f32 v44, v44, v116
    v_mfma_f32_16x16x32_bf16 v[64:67], v[144:147], a[104:107], v[64:67]
    v_add_f32 v45, v45, v117
    v_mfma_f32_16x16x32_bf16 v[68:71], v[144:147], a[108:111], v[68:71]
    v_add_f32 v46, v46, v118
    s_waitcnt vmcnt(11)
    v_mfma_f32_16x16x32_bf16 v[56:59], v[148:151], a[112:115], v[56:59]
    buffer_load_dwordx4 v[140:143], v34, s[84:87], s55 offen offset:1024 sc1
    v_mfma_f32_16x16x32_bf16 v[60:63], v[148:151], a[116:119], v[60:63]
    v_add_f32 v47, v47, v119
    v_mfma_f32_16x16x32_bf16 v[64:67], v[148:151], a[120:123], v[64:67]
    s_waitcnt lgkmcnt(2)
    v_add_f32 v44, v44, v48
    v_add_f32 v45, v45, v49
    v_mfma_f32_16x16x32_bf16 v[68:71], v[148:151], a[124:127], v[68:71]
    v_add_f32 v46, v46, v50
    s_waitcnt vmcnt(11)
    v_mfma_f32_16x16x32_bf16 v[56:59], v[152:155], a[192:195], v[56:59]
    buffer_load_dwordx4 v[144:147], v34, s[84:87], s56 offen offset:1024 sc1
    v_mfma_f32_16x16x32_bf16 v[60:63], v[152:155], a[196:199], v[60:63]
    v_add_f32 v47, v47, v51
    s_waitcnt lgkmcnt(1)
    v_add_f32 v44, v44, v52
    v_mfma_f32_16x16x32_bf16 v[64:67], v[152:155], a[200:203], v[64:67]
    v_add_f32 v45, v45, v53
    v_mfma_f32_16x16x32_bf16 v[68:71], v[152:155], a[204:207], v[68:71]
    v_add_f32 v46, v46, v54
    s_waitcnt vmcnt(11)
    v_mfma_f32_16x16x32_bf16 v[56:59], v[156:159], a[208:211], v[56:59]
    buffer_load_dwordx4 v[148:151], v34, s[84:87], s57 offen offset:1024 sc1
    v_mfma_f32_16x16x32_bf16 v[60:63], v[156:159], a[212:215], v[60:63]
    v_add_f32 v47, v47, v55
    v_mul_f32 v48, v44, v36
    v_mfma_f32_16x16x32_bf16 v[64:67], v[156:159], a[216:219], v[64:67]
    v_mul_f32 v49, v45, v36
    v_mul_f32 v50, v46, v36
    v_mfma_f32_16x16x32_bf16 v[68:71], v[156:159], a[220:223], v[68:71]
    v_mul_f32 v51, v47, v36
    s_waitcnt vmcnt(11)
    v_mfma_f32_16x16x32_bf16 v[56:59], v[160:163], a[224:227], v[56:59]
    buffer_load_dwordx4 v[152:155], v34, s[84:87], s58 offen offset:1024 sc1
    v_mfma_f32_16x16x32_bf16 v[60:63], v[160:163], a[228:231], v[60:63]
    v_exp_f32 v48, v48
    v_mfma_f32_16x16x32_bf16 v[64:67], v[160:163], a[232:235], v[64:67]
    v_exp_f32 v49, v49
    v_mfma_f32_16x16x32_bf16 v[68:71], v[160:163], a[236:239], v[68:71]
    s_waitcnt vmcnt(11)
    v_mfma_f32_16x16x32_bf16 v[56:59], v[164:167], a[240:243], v[56:59]
    buffer_load_dwordx4 v[156:159], v34, s[84:87], s59 offen offset:1024 sc1
    v_mfma_f32_16x16x32_bf16 v[60:63], v[164:167], a[244:247], v[60:63]
    v_exp_f32 v50, v50
    v_mfma_f32_16x16x32_bf16 v[64:67], v[164:167], a[248:251], v[64:67]
    v_exp_f32 v51, v51
    v_mfma_f32_16x16x32_bf16 v[68:71], v[164:167], a[252:255], v[68:71]
    s_waitcnt vmcnt(11)
    v_mfma_f32_16x16x32_bf16 v[56:59], v[168:171], v[208:211], v[56:59]
    buffer_load_dwordx4 v[160:163], v34, s[84:87], s60 offen offset:1024 sc1
    v_mfma_f32_16x16x32_bf16 v[60:63], v[168:171], v[212:215], v[60:63]
    s_waitcnt lgkmcnt(0)
    v_mul_f32 v44, v44, v40
    v_mfma_f32_16x16x32_bf16 v[64:67], v[168:171], v[216:219], v[64:67]
    v_mul_f32 v45, v45, v41
    v_mul_f32 v46, v46, v42
    v_mfma_f32_16x16x32_bf16 v[68:71], v[168:171], v[220:223], v[68:71]
    v_mul_f32 v47, v47, v43
    s_waitcnt vmcnt(11)
    v_mfma_f32_16x16x32_bf16 v[56:59], v[172:175], v[224:227], v[56:59]
    buffer_load_dwordx4 v[164:167], v34, s[84:87], s61 offen offset:1024 sc1
    v_mfma_f32_16x16x32_bf16 v[60:63], v[172:175], v[228:231], v[60:63]
    v_add_f32 v48, v48, v38
    v_mfma_f32_16x16x32_bf16 v[64:67], v[172:175], v[232:235], v[64:67]
    v_add_f32 v49, v49, v38
    v_add_f32 v50, v50, v38
    v_mfma_f32_16x16x32_bf16 v[68:71], v[172:175], v[236:239], v[68:71]
    v_add_f32 v51, v51, v38
    s_waitcnt vmcnt(11)
    v_mfma_f32_16x16x32_bf16 v[56:59], v[176:179], v[240:243], v[56:59]
    buffer_load_dwordx4 v[168:171], v34, s[84:87], s62 offen offset:1024 sc1
    v_mfma_f32_16x16x32_bf16 v[60:63], v[176:179], v[244:247], v[60:63]
    v_rcp_f32 v48, v48
    v_mfma_f32_16x16x32_bf16 v[64:67], v[176:179], v[248:251], v[64:67]
    v_rcp_f32 v49, v49
    v_mfma_f32_16x16x32_bf16 v[68:71], v[176:179], v[252:255], v[68:71]
    s_waitcnt vmcnt(11)
    v_mfma_f32_16x16x32_bf16 v[72:75], v[180:183], a[0:3], 0
    buffer_load_dwordx4 v[172:175], v34, s[84:87], s63 offen offset:1024 sc1
    v_mfma_f32_16x16x32_bf16 v[76:79], v[180:183], a[128:131], 0
    v_rcp_f32 v50, v50
    v_mfma_f32_16x16x32_bf16 v[80:83], v[180:183], a[4:7], 0
    ds_write_addtid_b32 v56 offset:16384
    v_mfma_f32_16x16x32_bf16 v[84:87], v[180:183], a[132:135], 0
    ds_write_addtid_b32 v57 offset:16640
    s_waitcnt vmcnt(11)
    v_mfma_f32_16x16x32_bf16 v[72:75], v[184:187], a[8:11], v[72:75]
    buffer_load_dwordx4 v[176:179], v34, s[84:87], s64 offen offset:1024 sc1
    v_mfma_f32_16x16x32_bf16 v[76:79], v[184:187], a[136:139], v[76:79]
    ds_write_addtid_b32 v58 offset:16896
    v_mfma_f32_16x16x32_bf16 v[80:83], v[184:187], a[12:15], v[80:83]
    ds_write_addtid_b32 v59 offset:17152
    v_mfma_f32_16x16x32_bf16 v[84:87], v[184:187], a[140:143], v[84:87]
    s_waitcnt vmcnt(11)
    v_mfma_f32_16x16x32_bf16 v[72:75], v[188:191], a[16:19], v[72:75]
    buffer_load_dwordx4 v[180:183], v34, s[84:87], s65 offen offset:1024 sc1
    v_mfma_f32_16x16x32_bf16 v[76:79], v[188:191], a[144:147], v[76:79]
    ds_write_addtid_b32 v60 offset:17408
    v_mfma_f32_16x16x32_bf16 v[80:83], v[188:191], a[20:23], v[80:83]
    ds_write_addtid_b32 v61 offset:17664
    v_mfma_f32_16x16x32_bf16 v[84:87], v[188:191], a[148:151], v[84:87]
    ds_write_addtid_b32 v62 offset:17920
    s_waitcnt vmcnt(11)
    v_mfma_f32_16x16x32_bf16 v[72:75], v[192:195], a[24:27], v[72:75]
    buffer_load_dwordx4 v[184:187], v34, s[84:87], s66 offen offset:1024 sc1
    v_mfma_f32_16x16x32_bf16 v[76:79], v[192:195], a[152:155], v[76:79]
    ds_write_addtid_b32 v63 offset:18176
    v_mfma_f32_16x16x32_bf16 v[80:83], v[192:195], a[28:31], v[80:83]
    ds_write_addtid_b32 v64 offset:18432
    v_mfma_f32_16x16x32_bf16 v[84:87], v[192:195], a[156:159], v[84:87]
    ds_write_addtid_b32 v65 offset:18688
    s_waitcnt vmcnt(11)
    v_mfma_f32_16x16x32_bf16 v[72:75], v[140:143], a[32:35], v[72:75]
    buffer_load_dwordx4 v[188:191], v34, s[84:87], s67 offen offset:1024 sc1
    v_mfma_f32_16x16x32_bf16 v[76:79], v[140:143], a[160:163], v[76:79]
    ds_write_addtid_b32 v66 offset:18944
    v_mfma_f32_16x16x32_bf16 v[80:83], v[140:143], a[36:39], v[80:83]
    ds_write_addtid_b32 v67 offset:19200
    v_rcp_f32 v51, v51
    v_mfma_f32_16x16x32_bf16 v[84:87], v[140:143], a[164:167], v[84:87]
    s_waitcnt vmcnt(11)
    v_mfma_f32_16x16x32_bf16 v[72:75], v[144:147], a[40:43], v[72:75]
    buffer_load_dwordx4 v[192:195], v34, s[84:87], s73 offen offset:1024 sc1
    v_mfma_f32_16x16x32_bf16 v[76:79], v[144:147], a[168:171], v[76:79]
    ds_write_addtid_b32 v68 offset:19456
    v_fma_f32 v44, v44, v48, v124
    v_mfma_f32_16x16x32_bf16 v[80:83], v[144:147], a[44:47], v[80:83]
    ds_write_addtid_b32 v69 offset:19712
    v_fma_f32 v45, v45, v49, v125
    v_mfma_f32_16x16x32_bf16 v[84:87], v[144:147], a[172:175], v[84:87]
    ds_write_addtid_b32 v70 offset:19968
    s_waitcnt vmcnt(11)
    v_mfma_f32_16x16x32_bf16 v[72:75], v[148:151], a[48:51], v[72:75]
    buffer_load_dwordx4 v[140:143], v34, s[84:87], s75 offen offset:1024 sc1
    v_mfma_f32_16x16x32_bf16 v[76:79], v[148:151], a[176:179], v[76:79]
    ds_write_addtid_b32 v71 offset:20224
    v_fma_f32 v46, v46, v50, v126
    v_mfma_f32_16x16x32_bf16 v[80:83], v[148:151], a[52:55], v[80:83]
    v_fma_f32 v47, v47, v51, v127
    v_mfma_f32_16x16x32_bf16 v[84:87], v[148:151], a[180:183], v[84:87]
    v_cvt_pk_bf16_f32 v104, v44, v45
    s_waitcnt vmcnt(11)
    v_mfma_f32_16x16x32_bf16 v[72:75], v[152:155], a[56:59], v[72:75]
    buffer_load_dwordx4 v[144:147], v34, s[84:87], s89 offen offset:1280 sc1
    v_mfma_f32_16x16x32_bf16 v[76:79], v[152:155], a[184:187], v[76:79]
    v_cvt_pk_bf16_f32 v105, v46, v47
    v_mfma_f32_16x16x32_bf16 v[80:83], v[152:155], a[60:63], v[80:83]
    buffer_store_dwordx2 v[104:105], v25, s[24:27], 0 offen offset:0 sc1
    v_mfma_f32_16x16x32_bf16 v[84:87], v[152:155], a[188:191], v[84:87]
    s_waitcnt lgkmcnt(0)
    s_barrier
    s_waitcnt vmcnt(12)
    v_mfma_f32_16x16x32_bf16 v[72:75], v[156:159], a[64:67], v[72:75]
    buffer_load_dwordx4 v[148:151], v34, s[84:87], s52 offen offset:1280 sc1
    v_mfma_f32_16x16x32_bf16 v[76:79], v[156:159], a[68:71], v[76:79]
    ds_read_b128 v[60:63], v23 offset:20480
    ds_read_b128 v[64:67], v23 offset:24576
    v_mfma_f32_16x16x32_bf16 v[80:83], v[156:159], a[72:75], v[80:83]
    ds_read_b128 v[68:71], v23 offset:28672
    v_mfma_f32_16x16x32_bf16 v[84:87], v[156:159], a[76:79], v[84:87]
    ds_read_b128 v[56:59], v23 offset:16384
    s_waitcnt vmcnt(12)
    v_mfma_f32_16x16x32_bf16 v[72:75], v[160:163], a[80:83], v[72:75]
    buffer_load_dwordx4 v[152:155], v34, s[84:87], s53 offen offset:1280 sc1
    v_mfma_f32_16x16x32_bf16 v[76:79], v[160:163], a[84:87], v[76:79]
    v_mfma_f32_16x16x32_bf16 v[80:83], v[160:163], a[88:91], v[80:83]
    v_mfma_f32_16x16x32_bf16 v[84:87], v[160:163], a[92:95], v[84:87]
    s_waitcnt vmcnt(12)
    v_mfma_f32_16x16x32_bf16 v[72:75], v[164:167], a[96:99], v[72:75]
    buffer_load_dwordx4 v[156:159], v34, s[84:87], s54 offen offset:1280 sc1
    v_mfma_f32_16x16x32_bf16 v[76:79], v[164:167], a[100:103], v[76:79]
    s_waitcnt lgkmcnt(3)
    v_add_f32 v60, v60, v116
    v_mfma_f32_16x16x32_bf16 v[80:83], v[164:167], a[104:107], v[80:83]
    v_add_f32 v61, v61, v117
    v_mfma_f32_16x16x32_bf16 v[84:87], v[164:167], a[108:111], v[84:87]
    v_add_f32 v62, v62, v118
    s_waitcnt vmcnt(12)
    v_mfma_f32_16x16x32_bf16 v[72:75], v[168:171], a[112:115], v[72:75]
    buffer_load_dwordx4 v[160:163], v34, s[84:87], s55 offen offset:1280 sc1
    v_mfma_f32_16x16x32_bf16 v[76:79], v[168:171], a[116:119], v[76:79]
    v_add_f32 v63, v63, v119
    s_waitcnt lgkmcnt(2)
    v_add_f32 v60, v60, v64
    v_mfma_f32_16x16x32_bf16 v[80:83], v[168:171], a[120:123], v[80:83]
    v_add_f32 v61, v61, v65
    v_mfma_f32_16x16x32_bf16 v[84:87], v[168:171], a[124:127], v[84:87]
    v_add_f32 v62, v62, v66
    s_waitcnt vmcnt(12)
    v_mfma_f32_16x16x32_bf16 v[72:75], v[172:175], a[192:195], v[72:75]
    buffer_load_dwordx4 v[164:167], v34, s[84:87], s56 offen offset:1280 sc1
    v_mfma_f32_16x16x32_bf16 v[76:79], v[172:175], a[196:199], v[76:79]
    v_add_f32 v63, v63, v67
    s_waitcnt lgkmcnt(1)
    v_add_f32 v60, v60, v68
    v_mfma_f32_16x16x32_bf16 v[80:83], v[172:175], a[200:203], v[80:83]
    v_add_f32 v61, v61, v69
    v_mfma_f32_16x16x32_bf16 v[84:87], v[172:175], a[204:207], v[84:87]
    v_add_f32 v62, v62, v70
    s_waitcnt vmcnt(12)
    v_mfma_f32_16x16x32_bf16 v[72:75], v[176:179], a[208:211], v[72:75]
    buffer_load_dwordx4 v[168:171], v34, s[84:87], s57 offen offset:1280 sc1
    v_mfma_f32_16x16x32_bf16 v[76:79], v[176:179], a[212:215], v[76:79]
    v_add_f32 v63, v63, v71
    v_mul_f32 v64, v60, v36
    v_mfma_f32_16x16x32_bf16 v[80:83], v[176:179], a[216:219], v[80:83]
    v_mul_f32 v65, v61, v36
    v_mul_f32 v66, v62, v36
    v_mfma_f32_16x16x32_bf16 v[84:87], v[176:179], a[220:223], v[84:87]
    v_mul_f32 v67, v63, v36
    s_waitcnt vmcnt(12)
    v_mfma_f32_16x16x32_bf16 v[72:75], v[180:183], a[224:227], v[72:75]
    buffer_load_dwordx4 v[172:175], v34, s[84:87], s58 offen offset:1280 sc1
    v_mfma_f32_16x16x32_bf16 v[76:79], v[180:183], a[228:231], v[76:79]
    v_exp_f32 v64, v64
    v_mfma_f32_16x16x32_bf16 v[80:83], v[180:183], a[232:235], v[80:83]
    v_exp_f32 v65, v65
    v_mfma_f32_16x16x32_bf16 v[84:87], v[180:183], a[236:239], v[84:87]
    s_waitcnt vmcnt(12)
    v_mfma_f32_16x16x32_bf16 v[72:75], v[184:187], a[240:243], v[72:75]
    buffer_load_dwordx4 v[176:179], v34, s[84:87], s59 offen offset:1280 sc1
    v_mfma_f32_16x16x32_bf16 v[76:79], v[184:187], a[244:247], v[76:79]
    v_exp_f32 v66, v66
    v_mfma_f32_16x16x32_bf16 v[80:83], v[184:187], a[248:251], v[80:83]
    v_exp_f32 v67, v67
    v_mfma_f32_16x16x32_bf16 v[84:87], v[184:187], a[252:255], v[84:87]
    s_waitcnt vmcnt(12)
    v_mfma_f32_16x16x32_bf16 v[72:75], v[188:191], v[208:211], v[72:75]
    buffer_load_dwordx4 v[180:183], v34, s[84:87], s60 offen offset:1280 sc1
    v_mfma_f32_16x16x32_bf16 v[76:79], v[188:191], v[212:215], v[76:79]
    s_waitcnt lgkmcnt(0)
    v_mul_f32 v60, v60, v56
    v_mfma_f32_16x16x32_bf16 v[80:83], v[188:191], v[216:219], v[80:83]
    v_mul_f32 v61, v61, v57
    v_mul_f32 v62, v62, v58
    v_mfma_f32_16x16x32_bf16 v[84:87], v[188:191], v[220:223], v[84:87]
    v_mul_f32 v63, v63, v59
    s_waitcnt vmcnt(12)
    v_mfma_f32_16x16x32_bf16 v[72:75], v[192:195], v[224:227], v[72:75]
    buffer_load_dwordx4 v[184:187], v34, s[84:87], s61 offen offset:1280 sc1
    v_mfma_f32_16x16x32_bf16 v[76:79], v[192:195], v[228:231], v[76:79]
    v_add_f32 v64, v64, v38
    v_add_f32 v65, v65, v38
    v_mfma_f32_16x16x32_bf16 v[80:83], v[192:195], v[232:235], v[80:83]
    v_add_f32 v66, v66, v38
    v_mfma_f32_16x16x32_bf16 v[84:87], v[192:195], v[236:239], v[84:87]
    v_add_f32 v67, v67, v38
    s_waitcnt vmcnt(12)
    v_mfma_f32_16x16x32_bf16 v[72:75], v[140:143], v[240:243], v[72:75]
    buffer_load_dwordx4 v[188:191], v34, s[84:87], s62 offen offset:1280 sc1
    v_mfma_f32_16x16x32_bf16 v[76:79], v[140:143], v[244:247], v[76:79]
    v_rcp_f32 v64, v64
    v_mfma_f32_16x16x32_bf16 v[80:83], v[140:143], v[248:251], v[80:83]
    v_rcp_f32 v65, v65
    v_mfma_f32_16x16x32_bf16 v[84:87], v[140:143], v[252:255], v[84:87]
    s_waitcnt vmcnt(12)
    v_mfma_f32_16x16x32_bf16 v[88:91], v[144:147], a[0:3], 0
    buffer_load_dwordx4 v[192:195], v34, s[84:87], s63 offen offset:1280 sc1
    v_mfma_f32_16x16x32_bf16 v[92:95], v[144:147], a[128:131], 0
    v_rcp_f32 v66, v66
    v_mfma_f32_16x16x32_bf16 v[96:99], v[144:147], a[4:7], 0
    ds_write_addtid_b32 v72 offset:32768
    v_mfma_f32_16x16x32_bf16 v[100:103], v[144:147], a[132:135], 0
    ds_write_addtid_b32 v73 offset:33024
    s_waitcnt vmcnt(11)
    v_mfma_f32_16x16x32_bf16 v[88:91], v[148:151], a[8:11], v[88:91]
    buffer_load_dwordx4 v[140:143], v34, s[84:87], s64 offen offset:1280 sc1
    v_mfma_f32_16x16x32_bf16 v[92:95], v[148:151], a[136:139], v[92:95]
    ds_write_addtid_b32 v74 offset:33280
    v_mfma_f32_16x16x32_bf16 v[96:99], v[148:151], a[12:15], v[96:99]
    ds_write_addtid_b32 v75 offset:33536
    v_mfma_f32_16x16x32_bf16 v[100:103], v[148:151], a[140:143], v[100:103]
    s_waitcnt vmcnt(11)
    v_mfma_f32_16x16x32_bf16 v[88:91], v[152:155], a[16:19], v[88:91]
    buffer_load_dwordx4 v[144:147], v34, s[84:87], s65 offen offset:1280 sc1
    v_mfma_f32_16x16x32_bf16 v[92:95], v[152:155], a[144:147], v[92:95]
    ds_write_addtid_b32 v76 offset:33792
    v_mfma_f32_16x16x32_bf16 v[96:99], v[152:155], a[20:23], v[96:99]
    ds_write_addtid_b32 v77 offset:34048
    v_mfma_f32_16x16x32_bf16 v[100:103], v[152:155], a[148:151], v[100:103]
    ds_write_addtid_b32 v78 offset:34304
    s_waitcnt vmcnt(11)
    v_mfma_f32_16x16x32_bf16 v[88:91], v[156:159], a[24:27], v[88:91]
    buffer_load_dwordx4 v[148:151], v34, s[84:87], s66 offen offset:1280 sc1
    v_mfma_f32_16x16x32_bf16 v[92:95], v[156:159], a[152:155], v[92:95]
    ds_write_addtid_b32 v79 offset:34560
    v_mfma_f32_16x16x32_bf16 v[96:99], v[156:159], a[28:31], v[96:99]
    ds_write_addtid_b32 v80 offset:34816
    v_mfma_f32_16x16x32_bf16 v[100:103], v[156:159], a[156:159], v[100:103]
    ds_write_addtid_b32 v81 offset:35072
    s_waitcnt vmcnt(11)
    v_mfma_f32_16x16x32_bf16 v[88:91], v[160:163], a[32:35], v[88:91]
    buffer_load_dwordx4 v[152:155], v34, s[84:87], s67 offen offset:1280 sc1
    v_mfma_f32_16x16x32_bf16 v[92:95], v[160:163], a[160:163], v[92:95]
    ds_write_addtid_b32 v82 offset:35328
    v_mfma_f32_16x16x32_bf16 v[96:99], v[160:163], a[36:39], v[96:99]
    ds_write_addtid_b32 v83 offset:35584
    v_mfma_f32_16x16x32_bf16 v[100:103], v[160:163], a[164:167], v[100:103]
    v_rcp_f32 v67, v67
    s_waitcnt vmcnt(11)
    v_mfma_f32_16x16x32_bf16 v[88:91], v[164:167], a[40:43], v[88:91]
    buffer_load_dwordx4 v[156:159], v34, s[84:87], s73 offen offset:1280 sc1
    v_mfma_f32_16x16x32_bf16 v[92:95], v[164:167], a[168:171], v[92:95]
    ds_write_addtid_b32 v84 offset:35840
    v_mfma_f32_16x16x32_bf16 v[96:99], v[164:167], a[44:47], v[96:99]
    ds_write_addtid_b32 v85 offset:36096
    v_fma_f32 v60, v60, v64, v128
    v_mfma_f32_16x16x32_bf16 v[100:103], v[164:167], a[172:175], v[100:103]
    ds_write_addtid_b32 v86 offset:36352
    s_waitcnt vmcnt(11)
    v_mfma_f32_16x16x32_bf16 v[88:91], v[168:171], a[48:51], v[88:91]
    buffer_load_dwordx4 v[160:163], v34, s[84:87], s75 offen offset:1280 sc1
    v_mfma_f32_16x16x32_bf16 v[92:95], v[168:171], a[176:179], v[92:95]
    ds_write_addtid_b32 v87 offset:36608
    v_fma_f32 v61, v61, v65, v129
    v_mfma_f32_16x16x32_bf16 v[96:99], v[168:171], a[52:55], v[96:99]
    v_fma_f32 v62, v62, v66, v130
    v_mfma_f32_16x16x32_bf16 v[100:103], v[168:171], a[180:183], v[100:103]
    v_fma_f32 v63, v63, v67, v131
    s_waitcnt vmcnt(11)
    v_mfma_f32_16x16x32_bf16 v[88:91], v[172:175], a[56:59], v[88:91]
    v_cvt_pk_bf16_f32 v106, v60, v61
    v_mfma_f32_16x16x32_bf16 v[92:95], v[172:175], a[184:187], v[92:95]
    v_cvt_pk_bf16_f32 v107, v62, v63
    v_mfma_f32_16x16x32_bf16 v[96:99], v[172:175], a[60:63], v[96:99]
    buffer_store_dwordx2 v[106:107], v25, s[24:27], s76 offen offset:0 sc1
    v_mfma_f32_16x16x32_bf16 v[100:103], v[172:175], a[188:191], v[100:103]
    s_waitcnt lgkmcnt(0)
    s_barrier
    s_waitcnt vmcnt(11)
    v_mfma_f32_16x16x32_bf16 v[88:91], v[176:179], a[64:67], v[88:91]
    ds_read_b128 v[76:79], v23 offset:36864
    v_mfma_f32_16x16x32_bf16 v[92:95], v[176:179], a[68:71], v[92:95]
    ds_read_b128 v[80:83], v23 offset:40960
    v_mfma_f32_16x16x32_bf16 v[96:99], v[176:179], a[72:75], v[96:99]
    ds_read_b128 v[84:87], v23 offset:45056
    v_mfma_f32_16x16x32_bf16 v[100:103], v[176:179], a[76:79], v[100:103]
    ds_read_b128 v[72:75], v23 offset:32768
    s_waitcnt vmcnt(10)
    v_mfma_f32_16x16x32_bf16 v[88:91], v[180:183], a[80:83], v[88:91]
    v_mfma_f32_16x16x32_bf16 v[92:95], v[180:183], a[84:87], v[92:95]
    v_mfma_f32_16x16x32_bf16 v[96:99], v[180:183], a[88:91], v[96:99]
    v_mfma_f32_16x16x32_bf16 v[100:103], v[180:183], a[92:95], v[100:103]
    s_waitcnt vmcnt(9)
    v_mfma_f32_16x16x32_bf16 v[88:91], v[184:187], a[96:99], v[88:91]
    s_waitcnt lgkmcnt(3)
    v_add_f32 v76, v76, v116
    v_mfma_f32_16x16x32_bf16 v[92:95], v[184:187], a[100:103], v[92:95]
    v_add_f32 v77, v77, v117
    v_mfma_f32_16x16x32_bf16 v[96:99], v[184:187], a[104:107], v[96:99]
    v_add_f32 v78, v78, v118
    v_add_f32 v79, v79, v119
    v_mfma_f32_16x16x32_bf16 v[100:103], v[184:187], a[108:111], v[100:103]
    s_waitcnt vmcnt(8)
    v_mfma_f32_16x16x32_bf16 v[88:91], v[188:191], a[112:115], v[88:91]
    s_waitcnt lgkmcnt(2)
    v_add_f32 v76, v76, v80
    v_add_f32 v77, v77, v81
    v_mfma_f32_16x16x32_bf16 v[92:95], v[188:191], a[116:119], v[92:95]
    v_add_f32 v78, v78, v82
    v_mfma_f32_16x16x32_bf16 v[96:99], v[188:191], a[120:123], v[96:99]
    v_add_f32 v79, v79, v83
    v_mfma_f32_16x16x32_bf16 v[100:103], v[188:191], a[124:127], v[100:103]
    s_waitcnt lgkmcnt(1)
    v_add_f32 v76, v76, v84
    s_waitcnt vmcnt(7)
    v_mfma_f32_16x16x32_bf16 v[88:91], v[192:195], a[192:195], v[88:91]
    v_add_f32 v77, v77, v85
    v_mfma_f32_16x16x32_bf16 v[92:95], v[192:195], a[196:199], v[92:95]
    v_add_f32 v78, v78, v86
    v_add_f32 v79, v79, v87
    v_mfma_f32_16x16x32_bf16 v[96:99], v[192:195], a[200:203], v[96:99]
    v_mul_f32 v80, v76, v36
    v_mul_f32 v81, v77, v36
    v_mfma_f32_16x16x32_bf16 v[100:103], v[192:195], a[204:207], v[100:103]
    s_waitcnt vmcnt(6)
    v_mfma_f32_16x16x32_bf16 v[88:91], v[140:143], a[208:211], v[88:91]
    v_mul_f32 v82, v78, v36
    v_mul_f32 v83, v79, v36
    v_mfma_f32_16x16x32_bf16 v[92:95], v[140:143], a[212:215], v[92:95]
    v_exp_f32 v80, v80
    v_mfma_f32_16x16x32_bf16 v[96:99], v[140:143], a[216:219], v[96:99]
    v_exp_f32 v81, v81
    v_mfma_f32_16x16x32_bf16 v[100:103], v[140:143], a[220:223], v[100:103]
    s_waitcnt vmcnt(5)
    v_mfma_f32_16x16x32_bf16 v[88:91], v[144:147], a[224:227], v[88:91]
    v_exp_f32 v82, v82
    v_mfma_f32_16x16x32_bf16 v[92:95], v[144:147], a[228:231], v[92:95]
    v_exp_f32 v83, v83
    v_mfma_f32_16x16x32_bf16 v[96:99], v[144:147], a[232:235], v[96:99]
    v_mfma_f32_16x16x32_bf16 v[100:103], v[144:147], a[236:239], v[100:103]
    s_waitcnt lgkmcnt(0)
    v_mul_f32 v76, v76, v72
    s_waitcnt vmcnt(4)
    v_mfma_f32_16x16x32_bf16 v[88:91], v[148:151], a[240:243], v[88:91]
    v_mul_f32 v77, v77, v73
    v_mfma_f32_16x16x32_bf16 v[92:95], v[148:151], a[244:247], v[92:95]
    v_mul_f32 v78, v78, v74
    v_mul_f32 v79, v79, v75
    v_mfma_f32_16x16x32_bf16 v[96:99], v[148:151], a[248:251], v[96:99]
    v_add_f32 v80, v80, v38
    v_add_f32 v81, v81, v38
    v_mfma_f32_16x16x32_bf16 v[100:103], v[148:151], a[252:255], v[100:103]
    s_waitcnt vmcnt(3)
    v_mfma_f32_16x16x32_bf16 v[88:91], v[152:155], v[208:211], v[88:91]
    v_add_f32 v82, v82, v38
    v_add_f32 v83, v83, v38
    v_mfma_f32_16x16x32_bf16 v[92:95], v[152:155], v[212:215], v[92:95]
    v_rcp_f32 v80, v80
    v_mfma_f32_16x16x32_bf16 v[96:99], v[152:155], v[216:219], v[96:99]
    v_rcp_f32 v81, v81
    v_mfma_f32_16x16x32_bf16 v[100:103], v[152:155], v[220:223], v[100:103]
    s_waitcnt vmcnt(2)
    v_mfma_f32_16x16x32_bf16 v[88:91], v[156:159], v[224:227], v[88:91]
    v_rcp_f32 v82, v82
    v_mfma_f32_16x16x32_bf16 v[92:95], v[156:159], v[228:231], v[92:95]
    v_rcp_f32 v83, v83
    v_mfma_f32_16x16x32_bf16 v[96:99], v[156:159], v[232:235], v[96:99]
    v_fma_f32 v76, v76, v80, v132
    v_mfma_f32_16x16x32_bf16 v[100:103], v[156:159], v[236:239], v[100:103]
    v_fma_f32 v77, v77, v81, v133
    s_waitcnt vmcnt(1)
    v_mfma_f32_16x16x32_bf16 v[88:91], v[160:163], v[240:243], v[88:91]
    v_fma_f32 v78, v78, v82, v134
    v_mfma_f32_16x16x32_bf16 v[92:95], v[160:163], v[244:247], v[92:95]
    v_fma_f32 v79, v79, v83, v135
    v_cvt_pk_bf16_f32 v108, v76, v77
    v_mfma_f32_16x16x32_bf16 v[96:99], v[160:163], v[248:251], v[96:99]
    v_cvt_pk_bf16_f32 v109, v78, v79
    v_mfma_f32_16x16x32_bf16 v[100:103], v[160:163], v[252:255], v[100:103]
    buffer_store_dwordx2 v[108:109], v25, s[24:27], 0 offen offset:1024 sc1
    ds_write_addtid_b32 v88 offset:49152
    ds_write_addtid_b32 v89 offset:49408
    ds_write_addtid_b32 v90 offset:49664
    ds_write_addtid_b32 v91 offset:49920
    ds_write_addtid_b32 v92 offset:50176
    ds_write_addtid_b32 v93 offset:50432
    ds_write_addtid_b32 v94 offset:50688
    ds_write_addtid_b32 v95 offset:50944
    ds_write_addtid_b32 v96 offset:51200
    ds_write_addtid_b32 v97 offset:51456
    ds_write_addtid_b32 v98 offset:51712
    ds_write_addtid_b32 v99 offset:51968
    ds_write_addtid_b32 v100 offset:52224
    ds_write_addtid_b32 v101 offset:52480
    ds_write_addtid_b32 v102 offset:52736
    ds_write_addtid_b32 v103 offset:52992
    s_waitcnt lgkmcnt(0)
    s_barrier
    ds_read_b128 v[92:95], v23 offset:53248
    ds_read_b128 v[96:99], v23 offset:57344
    ds_read_b128 v[100:103], v23 offset:61440
    ds_read_b128 v[88:91], v23 offset:49152
    s_waitcnt lgkmcnt(3)
    v_pk_add_f32 v[92:93], v[92:93], v[116:117]
    v_pk_add_f32 v[94:95], v[94:95], v[118:119]
    s_waitcnt lgkmcnt(2)
    v_pk_add_f32 v[92:93], v[92:93], v[96:97]
    v_pk_add_f32 v[94:95], v[94:95], v[98:99]
    s_waitcnt lgkmcnt(1)
    v_pk_add_f32 v[92:93], v[92:93], v[100:101]
    v_pk_add_f32 v[94:95], v[94:95], v[102:103]
    v_pk_mul_f32 v[96:97], v[92:93], v[36:37] op_sel_hi:[1,0]
    v_pk_mul_f32 v[98:99], v[94:95], v[36:37] op_sel_hi:[1,0]
    v_exp_f32 v96, v96
    v_exp_f32 v97, v97
    v_exp_f32 v98, v98
    v_exp_f32 v99, v99
    s_waitcnt lgkmcnt(0)
    v_pk_mul_f32 v[92:93], v[92:93], v[88:89]
    v_pk_mul_f32 v[94:95], v[94:95], v[90:91]
    v_pk_add_f32 v[96:97], v[96:97], v[38:39] op_sel_hi:[1,0]
    v_pk_add_f32 v[98:99], v[98:99], v[38:39] op_sel_hi:[1,0]
    v_rcp_f32 v96, v96
    v_rcp_f32 v97, v97
    v_rcp_f32 v98, v98
    v_rcp_f32 v99, v99
    v_pk_fma_f32 v[92:93], v[92:93], v[96:97], v[136:137]
    v_pk_fma_f32 v[94:95], v[94:95], v[98:99], v[138:139]
    v_cvt_pk_bf16_f32 v110, v92, v93
    v_cvt_pk_bf16_f32 v111, v94, v95
    buffer_store_dwordx2 v[110:111], v25, s[24:27], s76 offen offset:1024 sc1
    s_endpgm
L_a_w0:
    v_and_b32 v1, 15, v0
    s_lshl_b32 s77, s71, 7
    v_lshl_add_u32 v1, v1, 3, s77
    s_lshl_b32 s77, s70, 5
    s_add_u32 s77, s77, s4
    s_lshl_b32 s77, s77, 11
    v_and_b32 v2, 48, v0
    v_lshlrev_b32 v2, 9, v2
    v_add3_u32 v25, v1, v2, s77
    s_mov_b32 s76, 0x8000
    s_lshr_b32 s3, s2, 3
    s_lshl_b32 s77, s3, 7
    v_lshl_add_u32 v124, v0, 12, s77
    v_min_u32 v124, s50, v124
    v_mov_b32 v125, 0
    v_lshl_add_u64 v[124:125], v[124:125], 0, s[48:49]
    buffer_load_dwordx2 v[112:113], v1, s[36:39], 0 offen
    ds_read_b64_tr_b16 a[24:25], v21 offset:49152
    ds_read_b64_tr_b16 a[26:27], v21 offset:50176
    ds_read_b64_tr_b16 a[152:153], v22 offset:49152
    ds_read_b64_tr_b16 a[154:155], v22 offset:50176
    ds_read_b64_tr_b16 a[28:29], v19 offset:49152
    ds_read_b64_tr_b16 a[30:31], v19 offset:50176
    buffer_load_dwordx2 v[104:105], v25, s[8:11], 0 offen offset:0
    ds_read_b64_tr_b16 a[156:157], v20 offset:49152
    ds_read_b64_tr_b16 a[158:159], v20 offset:50176
    ds_read_b64_tr_b16 a[32:33], v21 offset:0
    ds_read_b64_tr_b16 a[34:35], v21 offset:1024
    ds_read_b64_tr_b16 a[160:161], v22 offset:0
    ds_read_b64_tr_b16 a[162:163], v22 offset:1024
    buffer_load_dwordx2 v[106:107], v25, s[8:11], s76 offen offset:0
    ds_read_b64_tr_b16 a[36:37], v19 offset:0
    ds_read_b64_tr_b16 a[38:39], v19 offset:1024
    ds_read_b64_tr_b16 a[164:165], v20 offset:0
    ds_read_b64_tr_b16 a[166:167], v20 offset:1024
    s_lshr_b32 s91, s70, 1
    s_lshl_b32 s91, s91, 12
    s_add_u32 s91, s91, 10485760
    buffer_load_dwordx2 v[108:109], v25, s[8:11], 0 offen offset:1024
    v_lshlrev_b32 v3, 8, v0
    s_mov_b32 s93, 0
    s_mov_b32 s92, 0xff00
    ds_read_b64_tr_b16 a[40:41], v21 offset:16384
    ds_read_b64_tr_b16 a[42:43], v21 offset:17408
    ds_read_b64_tr_b16 a[168:169], v22 offset:16384
    buffer_load_dwordx2 v[110:111], v25, s[8:11], s76 offen offset:1024
    ds_read_b64_tr_b16 a[170:171], v22 offset:17408
    ds_read_b64_tr_b16 a[44:45], v19 offset:16384
    ds_read_b64_tr_b16 a[46:47], v19 offset:17408
    ds_read_b64_tr_b16 a[172:173], v20 offset:16384
    ds_read_b64_tr_b16 a[174:175], v20 offset:17408
    ds_read_b64_tr_b16 a[48:49], v21 offset:32768
    global_load_dword v9, v[124:125], off
    ds_read_b64_tr_b16 a[50:51], v21 offset:33792
    ds_read_b64_tr_b16 a[176:177], v22 offset:32768
    ds_read_b64_tr_b16 a[178:179], v22 offset:33792
    ds_read_b64_tr_b16 a[52:53], v19 offset:32768
    ds_read_b64_tr_b16 a[54:55], v19 offset:33792
    ds_read_b64_tr_b16 a[180:181], v20 offset:32768
    ds_read_b64_tr_b16 a[182:183], v20 offset:33792
    s_add_u32 m0, s90, 131072
    s_nop 0
    buffer_load_dwordx4 v15, s[20:23], s88 offen offset:0 lds
    v_add_u32 v26, -65536, v21
    v_add_u32 v27, -65536, v22
    v_add_u32 v28, -65536, v19
    v_add_u32 v29, -65536, v20
    ds_read_b64_tr_b16 a[56:57], v26 offset:0
    ds_read_b64_tr_b16 a[58:59], v26 offset:1024
    buffer_load_dwordx4 v16, s[20:23], s88 offen offset:1024 lds
    ds_read_b64_tr_b16 a[184:185], v27 offset:0
    ds_read_b64_tr_b16 a[186:187], v27 offset:1024
    ds_read_b64_tr_b16 a[60:61], v28 offset:0
    ds_read_b64_tr_b16 a[62:63], v28 offset:1024
    ds_read_b64_tr_b16 a[188:189], v29 offset:0
    ds_read_b64_tr_b16 a[190:191], v29 offset:1024
    buffer_load_dwordx4 v17, s[20:23], s88 offen offset:2048 lds
    ds_read_b64_tr_b16 a[64:65], v26 offset:16384
    ds_read_b64_tr_b16 a[66:67], v26 offset:17408
    ds_read_b64_tr_b16 a[68:69], v27 offset:16384
    ds_read_b64_tr_b16 a[70:71], v27 offset:17408
    ds_read_b64_tr_b16 a[72:73], v28 offset:16384
    ds_read_b64_tr_b16 a[74:75], v28 offset:17408
    ds_read_b64_tr_b16 a[76:77], v29 offset:16384
    buffer_load_dwordx4 v18, s[20:23], s88 offen offset:3072 lds
    s_add_u32 s88, s88, 32768
    s_cmp_eq_u32 s88, s78
    s_cselect_b32 s88, 0, s88
    ds_read_b64_tr_b16 a[78:79], v29 offset:17408
    s_waitcnt vmcnt(15)
    ds_read_b64_tr_b16 a[80:81], v26 offset:32768
    ds_read_b64_tr_b16 a[82:83], v26 offset:33792
    ds_read_b64_tr_b16 a[84:85], v27 offset:32768
    ds_read_b64_tr_b16 a[86:87], v27 offset:33792
    ds_read_b64_tr_b16 a[88:89], v28 offset:32768
    s_add_u32 m0, s90, 147456
    s_nop 0
    buffer_load_dwordx4 v15, s[20:23], s88 offen offset:0 lds
    ds_read_b64_tr_b16 a[90:91], v28 offset:33792
    ds_read_b64_tr_b16 a[92:93], v29 offset:32768
    ds_read_b64_tr_b16 a[94:95], v29 offset:33792
    s_waitcnt vmcnt(12)
    ds_read_b64_tr_b16 a[96:97], v26 offset:49152
    ds_read_b64_tr_b16 a[98:99], v26 offset:50176
    ds_read_b64_tr_b16 a[100:101], v27 offset:49152
    buffer_load_dwordx4 v16, s[20:23], s88 offen offset:1024 lds
    ds_read_b64_tr_b16 a[102:103], v27 offset:50176
    ds_read_b64_tr_b16 a[104:105], v28 offset:49152
    ds_read_b64_tr_b16 a[106:107], v28 offset:50176
    ds_read_b64_tr_b16 a[108:109], v29 offset:49152
    ds_read_b64_tr_b16 a[110:111], v29 offset:50176
    v_and_b32 v23, 15, v0
    v_lshlrev_b32 v23, 4, v23
    buffer_load_dwordx4 v17, s[20:23], s88 offen offset:2048 lds
    v_and_b32 v24, 16, v0
    v_lshl_add_u32 v23, v24, 5, v23
    v_and_b32 v24, 32, v0
    v_lshl_add_u32 v34, v24, 6, v23
    v_bfe_u32 v24, v0, 2, 1
    v_xor_b32 v24, v24, v0
    v_and_b32 v24, 3, v24
    buffer_load_dwordx4 v18, s[20:23], s88 offen offset:3072 lds
    s_add_u32 s88, s88, 32768
    s_cmp_eq_u32 s88, s78
    s_cselect_b32 s88, 0, s88
    v_and_b32 v23, 12, v0
    v_lshlrev_b32 v23, 8, v23
    v_lshl_add_u32 v23, v24, 4, v23
    v_and_b32 v24, 48, v0
    v_lshl_add_u32 v23, v24, 2, v23
    v_lshl_add_u32 v23, s4, 8, v23
    v_mov_b32 v36, 0xbfb8aa3b
    s_waitcnt lgkmcnt(15)
    s_add_u32 m0, s90, 114688
    s_nop 0
    buffer_load_dwordx4 v15, s[20:23], s88 offen offset:0 lds
    v_mov_b32 v38, 1.0
    s_add_u32 s52, s89, 4096
    s_cmp_eq_u32 s52, s79
    s_cselect_b32 s52, 0, s52
    s_add_u32 s53, s52, 4096
    s_cmp_eq_u32 s53, s79
    s_cselect_b32 s53, 0, s53
    buffer_load_dwordx4 v16, s[20:23], s88 offen offset:1024 lds
    s_add_u32 s54, s53, 4096
    s_cmp_eq_u32 s54, s79
    s_cselect_b32 s54, 0, s54
    s_add_u32 s55, s54, 4096
    s_cmp_eq_u32 s55, s79
    s_cselect_b32 s55, 0, s55
    s_add_u32 s56, s55, 4096
    s_cmp_eq_u32 s56, s79
    s_cselect_b32 s56, 0, s56
    buffer_load_dwordx4 v17, s[20:23], s88 offen offset:2048 lds
    s_add_u32 s57, s56, 4096
    s_cmp_eq_u32 s57, s79
    s_cselect_b32 s57, 0, s57
    s_add_u32 s58, s57, 4096
    s_cmp_eq_u32 s58, s79
    s_cselect_b32 s58, 0, s58
    s_add_u32 s59, s58, 4096
    s_cmp_eq_u32 s59, s79
    s_cselect_b32 s59, 0, s59
    buffer_load_dwordx4 v18, s[20:23], s88 offen offset:3072 lds
    s_add_u32 s88, s88, 32768
    s_cmp_eq_u32 s88, s78
    s_cselect_b32 s88, 0, s88
    s_add_u32 s60, s59, 4096
    s_cmp_eq_u32 s60, s79
    s_cselect_b32 s60, 0, s60
    s_add_u32 s61, s60, 4096
    s_cmp_eq_u32 s61, s79
    s_cselect_b32 s61, 0, s61
    s_add_u32 s62, s61, 4096
    s_cmp_eq_u32 s62, s79
    s_cselect_b32 s62, 0, s62
    s_add_u32 m0, s90, 65536
    s_nop 0
    buffer_load_dwordx4 v15, s[20:23], s88 offen offset:0 lds
    s_add_u32 s63, s62, 4096
    s_cmp_eq_u32 s63, s79
    s_cselect_b32 s63, 0, s63
    s_add_u32 s64, s63, 4096
    s_cmp_eq_u32 s64, s79
    s_cselect_b32 s64, 0, s64
    s_add_u32 s65, s64, 4096
    s_cmp_eq_u32 s65, s79
    s_cselect_b32 s65, 0, s65
    buffer_load_dwordx4 v16, s[20:23], s88 offen offset:1024 lds
    v_add_u32 v30, 65536, v21
    v_add_u32 v31, 65536, v22
    v_add_u32 v32, 65536, v19
    v_add_u32 v33, 65536, v20
    s_waitcnt vmcnt(10)
    ds_read_b64_tr_b16 a[112:113], v30 offset:0
    ds_read_b64_tr_b16 a[114:115], v30 offset:1024
    s_mov_b64 exec, s[92:93]
    buffer_load_dword v4, v3, s[16:19], s91 offen sc1
    s_mov_b64 exec, -1
    ds_read_b64_tr_b16 a[116:117], v31 offset:0
    ds_read_b64_tr_b16 a[118:119], v31 offset:1024
    ds_read_b64_tr_b16 a[120:121], v32 offset:0
    ds_read_b64_tr_b16 a[122:123], v32 offset:1024
    ds_read_b64_tr_b16 a[124:125], v33 offset:0
    ds_read_b64_tr_b16 a[126:127], v33 offset:1024
    s_add_u32 s66, s65, 4096
    s_cmp_eq_u32 s66, s79
    s_cselect_b32 s66, 0, s66
    buffer_load_dwordx4 v17, s[20:23], s88 offen offset:2048 lds
    buffer_load_dwordx4 v18, s[20:23], s88 offen offset:3072 lds
    s_add_u32 s88, s88, 32768
    s_cmp_eq_u32 s88, s78
    s_cselect_b32 s88, 0, s88
    s_add_u32 m0, s90, 81920
    s_nop 0
    buffer_load_dwordx4 v15, s[20:23], s88 offen offset:0 lds
    s_waitcnt vmcnt(10)
    ds_read_b64_tr_b16 a[192:193], v30 offset:16384
    ds_read_b64_tr_b16 a[194:195], v30 offset:17408
    ds_read_b64_tr_b16 a[196:197], v31 offset:16384
    ds_read_b64_tr_b16 a[198:199], v31 offset:17408
    ds_read_b64_tr_b16 a[200:201], v32 offset:16384
    ds_read_b64_tr_b16 a[202:203], v32 offset:17408
    buffer_load_dwordx4 v16, s[20:23], s88 offen offset:1024 lds
    ds_read_b64_tr_b16 a[204:205], v33 offset:16384
    ds_read_b64_tr_b16 a[206:207], v33 offset:17408
    buffer_load_dwordx4 v17, s[20:23], s88 offen offset:2048 lds
    buffer_load_dwordx4 v18, s[20:23], s88 offen offset:3072 lds
    s_add_u32 s88, s88, 32768
    s_cmp_eq_u32 s88, s78
    s_cselect_b32 s88, 0, s88
    s_waitcnt vmcnt(9)
    ds_read_b64_tr_b16 a[208:209], v21 offset:49152
    ds_read_b64_tr_b16 a[210:211], v21 offset:50176
    ds_read_b64_tr_b16 a[212:213], v22 offset:49152
    ds_read_b64_tr_b16 a[214:215], v22 offset:50176
    ds_read_b64_tr_b16 a[216:217], v19 offset:49152
    ds_read_b64_tr_b16 a[218:219], v19 offset:50176
    ds_read_b64_tr_b16 a[220:221], v20 offset:49152
    ds_read_b64_tr_b16 a[222:223], v20 offset:50176
    s_waitcnt vmcnt(6)
    v_cmp_ne_u32 vcc, 1, v4
    s_nop 4
    s_cbranch_vccnz L_a1_go_retry
L_a1_go_ok:
    buffer_load_dwordx4 v[140:143], v34, s[84:87], s89 offen offset:0 sc1
    buffer_load_dwordx4 v[144:147], v34, s[84:87], s52 offen offset:0 sc1
    buffer_load_dwordx4 v[148:151], v34, s[84:87], s53 offen offset:0 sc1
    buffer_load_dwordx4 v[152:155], v34, s[84:87], s54 offen offset:0 sc1
    buffer_load_dwordx4 v[156:159], v34, s[84:87], s55 offen offset:0 sc1
    buffer_load_dwordx4 v[160:163], v34, s[84:87], s56 offen offset:0 sc1
    buffer_load_dwordx4 v[164:167], v34, s[84:87], s57 offen offset:0 sc1
    buffer_load_dwordx4 v[168:171], v34, s[84:87], s58 offen offset:0 sc1
    buffer_load_dwordx4 v[172:175], v34, s[84:87], s59 offen offset:0 sc1
    buffer_load_dwordx4 v[176:179], v34, s[84:87], s60 offen offset:0 sc1
    buffer_load_dwordx4 v[180:183], v34, s[84:87], s61 offen offset:0 sc1
    buffer_load_dwordx4 v[184:187], v34, s[84:87], s62 offen offset:0 sc1
    s_mov_b32 m0, s90
    v_lshlrev_b32 v124, 16, v104
    v_and_b32 v125, 0xffff0000, v104
    v_lshlrev_b32 v126, 16, v105
    v_and_b32 v127, 0xffff0000, v105
    v_lshlrev_b32 v128, 16, v106
    v_and_b32 v129, 0xffff0000, v106
    v_lshlrev_b32 v130, 16, v107
    v_and_b32 v131, 0xffff0000, v107
    v_lshlrev_b32 v132, 16, v108
    v_and_b32 v133, 0xffff0000, v108
    v_lshlrev_b32 v134, 16, v109
    v_and_b32 v135, 0xffff0000, v109
    v_lshlrev_b32 v136, 16, v110
    v_and_b32 v137, 0xffff0000, v110
    v_lshlrev_b32 v138, 16, v111
    v_and_b32 v139, 0xffff0000, v111
    v_lshlrev_b32 v116, 16, v112
    v_and_b32 v117, 0xffff0000, v112
    v_lshlrev_b32 v118, 16, v113
    v_and_b32 v119, 0xffff0000, v113
    s_waitcnt vmcnt(11)
    v_mfma_f32_16x16x32_bf16 v[40:43], v[140:143], a[0:3], 0
    buffer_load_dwordx4 v[188:191], v34, s[84:87], s63 offen offset:0 sc1
    v_mfma_f32_16x16x32_bf16 v[44:47], v[140:143], a[128:131], 0
    ds_read_b64_tr_b16 a[224:225], v21 offset:0
    ds_read_b64_tr_b16 a[226:227], v21 offset:1024
    v_mfma_f32_16x16x32_bf16 v[48:51], v[140:143], a[4:7], 0
    ds_read_b64_tr_b16 a[228:229], v22 offset:0
    v_mfma_f32_16x16x32_bf16 v[52:55], v[140:143], a[132:135], 0
    ds_read_b64_tr_b16 a[230:231], v22 offset:1024
    s_waitcnt vmcnt(11)
    v_mfma_f32_16x16x32_bf16 v[40:43], v[144:147], a[8:11], v[40:43]
    buffer_load_dwordx4 v[192:195], v34, s[84:87], s64 offen offset:0 sc1
    v_mfma_f32_16x16x32_bf16 v[44:47], v[144:147], a[136:139], v[44:47]
    ds_read_b64_tr_b16 a[232:233], v19 offset:0
    ds_read_b64_tr_b16 a[234:235], v19 offset:1024
    v_mfma_f32_16x16x32_bf16 v[48:51], v[144:147], a[12:15], v[48:51]
    ds_read_b64_tr_b16 a[236:237], v20 offset:0
    v_mfma_f32_16x16x32_bf16 v[52:55], v[144:147], a[140:143], v[52:55]
    ds_read_b64_tr_b16 a[238:239], v20 offset:1024
    s_waitcnt vmcnt(11)
    v_mfma_f32_16x16x32_bf16 v[40:43], v[148:151], a[16:19], v[40:43]
    buffer_load_dwordx4 v[140:143], v34, s[84:87], s65 offen offset:0 sc1
    v_mfma_f32_16x16x32_bf16 v[44:47], v[148:151], a[144:147], v[44:47]
    ds_read_b64_tr_b16 a[240:241], v21 offset:16384
    ds_read_b64_tr_b16 a[242:243], v21 offset:17408
    v_mfma_f32_16x16x32_bf16 v[48:51], v[148:151], a[20:23], v[48:51]
    ds_read_b64_tr_b16 a[244:245], v22 offset:16384
    v_mfma_f32_16x16x32_bf16 v[52:55], v[148:151], a[148:151], v[52:55]
    ds_read_b64_tr_b16 a[246:247], v22 offset:17408
    s_waitcnt vmcnt(11)
    v_mfma_f32_16x16x32_bf16 v[40:43], v[152:155], a[24:27], v[40:43]
    buffer_load_dwordx4 v[144:147], v34, s[84:87], s66 offen offset:0 sc1
    v_mfma_f32_16x16x32_bf16 v[44:47], v[152:155], a[152:155], v[44:47]
    ds_read_b64_tr_b16 a[248:249], v19 offset:16384
    ds_read_b64_tr_b16 a[250:251], v19 offset:17408
    v_mfma_f32_16x16x32_bf16 v[48:51], v[152:155], a[28:31], v[48:51]
    ds_read_b64_tr_b16 a[252:253], v20 offset:16384
    v_mfma_f32_16x16x32_bf16 v[52:55], v[152:155], a[156:159], v[52:55]
    ds_read_b64_tr_b16 a[254:255], v20 offset:17408
    s_waitcnt vmcnt(11)
    v_mfma_f32_16x16x32_bf16 v[40:43], v[156:159], a[32:35], v[40:43]
    buffer_load_dwordx4 v[148:151], v34, s[84:87], s89 offen offset:256 sc1
    v_mfma_f32_16x16x32_bf16 v[44:47], v[156:159], a[160:163], v[44:47]
    v_mfma_f32_16x16x32_bf16 v[48:51], v[156:159], a[36:39], v[48:51]
    v_mfma_f32_16x16x32_bf16 v[52:55], v[156:159], a[164:167], v[52:55]
    s_waitcnt vmcnt(11)
    v_mfma_f32_16x16x32_bf16 v[40:43], v[160:163], a[40:43], v[40:43]
    buffer_load_dwordx4 v[152:155], v34, s[84:87], s52 offen offset:256 sc1
    v_mfma_f32_16x16x32_bf16 v[44:47], v[160:163], a[168:171], v[44:47]
    v_mfma_f32_16x16x32_bf16 v[48:51], v[160:163], a[44:47], v[48:51]
    v_mfma_f32_16x16x32_bf16 v[52:55], v[160:163], a[172:175], v[52:55]
    s_waitcnt vmcnt(11)
    v_mfma_f32_16x16x32_bf16 v[40:43], v[164:167], a[48:51], v[40:43]
    buffer_load_dwordx4 v[156:159], v34, s[84:87], s53 offen offset:256 sc1
    v_mfma_f32_16x16x32_bf16 v[44:47], v[164:167], a[176:179], v[44:47]
    v_mfma_f32_16x16x32_bf16 v[48:51], v[164:167], a[52:55], v[48:51]
    v_mfma_f32_16x16x32_bf16 v[52:55], v[164:167], a[180:183], v[52:55]
    s_waitcnt vmcnt(11)
    v_mfma_f32_16x16x32_bf16 v[40:43], v[168:171], a[56:59], v[40:43]
    buffer_load_dwordx4 v[160:163], v34, s[84:87], s54 offen offset:256 sc1
    v_mfma_f32_16x16x32_bf16 v[44:47], v[168:171], a[184:187], v[44:47]
    v_mfma_f32_16x16x32_bf16 v[48:51], v[168:171], a[60:63], v[48:51]
    v_mfma_f32_16x16x32_bf16 v[52:55], v[168:171], a[188:191], v[52:55]
    s_waitcnt vmcnt(11)
    v_mfma_f32_16x16x32_bf16 v[40:43], v[172:175], a[64:67], v[40:43]
    buffer_load_dwordx4 v[164:167], v34, s[84:87], s55 offen offset:256 sc1
    v_mfma_f32_16x16x32_bf16 v[44:47], v[172:175], a[68:71], v[44:47]
    v_mfma_f32_16x16x32_bf16 v[48:51], v[172:175], a[72:75], v[48:51]
    v_mfma_f32_16x16x32_bf16 v[52:55], v[172:175], a[76:79], v[52:55]
    s_waitcnt vmcnt(11) lgkmcnt(15)
    v_mfma_f32_16x16x32_bf16 v[40:43], v[176:179], a[80:83], v[40:43]
    buffer_load_dwordx4 v[168:171], v34, s[84:87], s56 offen offset:256 sc1
    v_mfma_f32_16x16x32_bf16 v[44:47], v[176:179], a[84:87], v[44:47]
    v_mfma_f32_16x16x32_bf16 v[48:51], v[176:179], a[88:91], v[48:51]
    v_mfma_f32_16x16x32_bf16 v[52:55], v[176:179], a[92:95], v[52:55]
    s_waitcnt vmcnt(11)
    v_mfma_f32_16x16x32_bf16 v[40:43], v[180:183], a[96:99], v[40:43]
    buffer_load_dwordx4 v[172:175], v34, s[84:87], s57 offen offset:256 sc1
    v_mfma_f32_16x16x32_bf16 v[44:47], v[180:183], a[100:103], v[44:47]
    v_mfma_f32_16x16x32_bf16 v[48:51], v[180:183], a[104:107], v[48:51]
    v_mfma_f32_16x16x32_bf16 v[52:55], v[180:183], a[108:111], v[52:55]
    s_waitcnt vmcnt(11)
    v_mfma_f32_16x16x32_bf16 v[40:43], v[184:187], a[112:115], v[40:43]
    buffer_load_dwordx4 v[176:179], v34, s[84:87], s58 offen offset:256 sc1
    v_mfma_f32_16x16x32_bf16 v[44:47], v[184:187], a[116:119], v[44:47]
    v_mfma_f32_16x16x32_bf16 v[48:51], v[184:187], a[120:123], v[48:51]
    v_mfma_f32_16x16x32_bf16 v[52:55], v[184:187], a[124:127], v[52:55]
    s_waitcnt vmcnt(11)
    v_mfma_f32_16x16x32_bf16 v[40:43], v[188:191], a[192:195], v[40:43]
    buffer_load_dwordx4 v[180:183], v34, s[84:87], s59 offen offset:256 sc1
    v_mfma_f32_16x16x32_bf16 v[44:47], v[188:191], a[196:199], v[44:47]
    v_mfma_f32_16x16x32_bf16 v[48:51], v[188:191], a[200:203], v[48:51]
    v_mfma_f32_16x16x32_bf16 v[52:55], v[188:191], a[204:207], v[52:55]
    s_waitcnt vmcnt(11)
    v_mfma_f32_16x16x32_bf16 v[40:43], v[192:195], a[208:211], v[40:43]
    buffer_load_dwordx4 v[184:187], v34, s[84:87], s60 offen offset:256 sc1
    v_mfma_f32_16x16x32_bf16 v[44:47], v[192:195], a[212:215], v[44:47]
    v_mfma_f32_16x16x32_bf16 v[48:51], v[192:195], a[216:219], v[48:51]
    v_mfma_f32_16x16x32_bf16 v[52:55], v[192:195], a[220:223], v[52:55]
    s_waitcnt vmcnt(11) lgkmcnt(14)
    v_mfma_f32_16x16x32_bf16 v[40:43], v[140:143], a[224:227], v[40:43]
    buffer_load_dwordx4 v[188:191], v34, s[84:87], s61 offen offset:256 sc1
    s_waitcnt lgkmcnt(12)
    v_mfma_f32_16x16x32_bf16 v[44:47], v[140:143], a[228:231], v[44:47]
    s_waitcnt lgkmcnt(10)
    v_mfma_f32_16x16x32_bf16 v[48:51], v[140:143], a[232:235], v[48:51]
    s_waitcnt lgkmcnt(8)
    v_mfma_f32_16x16x32_bf16 v[52:55], v[140:143], a[236:239], v[52:55]
    s_waitcnt vmcnt(11) lgkmcnt(6)
    v_mfma_f32_16x16x32_bf16 v[40:43], v[144:147], a[240:243], v[40:43]
    buffer_load_dwordx4 v[192:195], v34, s[84:87], s62 offen offset:256 sc1
    s_waitcnt lgkmcnt(4)
    v_mfma_f32_16x16x32_bf16 v[44:47], v[144:147], a[244:247], v[44:47]
    s_waitcnt lgkmcnt(2)
    v_mfma_f32_16x16x32_bf16 v[48:51], v[144:147], a[248:251], v[48:51]
    s_waitcnt lgkmcnt(0)
    v_mfma_f32_16x16x32_bf16 v[52:55], v[144:147], a[252:255], v[52:55]
    s_waitcnt vmcnt(11)
    v_mfma_f32_16x16x32_bf16 v[56:59], v[148:151], a[0:3], 0
    buffer_load_dwordx4 v[140:143], v34, s[84:87], s63 offen offset:256 sc1
    v_mfma_f32_16x16x32_bf16 v[60:63], v[148:151], a[128:131], 0
    v_mfma_f32_16x16x32_bf16 v[64:67], v[148:151], a[4:7], 0
    ds_write_addtid_b32 v40 offset:0
    v_mfma_f32_16x16x32_bf16 v[68:71], v[148:151], a[132:135], 0
    ds_write_addtid_b32 v41 offset:256
    s_waitcnt vmcnt(11)
    v_mfma_f32_16x16x32_bf16 v[56:59], v[152:155], a[8:11], v[56:59]
    buffer_load_dwordx4 v[144:147], v34, s[84:87], s64 offen offset:256 sc1
    v_mfma_f32_16x16x32_bf16 v[60:63], v[152:155], a[136:139], v[60:63]
    ds_write_addtid_b32 v42 offset:512
    v_mfma_f32_16x16x32_bf16 v[64:67], v[152:155], a[12:15], v[64:67]
    ds_write_addtid_b32 v43 offset:768
    v_mfma_f32_16x16x32_bf16 v[68:71], v[152:155], a[140:143], v[68:71]
    s_waitcnt vmcnt(11)
    v_mfma_f32_16x16x32_bf16 v[56:59], v[156:159], a[16:19], v[56:59]
    buffer_load_dwordx4 v[148:151], v34, s[84:87], s65 offen offset:256 sc1
    v_mfma_f32_16x16x32_bf16 v[60:63], v[156:159], a[144:147], v[60:63]
    ds_write_addtid_b32 v44 offset:1024
    v_mfma_f32_16x16x32_bf16 v[64:67], v[156:159], a[20:23], v[64:67]
    ds_write_addtid_b32 v45 offset:1280
    v_mfma_f32_16x16x32_bf16 v[68:71], v[156:159], a[148:151], v[68:71]
    ds_write_addtid_b32 v46 offset:1536
    s_waitcnt vmcnt(11)
    v_mfma_f32_16x16x32_bf16 v[56:59], v[160:163], a[24:27], v[56:59]
    buffer_load_dwordx4 v[152:155], v34, s[84:87], s66 offen offset:256 sc1
    v_mfma_f32_16x16x32_bf16 v[60:63], v[160:163], a[152:155], v[60:63]
    ds_write_addtid_b32 v47 offset:1792
    v_mfma_f32_16x16x32_bf16 v[64:67], v[160:163], a[28:31], v[64:67]
    ds_write_addtid_b32 v48 offset:2048
    v_mfma_f32_16x16x32_bf16 v[68:71], v[160:163], a[156:159], v[68:71]
    ds_write_addtid_b32 v49 offset:2304
    s_waitcnt vmcnt(11)
    v_mfma_f32_16x16x32_bf16 v[56:59], v[164:167], a[32:35], v[56:59]
    buffer_load_dwordx4 v[156:159], v34, s[84:87], s89 offen offset:1024 sc1
    v_mfma_f32_16x16x32_bf16 v[60:63], v[164:167], a[160:163], v[60:63]
    ds_write_addtid_b32 v50 offset:2560
    v_mfma_f32_16x16x32_bf16 v[64:67], v[164:167], a[36:39], v[64:67]
    ds_write_addtid_b32 v51 offset:2816
    v_mfma_f32_16x16x32_bf16 v[68:71], v[164:167], a[164:167], v[68:71]
    s_waitcnt vmcnt(11)
    v_mfma_f32_16x16x32_bf16 v[56:59], v[168:171], a[40:43], v[56:59]
    buffer_load_dwordx4 v[160:163], v34, s[84:87], s52 offen offset:1024 sc1
    v_mfma_f32_16x16x32_bf16 v[60:63], v[168:171], a[168:171], v[60:63]
    ds_write_addtid_b32 v52 offset:3072
    v_mfma_f32_16x16x32_bf16 v[64:67], v[168:171], a[44:47], v[64:67]
    ds_write_addtid_b32 v53 offset:3328
    v_mfma_f32_16x16x32_bf16 v[68:71], v[168:171], a[172:175], v[68:71]
    ds_write_addtid_b32 v54 offset:3584
    s_waitcnt vmcnt(11)
    v_mfma_f32_16x16x32_bf16 v[56:59], v[172:175], a[48:51], v[56:59]
    buffer_load_dwordx4 v[164:167], v34, s[84:87], s53 offen offset:1024 sc1
    v_mfma_f32_16x16x32_bf16 v[60:63], v[172:175], a[176:179], v[60:63]
    ds_write_addtid_b32 v55 offset:3840
    v_mfma_f32_16x16x32_bf16 v[64:67], v[172:175], a[52:55], v[64:67]
    v_mfma_f32_16x16x32_bf16 v[68:71], v[172:175], a[180:183], v[68:71]
    s_waitcnt vmcnt(11)
    v_mfma_f32_16x16x32_bf16 v[56:59], v[176:179], a[56:59], v[56:59]
    buffer_load_dwordx4 v[168:171], v34, s[84:87], s54 offen offset:1024 sc1
    v_mfma_f32_16x16x32_bf16 v[60:63], v[176:179], a[184:187], v[60:63]
    v_mfma_f32_16x16x32_bf16 v[64:67], v[176:179], a[60:63], v[64:67]
    v_mfma_f32_16x16x32_bf16 v[68:71], v[176:179], a[188:191], v[68:71]
    s_waitcnt vmcnt(11)
    v_mfma_f32_16x16x32_bf16 v[56:59], v[180:183], a[64:67], v[56:59]
    buffer_load_dwordx4 v[172:175], v34, s[84:87], s55 offen offset:1024 sc1
    v_mfma_f32_16x16x32_bf16 v[60:63], v[180:183], a[68:71], v[60:63]
    v_mfma_f32_16x16x32_bf16 v[64:67], v[180:183], a[72:75], v[64:67]
    v_mfma_f32_16x16x32_bf16 v[68:71], v[180:183], a[76:79], v[68:71]
    s_waitcnt vmcnt(11)
    v_mfma_f32_16x16x32_bf16 v[56:59], v[184:187], a[80:83], v[56:59]
    buffer_load_dwordx4 v[176:179], v34, s[84:87], s56 offen offset:1024 sc1
    v_mfma_f32_16x16x32_bf16 v[60:63], v[184:187], a[84:87], v[60:63]
    v_mfma_f32_16x16x32_bf16 v[64:67], v[184:187], a[88:91], v[64:67]
    v_mfma_f32_16x16x32_bf16 v[68:71], v[184:187], a[92:95], v[68:71]
    s_waitcnt vmcnt(11)
    v_mfma_f32_16x16x32_bf16 v[56:59], v[188:191], a[96:99], v[56:59]
    buffer_load_dwordx4 v[180:183], v34, s[84:87], s57 offen offset:1024 sc1
    v_mfma_f32_16x16x32_bf16 v[60:63], v[188:191], a[100:103], v[60:63]
    v_mfma_f32_16x16x32_bf16 v[64:67], v[188:191], a[104:107], v[64:67]
    v_mfma_f32_16x16x32_bf16 v[68:71], v[188:191], a[108:111], v[68:71]
    s_waitcnt vmcnt(11)
    v_mfma_f32_16x16x32_bf16 v[56:59], v[192:195], a[112:115], v[56:59]
    buffer_load_dwordx4 v[184:187], v34, s[84:87], s58 offen offset:1024 sc1
    v_mfma_f32_16x16x32_bf16 v[60:63], v[192:195], a[116:119], v[60:63]
    v_mfma_f32_16x16x32_bf16 v[64:67], v[192:195], a[120:123], v[64:67]
    v_mfma_f32_16x16x32_bf16 v[68:71], v[192:195], a[124:127], v[68:71]
    s_waitcnt vmcnt(11)
    v_mfma_f32_16x16x32_bf16 v[56:59], v[140:143], a[192:195], v[56:59]
    buffer_load_dwordx4 v[188:191], v34, s[84:87], s59 offen offset:1024 sc1
    v_mfma_f32_16x16x32_bf16 v[60:63], v[140:143], a[196:199], v[60:63]
    v_mfma_f32_16x16x32_bf16 v[64:67], v[140:143], a[200:203], v[64:67]
    v_mfma_f32_16x16x32_bf16 v[68:71], v[140:143], a[204:207], v[68:71]
    s_waitcnt vmcnt(11)
    v_mfma_f32_16x16x32_bf16 v[56:59], v[144:147], a[208:211], v[56:59]
    buffer_load_dwordx4 v[192:195], v34, s[84:87], s60 offen offset:1024 sc1
    v_mfma_f32_16x16x32_bf16 v[60:63], v[144:147], a[212:215], v[60:63]
    v_mfma_f32_16x16x32_bf16 v[64:67], v[144:147], a[216:219], v[64:67]
    v_mfma_f32_16x16x32_bf16 v[68:71], v[144:147], a[220:223], v[68:71]
    s_waitcnt vmcnt(11)
    v_mfma_f32_16x16x32_bf16 v[56:59], v[148:151], a[224:227], v[56:59]
    buffer_load_dwordx4 v[140:143], v34, s[84:87], s61 offen offset:1024 sc1
    v_mfma_f32_16x16x32_bf16 v[60:63], v[148:151], a[228:231], v[60:63]
    v_mfma_f32_16x16x32_bf16 v[64:67], v[148:151], a[232:235], v[64:67]
    v_mfma_f32_16x16x32_bf16 v[68:71], v[148:151], a[236:239], v[68:71]
    s_waitcnt vmcnt(11)
    v_mfma_f32_16x16x32_bf16 v[56:59], v[152:155], a[240:243], v[56:59]
    buffer_load_dwordx4 v[144:147], v34, s[84:87], s62 offen offset:1024 sc1
    v_mfma_f32_16x16x32_bf16 v[60:63], v[152:155], a[244:247], v[60:63]
    v_mfma_f32_16x16x32_bf16 v[64:67], v[152:155], a[248:251], v[64:67]
    v_mfma_f32_16x16x32_bf16 v[68:71], v[152:155], a[252:255], v[68:71]
    s_waitcnt vmcnt(11)
    v_mfma_f32_16x16x32_bf16 v[72:75], v[156:159], a[0:3], 0
    buffer_load_dwordx4 v[148:151], v34, s[84:87], s63 offen offset:1024 sc1
    v_mfma_f32_16x16x32_bf16 v[76:79], v[156:159], a[128:131], 0
    v_mfma_f32_16x16x32_bf16 v[80:83], v[156:159], a[4:7], 0
    ds_write_addtid_b32 v56 offset:16384
    v_mfma_f32_16x16x32_bf16 v[84:87], v[156:159], a[132:135], 0
    s_waitcnt lgkmcnt(1)
    s_barrier
    s_waitcnt vmcnt(11)
    v_mfma_f32_16x16x32_bf16 v[72:75], v[160:163], a[8:11], v[72:75]
    buffer_load_dwordx4 v[152:155], v34, s[84:87], s64 offen offset:1024 sc1
    v_mfma_f32_16x16x32_bf16 v[76:79], v[160:163], a[136:139], v[76:79]
    ds_write_addtid_b32 v57 offset:16640
    ds_read_b128 v[44:47], v23 offset:4096
    ds_read_b128 v[48:51], v23 offset:8192
    v_mfma_f32_16x16x32_bf16 v[80:83], v[160:163], a[12:15], v[80:83]
    ds_write_addtid_b32 v58 offset:16896
    ds_write_addtid_b32 v59 offset:17152
    v_mfma_f32_16x16x32_bf16 v[84:87], v[160:163], a[140:143], v[84:87]
    ds_read_b128 v[52:55], v23 offset:12288
    ds_read_b128 v[40:43], v23 offset:0
    s_waitcnt vmcnt(11)
    v_mfma_f32_16x16x32_bf16 v[72:75], v[164:167], a[16:19], v[72:75]
    buffer_load_dwordx4 v[156:159], v34, s[84:87], s65 offen offset:1024 sc1
    v_mfma_f32_16x16x32_bf16 v[76:79], v[164:167], a[144:147], v[76:79]
    ds_write_addtid_b32 v60 offset:17408
    v_mfma_f32_16x16x32_bf16 v[80:83], v[164:167], a[20:23], v[80:83]
    ds_write_addtid_b32 v61 offset:17664
    v_mfma_f32_16x16x32_bf16 v[84:87], v[164:167], a[148:151], v[84:87]
    ds_write_addtid_b32 v62 offset:17920
    s_waitcnt vmcnt(11)
    v_mfma_f32_16x16x32_bf16 v[72:75], v[168:171], a[24:27], v[72:75]
    buffer_load_dwordx4 v[160:163], v34, s[84:87], s66 offen offset:1024 sc1
    v_mfma_f32_16x16x32_bf16 v[76:79], v[168:171], a[152:155], v[76:79]
    ds_write_addtid_b32 v63 offset:18176
    v_mfma_f32_16x16x32_bf16 v[80:83], v[168:171], a[28:31], v[80:83]
    ds_write_addtid_b32 v64 offset:18432
    s_waitcnt lgkmcnt(10)
    v_add_f32 v44, v44, v116
    v_mfma_f32_16x16x32_bf16 v[84:87], v[168:171], a[156:159], v[84:87]
    v_add_f32 v45, v45, v117
    s_waitcnt vmcnt(11)
    v_mfma_f32_16x16x32_bf16 v[72:75], v[172:175], a[32:35], v[72:75]
    buffer_load_dwordx4 v[164:167], v34, s[84:87], s89 offen offset:1280 sc1
    v_mfma_f32_16x16x32_bf16 v[76:79], v[172:175], a[160:163], v[76:79]
    ds_write_addtid_b32 v65 offset:18688
    ds_write_addtid_b32 v66 offset:18944
    v_mfma_f32_16x16x32_bf16 v[80:83], v[172:175], a[36:39], v[80:83]
    ds_write_addtid_b32 v67 offset:19200
    v_mfma_f32_16x16x32_bf16 v[84:87], v[172:175], a[164:167], v[84:87]
    v_add_f32 v46, v46, v118
    s_waitcnt vmcnt(11)
    v_mfma_f32_16x16x32_bf16 v[72:75], v[176:179], a[40:43], v[72:75]
    buffer_load_dwordx4 v[168:171], v34, s[84:87], s52 offen offset:1280 sc1
    v_mfma_f32_16x16x32_bf16 v[76:79], v[176:179], a[168:171], v[76:79]
    ds_write_addtid_b32 v68 offset:19456
    v_mfma_f32_16x16x32_bf16 v[80:83], v[176:179], a[44:47], v[80:83]
    ds_write_addtid_b32 v69 offset:19712
    v_add_f32 v47, v47, v119
    v_mfma_f32_16x16x32_bf16 v[84:87], v[176:179], a[172:175], v[84:87]
    ds_write_addtid_b32 v70 offset:19968
    s_waitcnt vmcnt(11)
    v_mfma_f32_16x16x32_bf16 v[72:75], v[180:183], a[48:51], v[72:75]
    buffer_load_dwordx4 v[172:175], v34, s[84:87], s53 offen offset:1280 sc1
    v_mfma_f32_16x16x32_bf16 v[76:79], v[180:183], a[176:179], v[76:79]
    ds_write_addtid_b32 v71 offset:20224
    s_waitcnt lgkmcnt(15)
    v_add_f32 v44, v44, v48
    v_mfma_f32_16x16x32_bf16 v[80:83], v[180:183], a[52:55], v[80:83]
    v_add_f32 v45, v45, v49
    v_mfma_f32_16x16x32_bf16 v[84:87], v[180:183], a[180:183], v[84:87]
    s_waitcnt vmcnt(11)
    v_mfma_f32_16x16x32_bf16 v[72:75], v[184:187], a[56:59], v[72:75]
    buffer_load_dwordx4 v[176:179], v34, s[84:87], s54 offen offset:1280 sc1
    v_mfma_f32_16x16x32_bf16 v[76:79], v[184:187], a[184:187], v[76:79]
    v_add_f32 v46, v46, v50
    v_add_f32 v47, v47, v51
    v_mfma_f32_16x16x32_bf16 v[80:83], v[184:187], a[60:63], v[80:83]
    s_waitcnt lgkmcnt(13)
    v_add_f32 v44, v44, v52
    v_add_f32 v45, v45, v53
    v_mfma_f32_16x16x32_bf16 v[84:87], v[184:187], a[188:191], v[84:87]
    v_add_f32 v46, v46, v54
    s_waitcnt vmcnt(11)
    v_mfma_f32_16x16x32_bf16 v[72:75], v[188:191], a[64:67], v[72:75]
    buffer_load_dwordx4 v[180:183], v34, s[84:87], s55 offen offset:1280 sc1
    v_mfma_f32_16x16x32_bf16 v[76:79], v[188:191], a[68:71], v[76:79]
    v_add_f32 v47, v47, v55
    v_mul_f32 v48, v44, v36
    v_mfma_f32_16x16x32_bf16 v[80:83], v[188:191], a[72:75], v[80:83]
    v_mul_f32 v49, v45, v36
    v_mul_f32 v50, v46, v36
    v_mfma_f32_16x16x32_bf16 v[84:87], v[188:191], a[76:79], v[84:87]
    v_mul_f32 v51, v47, v36
    s_waitcnt vmcnt(11)
    v_mfma_f32_16x16x32_bf16 v[72:75], v[192:195], a[80:83], v[72:75]
    buffer_load_dwordx4 v[184:187], v34, s[84:87], s56 offen offset:1280 sc1
    v_mfma_f32_16x16x32_bf16 v[76:79], v[192:195], a[84:87], v[76:79]
    v_exp_f32 v48, v48
    v_mfma_f32_16x16x32_bf16 v[80:83], v[192:195], a[88:91], v[80:83]
    v_exp_f32 v49, v49
    v_mfma_f32_16x16x32_bf16 v[84:87], v[192:195], a[92:95], v[84:87]
    s_waitcnt vmcnt(11)
    v_mfma_f32_16x16x32_bf16 v[72:75], v[140:143], a[96:99], v[72:75]
    buffer_load_dwordx4 v[188:191], v34, s[84:87], s57 offen offset:1280 sc1
    v_mfma_f32_16x16x32_bf16 v[76:79], v[140:143], a[100:103], v[76:79]
    v_exp_f32 v50, v50
    v_mfma_f32_16x16x32_bf16 v[80:83], v[140:143], a[104:107], v[80:83]
    v_exp_f32 v51, v51
    v_mfma_f32_16x16x32_bf16 v[84:87], v[140:143], a[108:111], v[84:87]
    s_waitcnt vmcnt(11)
    v_mfma_f32_16x16x32_bf16 v[72:75], v[144:147], a[112:115], v[72:75]
    buffer_load_dwordx4 v[192:195], v34, s[84:87], s58 offen offset:1280 sc1
    v_mfma_f32_16x16x32_bf16 v[76:79], v[144:147], a[116:119], v[76:79]
    s_waitcnt lgkmcnt(12)
    v_mul_f32 v44, v44, v40
    v_mfma_f32_16x16x32_bf16 v[80:83], v[144:147], a[120:123], v[80:83]
    v_mul_f32 v45, v45, v41
    v_mfma_f32_16x16x32_bf16 v[84:87], v[144:147], a[124:127], v[84:87]
    v_mul_f32 v46, v46, v42
    s_waitcnt vmcnt(11)
    v_mfma_f32_16x16x32_bf16 v[72:75], v[148:151], a[192:195], v[72:75]
    buffer_load_dwordx4 v[140:143], v34, s[84:87], s59 offen offset:1280 sc1
    v_mfma_f32_16x16x32_bf16 v[76:79], v[148:151], a[196:199], v[76:79]
    v_mul_f32 v47, v47, v43
    v_add_f32 v48, v48, v38
    v_mfma_f32_16x16x32_bf16 v[80:83], v[148:151], a[200:203], v[80:83]
    v_add_f32 v49, v49, v38
    v_add_f32 v50, v50, v38
    v_mfma_f32_16x16x32_bf16 v[84:87], v[148:151], a[204:207], v[84:87]
    v_add_f32 v51, v51, v38
    s_waitcnt vmcnt(11)
    v_mfma_f32_16x16x32_bf16 v[72:75], v[152:155], a[208:211], v[72:75]
    buffer_load_dwordx4 v[144:147], v34, s[84:87], s60 offen offset:1280 sc1
    v_mfma_f32_16x16x32_bf16 v[76:79], v[152:155], a[212:215], v[76:79]
    v_rcp_f32 v48, v48
    v_mfma_f32_16x16x32_bf16 v[80:83], v[152:155], a[216:219], v[80:83]
    v_rcp_f32 v49, v49
    v_mfma_f32_16x16x32_bf16 v[84:87], v[152:155], a[220:223], v[84:87]
    s_waitcnt vmcnt(11)
    v_mfma_f32_16x16x32_bf16 v[72:75], v[156:159], a[224:227], v[72:75]
    buffer_load_dwordx4 v[148:151], v34, s[84:87], s61 offen offset:1280 sc1
    v_mfma_f32_16x16x32_bf16 v[76:79], v[156:159], a[228:231], v[76:79]
    v_rcp_f32 v50, v50
    v_mfma_f32_16x16x32_bf16 v[80:83], v[156:159], a[232:235], v[80:83]
    v_rcp_f32 v51, v51
    v_mfma_f32_16x16x32_bf16 v[84:87], v[156:159], a[236:239], v[84:87]
    v_fma_f32 v44, v44, v48, v124
    s_waitcnt vmcnt(11)
    v_mfma_f32_16x16x32_bf16 v[72:75], v[160:163], a[240:243], v[72:75]
    buffer_load_dwordx4 v[152:155], v34, s[84:87], s62 offen offset:1280 sc1
    v_mfma_f32_16x16x32_bf16 v[76:79], v[160:163], a[244:247], v[76:79]
    v_fma_f32 v45, v45, v49, v125
    v_fma_f32 v46, v46, v50, v126
    v_mfma_f32_16x16x32_bf16 v[80:83], v[160:163], a[248:251], v[80:83]
    v_fma_f32 v47, v47, v51, v127
    v_cvt_pk_bf16_f32 v104, v44, v45
    v_mfma_f32_16x16x32_bf16 v[84:87], v[160:163], a[252:255], v[84:87]
    v_cvt_pk_bf16_f32 v105, v46, v47
    s_waitcnt vmcnt(11)
    v_mfma_f32_16x16x32_bf16 v[88:91], v[164:167], a[0:3], 0
    buffer_load_dwordx4 v[156:159], v34, s[84:87], s63 offen offset:1280 sc1
    v_mfma_f32_16x16x32_bf16 v[92:95], v[164:167], a[128:131], 0
    buffer_store_dwordx2 v[104:105], v25, s[24:27], 0 offen offset:0 sc1
    v_mfma_f32_16x16x32_bf16 v[96:99], v[164:167], a[4:7], 0
    ds_write_addtid_b32 v72 offset:32768
    v_mfma_f32_16x16x32_bf16 v[100:103], v[164:167], a[132:135], 0
    s_waitcnt vmcnt(12)
    v_mfma_f32_16x16x32_bf16 v[88:91], v[168:171], a[8:11], v[88:91]
    buffer_load_dwordx4 v[160:163], v34, s[84:87], s64 offen offset:1280 sc1
    v_mfma_f32_16x16x32_bf16 v[92:95], v[168:171], a[136:139], v[92:95]
    ds_write_addtid_b32 v73 offset:33024
    v_mfma_f32_16x16x32_bf16 v[96:99], v[168:171], a[12:15], v[96:99]
    ds_write_addtid_b32 v74 offset:33280
    v_mfma_f32_16x16x32_bf16 v[100:103], v[168:171], a[140:143], v[100:103]
    ds_write_addtid_b32 v75 offset:33536
    s_waitcnt vmcnt(12)
    v_mfma_f32_16x16x32_bf16 v[88:91], v[172:175], a[16:19], v[88:91]
    buffer_load_dwordx4 v[164:167], v34, s[84:87], s65 offen offset:1280 sc1
    v_mfma_f32_16x16x32_bf16 v[92:95], v[172:175], a[144:147], v[92:95]
    ds_write_addtid_b32 v76 offset:33792
    v_mfma_f32_16x16x32_bf16 v[96:99], v[172:175], a[20:23], v[96:99]
    ds_write_addtid_b32 v77 offset:34048
    v_mfma_f32_16x16x32_bf16 v[100:103], v[172:175], a[148:151], v[100:103]
    s_waitcnt vmcnt(12)
    v_mfma_f32_16x16x32_bf16 v[88:91], v[176:179], a[24:27], v[88:91]
    buffer_load_dwordx4 v[168:171], v34, s[84:87], s66 offen offset:1280 sc1
    v_mfma_f32_16x16x32_bf16 v[92:95], v[176:179], a[152:155], v[92:95]
    ds_write_addtid_b32 v78 offset:34304
    v_mfma_f32_16x16x32_bf16 v[96:99], v[176:179], a[28:31], v[96:99]
    ds_write_addtid_b32 v79 offset:34560
    v_mfma_f32_16x16x32_bf16 v[100:103], v[176:179], a[156:159], v[100:103]
    s_waitcnt lgkmcnt(8)
    s_barrier
    s_waitcnt vmcnt(12)
    v_mfma_f32_16x16x32_bf16 v[88:91], v[180:183], a[32:35], v[88:91]
    ds_write_addtid_b32 v80 offset:34816
    ds_read_b128 v[60:63], v23 offset:20480
    v_mfma_f32_16x16x32_bf16 v[92:95], v[180:183], a[160:163], v[92:95]
    ds_write_addtid_b32 v81 offset:35072
    ds_read_b128 v[64:67], v23 offset:24576
    v_mfma_f32_16x16x32_bf16 v[96:99], v[180:183], a[36:39], v[96:99]
    ds_write_addtid_b32 v82 offset:35328
    ds_read_b128 v[68:71], v23 offset:28672
    v_mfma_f32_16x16x32_bf16 v[100:103], v[180:183], a[164:167], v[100:103]
    ds_read_b128 v[56:59], v23 offset:16384
    s_waitcnt vmcnt(11)
    v_mfma_f32_16x16x32_bf16 v[88:91], v[184:187], a[40:43], v[88:91]
    ds_write_addtid_b32 v83 offset:35584
    v_mfma_f32_16x16x32_bf16 v[92:95], v[184:187], a[168:171], v[92:95]
    ds_write_addtid_b32 v84 offset:35840
    v_mfma_f32_16x16x32_bf16 v[96:99], v[184:187], a[44:47], v[96:99]
    ds_write_addtid_b32 v85 offset:36096
    v_mfma_f32_16x16x32_bf16 v[100:103], v[184:187], a[172:175], v[100:103]
    ds_write_addtid_b32 v86 offset:36352
    s_waitcnt vmcnt(10)
    v_mfma_f32_16x16x32_bf16 v[88:91], v[188:191], a[48:51], v[88:91]
    s_waitcnt lgkmcnt(9)
    v_add_f32 v60, v60, v116
    v_mfma_f32_16x16x32_bf16 v[92:95], v[188:191], a[176:179], v[92:95]
    ds_write_addtid_b32 v87 offset:36608
    v_mfma_f32_16x16x32_bf16 v[96:99], v[188:191], a[52:55], v[96:99]
    v_add_f32 v61, v61, v117
    v_add_f32 v62, v62, v118
    v_mfma_f32_16x16x32_bf16 v[100:103], v[188:191], a[180:183], v[100:103]
    v_add_f32 v63, v63, v119
    s_waitcnt vmcnt(9)
    v_mfma_f32_16x16x32_bf16 v[88:91], v[192:195], a[56:59], v[88:91]
    v_mfma_f32_16x16x32_bf16 v[92:95], v[192:195], a[184:187], v[92:95]
    s_waitcnt lgkmcnt(8)
    v_add_f32 v60, v60, v64
    v_add_f32 v61, v61, v65
    v_mfma_f32_16x16x32_bf16 v[96:99], v[192:195], a[60:63], v[96:99]
    v_add_f32 v62, v62, v66
    v_mfma_f32_16x16x32_bf16 v[100:103], v[192:195], a[188:191], v[100:103]
    s_waitcnt vmcnt(8)
    v_mfma_f32_16x16x32_bf16 v[88:91], v[140:143], a[64:67], v[88:91]
    v_add_f32 v63, v63, v67
    s_waitcnt lgkmcnt(6)
    v_add_f32 v60, v60, v68
    v_mfma_f32_16x16x32_bf16 v[92:95], v[140:143], a[68:71], v[92:95]
    v_add_f32 v61, v61, v69
    v_mfma_f32_16x16x32_bf16 v[96:99], v[140:143], a[72:75], v[96:99]
    v_add_f32 v62, v62, v70
    v_add_f32 v63, v63, v71
    v_mfma_f32_16x16x32_bf16 v[100:103], v[140:143], a[76:79], v[100:103]
    s_waitcnt vmcnt(7)
    v_mfma_f32_16x16x32_bf16 v[88:91], v[144:147], a[80:83], v[88:91]
    v_mul_f32 v64, v60, v36
    v_mul_f32 v65, v61, v36
    v_mfma_f32_16x16x32_bf16 v[92:95], v[144:147], a[84:87], v[92:95]
    v_mul_f32 v66, v62, v36
    v_mul_f32 v67, v63, v36
    v_mfma_f32_16x16x32_bf16 v[96:99], v[144:147], a[88:91], v[96:99]
    v_exp_f32 v64, v64
    v_mfma_f32_16x16x32_bf16 v[100:103], v[144:147], a[92:95], v[100:103]
    s_waitcnt vmcnt(6)
    v_mfma_f32_16x16x32_bf16 v[88:91], v[148:151], a[96:99], v[88:91]
    v_mfma_f32_16x16x32_bf16 v[92:95], v[148:151], a[100:103], v[92:95]
    v_exp_f32 v65, v65
    v_mfma_f32_16x16x32_bf16 v[96:99], v[148:151], a[104:107], v[96:99]
    v_exp_f32 v66, v66
    v_mfma_f32_16x16x32_bf16 v[100:103], v[148:151], a[108:111], v[100:103]
    s_waitcnt vmcnt(5)
    v_mfma_f32_16x16x32_bf16 v[88:91], v[152:155], a[112:115], v[88:91]
    v_mfma_f32_16x16x32_bf16 v[92:95], v[152:155], a[116:119], v[92:95]
    v_exp_f32 v67, v67
    v_mfma_f32_16x16x32_bf16 v[96:99], v[152:155], a[120:123], v[96:99]
    s_waitcnt lgkmcnt(5)
    v_mul_f32 v60, v60, v56
    v_mul_f32 v61, v61, v57
    v_mfma_f32_16x16x32_bf16 v[100:103], v[152:155], a[124:127], v[100:103]
    v_mul_f32 v62, v62, v58
    s_waitcnt vmcnt(4)
    v_mfma_f32_16x16x32_bf16 v[88:91], v[156:159], a[192:195], v[88:91]
    v_mul_f32 v63, v63, v59
    v_mfma_f32_16x16x32_bf16 v[92:95], v[156:159], a[196:199], v[92:95]
    v_add_f32 v64, v64, v38
    v_add_f32 v65, v65, v38
    v_mfma_f32_16x16x32_bf16 v[96:99], v[156:159], a[200:203], v[96:99]
    v_add_f32 v66, v66, v38
    v_mfma_f32_16x16x32_bf16 v[100:103], v[156:159], a[204:207], v[100:103]
    v_add_f32 v67, v67, v38
    s_waitcnt vmcnt(2)
    v_mfma_f32_16x16x32_bf16 v[88:91], v[160:163], a[208:211], v[88:91]
    v_rcp_f32 v64, v64
    v_mfma_f32_16x16x32_bf16 v[92:95], v[160:163], a[212:215], v[92:95]
    v_mfma_f32_16x16x32_bf16 v[96:99], v[160:163], a[216:219], v[96:99]
    v_rcp_f32 v65, v65
    v_mfma_f32_16x16x32_bf16 v[100:103], v[160:163], a[220:223], v[100:103]
    s_waitcnt vmcnt(1)
    v_mfma_f32_16x16x32_bf16 v[88:91], v[164:167], a[224:227], v[88:91]
    v_rcp_f32 v66, v66
    v_mfma_f32_16x16x32_bf16 v[92:95], v[164:167], a[228:231], v[92:95]
    v_rcp_f32 v67, v67
    v_mfma_f32_16x16x32_bf16 v[96:99], v[164:167], a[232:235], v[96:99]
    v_fma_f32 v60, v60, v64, v128
    v_mfma_f32_16x16x32_bf16 v[100:103], v[164:167], a[236:239], v[100:103]
    v_fma_f32 v61, v61, v65, v129
    s_waitcnt vmcnt(0)
    v_mfma_f32_16x16x32_bf16 v[88:91], v[168:171], a[240:243], v[88:91]
    v_fma_f32 v62, v62, v66, v130
    v_fma_f32 v63, v63, v67, v131
    v_mfma_f32_16x16x32_bf16 v[92:95], v[168:171], a[244:247], v[92:95]
    v_cvt_pk_bf16_f32 v106, v60, v61
    v_mfma_f32_16x16x32_bf16 v[96:99], v[168:171], a[248:251], v[96:99]
    v_cvt_pk_bf16_f32 v107, v62, v63
    v_mfma_f32_16x16x32_bf16 v[100:103], v[168:171], a[252:255], v[100:103]
    buffer_store_dwordx2 v[106:107], v25, s[24:27], s76 offen offset:0 sc1
    ds_write_addtid_b32 v88 offset:49152
    ds_write_addtid_b32 v89 offset:49408
    ds_write_addtid_b32 v90 offset:49664
    ds_write_addtid_b32 v91 offset:49920
    ds_write_addtid_b32 v92 offset:50176
    ds_write_addtid_b32 v93 offset:50432
    ds_write_addtid_b32 v94 offset:50688
    ds_write_addtid_b32 v95 offset:50944
    ds_write_addtid_b32 v96 offset:51200
    ds_write_addtid_b32 v97 offset:51456
    ds_write_addtid_b32 v98 offset:51712
    ds_write_addtid_b32 v99 offset:51968
    ds_write_addtid_b32 v100 offset:52224
    ds_write_addtid_b32 v101 offset:52480
    ds_write_addtid_b32 v102 offset:52736
    ds_write_addtid_b32 v103 offset:52992
    s_waitcnt lgkmcnt(15)
    s_barrier
    ds_read_b128 v[76:79], v23 offset:36864
    ds_read_b128 v[80:83], v23 offset:40960
    ds_read_b128 v[84:87], v23 offset:45056
    ds_read_b128 v[72:75], v23 offset:32768
    s_waitcnt lgkmcnt(3)
    v_pk_add_f32 v[76:77], v[76:77], v[116:117]
    v_pk_add_f32 v[78:79], v[78:79], v[118:119]
    s_waitcnt lgkmcnt(2)
    v_pk_add_f32 v[76:77], v[76:77], v[80:81]
    v_pk_add_f32 v[78:79], v[78:79], v[82:83]
    s_waitcnt lgkmcnt(1)
    v_pk_add_f32 v[76:77], v[76:77], v[84:85]
    v_pk_add_f32 v[78:79], v[78:79], v[86:87]
    v_pk_mul_f32 v[80:81], v[76:77], v[36:37] op_sel_hi:[1,0]
    v_pk_mul_f32 v[82:83], v[78:79], v[36:37] op_sel_hi:[1,0]
    v_exp_f32 v80, v80
    v_exp_f32 v81, v81
    v_exp_f32 v82, v82
    v_exp_f32 v83, v83
    s_waitcnt lgkmcnt(0)
    v_pk_mul_f32 v[76:77], v[76:77], v[72:73]
    v_pk_mul_f32 v[78:79], v[78:79], v[74:75]
    v_pk_add_f32 v[80:81], v[80:81], v[38:39] op_sel_hi:[1,0]
    v_pk_add_f32 v[82:83], v[82:83], v[38:39] op_sel_hi:[1,0]
    v_rcp_f32 v80, v80
    v_rcp_f32 v81, v81
    v_rcp_f32 v82, v82
    v_rcp_f32 v83, v83
    v_pk_fma_f32 v[76:77], v[76:77], v[80:81], v[132:133]
    v_pk_fma_f32 v[78:79], v[78:79], v[82:83], v[134:135]
    v_cvt_pk_bf16_f32 v108, v76, v77
    v_cvt_pk_bf16_f32 v109, v78, v79
    buffer_store_dwordx2 v[108:109], v25, s[24:27], 0 offen offset:1024 sc1
    s_barrier
    ds_read_b128 v[92:95], v23 offset:53248
    ds_read_b128 v[96:99], v23 offset:57344
    ds_read_b128 v[100:103], v23 offset:61440
    ds_read_b128 v[88:91], v23 offset:49152
    s_waitcnt lgkmcnt(3)
    v_pk_add_f32 v[92:93], v[92:93], v[116:117]
    v_pk_add_f32 v[94:95], v[94:95], v[118:119]
    s_waitcnt lgkmcnt(2)
    v_pk_add_f32 v[92:93], v[92:93], v[96:97]
    v_pk_add_f32 v[94:95], v[94:95], v[98:99]
    s_waitcnt lgkmcnt(1)
    v_pk_add_f32 v[92:93], v[92:93], v[100:101]
    v_pk_add_f32 v[94:95], v[94:95], v[102:103]
    v_pk_mul_f32 v[96:97], v[92:93], v[36:37] op_sel_hi:[1,0]
    v_pk_mul_f32 v[98:99], v[94:95], v[36:37] op_sel_hi:[1,0]
    v_exp_f32 v96, v96
    v_exp_f32 v97, v97
    v_exp_f32 v98, v98
    v_exp_f32 v99, v99
    s_waitcnt lgkmcnt(0)
    v_pk_mul_f32 v[92:93], v[92:93], v[88:89]
    v_pk_mul_f32 v[94:95], v[94:95], v[90:91]
    v_pk_add_f32 v[96:97], v[96:97], v[38:39] op_sel_hi:[1,0]
    v_pk_add_f32 v[98:99], v[98:99], v[38:39] op_sel_hi:[1,0]
    v_rcp_f32 v96, v96
    v_rcp_f32 v97, v97
    v_rcp_f32 v98, v98
    v_rcp_f32 v99, v99
    v_pk_fma_f32 v[92:93], v[92:93], v[96:97], v[136:137]
    v_pk_fma_f32 v[94:95], v[94:95], v[98:99], v[138:139]
    v_cvt_pk_bf16_f32 v110, v92, v93
    v_cvt_pk_bf16_f32 v111, v94, v95
    buffer_store_dwordx2 v[110:111], v25, s[24:27], s76 offen offset:1024 sc1
    s_endpgm
L_a_rdy_retry:
    s_mov_b32 s82, 1048576
L_a_rdy_loop:
    buffer_load_dword v9, off, s[28:31], 0 sc1
    s_sub_u32 s82, s82, 1
    s_cbranch_scc1 L_a_rdy_ok
    s_waitcnt vmcnt(0)
    v_readfirstlane_b32 s3, v9
    s_nop 3
    s_cmp_eq_u32 s3, 0
    s_cbranch_scc1 L_a_rdy_loop
    s_branch L_a_rdy_ok
L_a0_go_retry:
    s_mov_b32 s82, 1048576
L_a0_go_loop:
    s_mov_b64 exec, s[92:93]
    buffer_load_dword v4, v3, s[16:19], s91 offen sc1
    s_mov_b64 exec, -1
    s_sub_u32 s82, s82, 1
    s_cbranch_scc1 L_a0_go_ok
    s_waitcnt vmcnt(0)
    v_cmp_ne_u32 vcc, 1, v4
    s_nop 4
    s_cbranch_vccnz L_a0_go_loop
    s_branch L_a0_go_ok
L_a1_go_retry:
    s_mov_b32 s82, 1048576
L_a1_go_loop:
    s_mov_b64 exec, s[92:93]
    buffer_load_dword v4, v3, s[16:19], s91 offen sc1
    s_mov_b64 exec, -1
    s_sub_u32 s82, s82, 1
    s_cbranch_scc1 L_a1_go_ok
    s_waitcnt vmcnt(0)
    v_cmp_ne_u32 vcc, 1, v4
    s_nop 4
    s_cbranch_vccnz L_a1_go_loop
    s_branch L_a1_go_ok
L_exit:
    s_endpgm
L_code_end:
.section .rodata,"a"
.p2align 6
.amdhsa_kernel recurrent_scan__sliding_local_dilated__dense_activation_gelu__prompt_kernel
  .amdhsa_next_free_vgpr 512
  .amdhsa_next_free_sgpr 102
  .amdhsa_accum_offset 256
  .amdhsa_group_segment_fixed_size 0
  .amdhsa_kernarg_size 88
  .amdhsa_user_sgpr_count 2
  .amdhsa_user_sgpr_kernarg_segment_ptr 1
  .amdhsa_system_sgpr_workgroup_id_x 1
.end_amdhsa_kernel
```
